```python
import torch

def _softmax(x, axis=-1):
    return torch.softmax(x, dim=axis)
def _gelu(x):
    return torch.nn.functional.gelu(x, approximate="tanh")
def _silu(x):
    return torch.nn.functional.silu(x)
def _sigmoid(x):
    return torch.sigmoid(x)
def _layernorm(x, axis=-1, eps=1e-5):
    m = x.mean(dim=axis, keepdim=True)
    v = x.var(dim=axis, keepdim=True, unbiased=False)
    return (x - m) / torch.sqrt(v + eps)
def _scatter_add(tgt, idx, src, axis=0):
    return tgt.clone().index_add_(axis, idx, src)
def _segment_sum(src, seg, n):
    out = torch.zeros((n,) + src.shape[1:], dtype=src.dtype)
    return out.index_add_(0, seg, src)
def _pad(x, pw):
    flat = tuple(v for pair in reversed(pw) for v in pair)
    return torch.nn.functional.pad(x, flat)

kernel_name = 'standalone__mha_softmax__near_ridge'

def setup_inputs():

    _w = (lambda a: (lambda t: t.to(torch.bfloat16) if t.is_floating_point() else t)(torch.as_tensor(a)))
    B, H, Sq, Sk, D = 16, 32, 288, 512, 128
    return {
        "q": _w((lambda *s: torch.randn(*s, dtype=torch.bfloat16) * 0.8)(B, H, Sq, D)),
        "k": _w((lambda *s: torch.randn(*s, dtype=torch.bfloat16) * 0.8)(B, H, Sk, D)),
        "v": _w((lambda *s: torch.randn(*s, dtype=torch.bfloat16) * 0.05)(B, H, Sk, D)),
    }

def reference(q, k, v):
    scale = q.shape[-1] ** -0.5
    scores = torch.einsum("bhqd,bhkd->bhqk", q, k) * scale
    p = _softmax(scores, axis=-1)
    return torch.einsum("bhqk,bhkd->bhqd", p, v)
```

```asm
; @launch grid=(256,1,1) block=(256,1,1) lds=163840
.amdgcn_target "amdgcn-amd-amdhsa--gfx950"
.text
.globl standalone__mha_softmax__near_ridge_kernel
.p2align 8
.type standalone__mha_softmax__near_ridge_kernel,@function
standalone__mha_softmax__near_ridge_kernel:
  s_cmp_ge_u32 s2, 0x100
  s_cbranch_scc1 L_end
  s_load_dwordx2 s[8:9], s[0:1], 0
  s_load_dwordx2 s[12:13], s[0:1], 8
  s_load_dwordx2 s[16:17], s[0:1], 16
  s_load_dwordx2 s[20:21], s[0:1], 24
  v_lshrrev_b32 v1, 6, v0
  s_getpc_b64 s[4:5]
  s_bfe_u32 s36, s2, 0x30003
  s_lshl_b32 s36, s36, 13
  v_lshrrev_b32 v40, 2, v0
  v_lshl_add_u32 v40, v40, 7, s36
  v_min_u32 v40, L_slow-L_start, v40
  global_load_dword v41, v40, s[4:5]
  v_readfirstlane_b32 s3, v1
  v_and_b32 v0, 63, v0
  v_lshrrev_b32 v30, 4, v0
  v_and_b32 v31, 15, v0
  v_xor_b32 v32, v30, v31
  v_lshlrev_b32 v33, 10, v1
  v_lshl_add_u32 v33, v30, 8, v33
  v_lshl_add_u32 v2, v32, 4, v33
  v_add_u32 v3, 0xc00, v2
  v_lshlrev_b32 v33, 8, v1
  v_lshl_add_u32 v33, v30, 11, v33
  v_lshl_add_u32 v4, v31, 4, v33
  v_xor_b32 v5, 0x80, v4
  v_lshlrev_b32 v33, 4, v30
  v_lshl_add_u32 v12, v31, 8, v33
  s_mov_b32 s10, 37748736
  s_mov_b32 s11, 0x20000
  s_mov_b32 s14, 67108864
  s_mov_b32 s15, 0x20000
  s_mov_b32 s18, 67108864
  s_mov_b32 s19, 0x20000
  s_mov_b32 s22, 37748736
  s_mov_b32 s23, 0x20000
  s_mul_i32 s24, s3, 2112
  s_and_b32 s36, s3, 1
  s_mul_i32 s36, s36, 24
  s_mul_i32 s25, s3, 2080
  s_sub_u32 s25, s25, s36
  s_add_u32 s25, s25, 59136
  s_mul_i32 s26, s3, 8704
  s_add_u32 s26, s26, 117376
  s_lshl_b32 s27, s2, 17
  s_lshl_b32 s36, s2, 10
  s_and_b32 s36, s36, 0x1e000
  s_xor_b32 s27, s27, s36
  s_mul_i32 s29, s2, 73728
  s_lshl_b32 s36, s3, 14
  s_add_u32 s28, s29, s36
  s_mul_i32 s36, s3, 15360
  s_add_u32 s41, s29, s36
  s_and_b32 s36, s3, 1
  s_lshl_b32 s36, s36, 12
  s_add_u32 s29, s29, 65536
  s_add_u32 s29, s29, s36
  s_mov_b32 s38, 0
  v_mov_b32 v34, 0x7f800000
  v_accvgpr_write_b32 a244, v34
  v_accvgpr_write_b32 a245, v34
  v_accvgpr_write_b32 a246, v34
  v_accvgpr_write_b32 a247, v34
  v_accvgpr_write_b32 a248, v34
  v_accvgpr_write_b32 a249, v34
  v_accvgpr_write_b32 a250, v34
  v_accvgpr_write_b32 a251, v34
  v_accvgpr_write_b32 a252, v34
  v_accvgpr_write_b32 a253, v34
  s_waitcnt lgkmcnt(0)
L_start:
  s_mul_i32 s37, s3, 8448
  s_add_u32 s37, s37, 25344
  s_add_u32 m0, s24, 0
  s_xor_b32 s33, s27, 0
  buffer_load_dwordx4 v2, s[12:15], s33 offen nt lds
  buffer_load_dwordx4 v3, s[12:15], s33 offen offset:1024 nt lds
  s_add_u32 m0, s24, 152192
  s_and_b32 s34, s29, 0xffffe000
  buffer_load_dwordx4 v2, s[8:11], s34 offen nt lds
  buffer_load_dwordx4 v3, s[8:11], s34 offen offset:1024 nt lds
  s_add_u32 m0, s26, 0
  s_add_u32 s34, s41, 0
  buffer_load_dwordx4 v2, s[8:11], s34 offen nt lds
  s_add_u32 m0, s26, 2112
  s_add_u32 s34, s41, 1024
  buffer_load_dwordx4 v2, s[8:11], s34 offen nt lds
  s_add_u32 m0, s26, 4224
  s_add_u32 s34, s41, 2048
  buffer_load_dwordx4 v2, s[8:11], s34 offen nt lds
  s_add_u32 m0, s26, 6336
  s_add_u32 s34, s41, 3072
  buffer_load_dwordx4 v2, s[8:11], s34 offen nt lds
  s_mov_b32 s30, 0x3e0293ee
  s_mov_b32 s31, 0xbe0293ee
  s_mov_b32 s32, 0x53800000
  s_mov_b64 s[42:43], 0
  s_lshr_b32 s39, s3, 1
  s_xor_b32 s36, s3, 2
  s_mul_i32 s40, s36, 8704
  s_add_u32 s40, s40, 121728
  v_mbcnt_lo_u32_b32 v0, -1, 0
  v_mbcnt_hi_u32_b32 v0, -1, v0
  v_lshrrev_b32 v30, 4, v0
  v_and_b32 v31, 15, v0
  v_lshlrev_b32 v17, 4, v0
  v_bfe_u32 v32, v0, 2, 2
  v_and_b32 v33, 3, v0
  v_mul_u32_u24 v34, 0x840, v32
  v_lshl_add_u32 v34, v33, 8, v34
  v_xor_b32 v35, v30, v33
  v_lshl_add_u32 v34, v35, 4, v34
  s_lshl_b32 s36, s39, 10
  v_add_u32 v6, s36, v34
  s_xor_b32 s36, s36, 0x400
  v_add_u32 v7, s36, v34
  v_add_u32 v18, s26, v34
  v_add_u32 v19, s37, v34
  s_and_b32 s36, s3, 1
  s_lshl_b32 s36, s36, 10
  s_add_u32 s36, s36, 152192
  v_add_u32 v20, s36, v34
  v_mul_u32_u24 v34, 0x820, v32
  v_and_b32 v35, 1, v32
  v_mul_u32_u24 v35, 24, v35
  v_sub_u32 v34, v34, v35
  v_and_b32 v35, 1, v30
  v_lshl_add_u32 v34, v35, 10, v34
  v_lshrrev_b32 v36, 1, v30
  v_lshl_add_u32 v34, v36, 8, v34
  v_lshl_add_u32 v34, v33, 4, v34
  v_add_u32 v34, 59136, v34
  v_xor_b32 v35, s39, v35
  v_xor_b32 v36, 1, v35
  v_lshl_add_u32 v35, v35, 7, v34
  v_lshl_add_u32 v36, v36, 7, v34
  s_lshl_b32 s36, s39, 9
  v_add_u32 v8, s36, v35
  v_add_u32 v9, s36, v36
  s_xor_b32 s36, s36, 0x200
  v_add_u32 v10, s36, v35
  v_add_u32 v11, s36, v36
  v_mul_u32_u24 v34, 0x110, v31
  v_lshl_add_u32 v34, v30, 4, v34
  v_add_u32 v34, s26, v34
  s_lshl_b32 s36, s39, 7
  v_add_u32 v14, s36, v34
  s_xor_b32 s36, s36, 0x80
  v_add_u32 v15, s36, v34
  v_mul_u32_u24 v34, 0x110, v30
  v_lshl_add_u32 v34, v31, 4, v34
  v_add_u32 v16, s26, v34
  v_mov_b32 v34, 0x3f803f80
  v_cmp_eq_u32 vcc, 0, v33
  s_nop 1
  v_cndmask_b32 v34, 0, v34, vcc
  v_accvgpr_write_b32 a240, v34
  v_accvgpr_write_b32 a241, v34
  v_accvgpr_write_b32 a242, v34
  v_accvgpr_write_b32 a243, v34
  v_mov_b32 v35, 160640
  v_mov_b32 v34, 0
  ds_write_b32 v35, v34
  s_add_u32 m0, s26, 0
  s_add_u32 s34, s41, 0
  buffer_load_dwordx4 v3, s[8:11], s34 offen offset:1024 nt lds
  s_add_u32 m0, s26, 2112
  s_add_u32 s34, s41, 1024
  buffer_load_dwordx4 v3, s[8:11], s34 offen offset:1024 nt lds
  s_add_u32 m0, s26, 4224
  s_add_u32 s34, s41, 2048
  buffer_load_dwordx4 v3, s[8:11], s34 offen offset:1024 nt lds
  s_add_u32 m0, s26, 6336
  s_add_u32 s34, s41, 3072
  buffer_load_dwordx4 v3, s[8:11], s34 offen offset:1024 nt lds
  s_add_u32 m0, s25, 0
  s_xor_b32 s33, s27, 0
  buffer_load_dwordx4 v4, s[16:19], s33 offen nt lds
  buffer_load_dwordx4 v5, s[16:19], s33 offen offset:1024 nt lds
  s_add_u32 m0, s37, 0
  s_add_u32 s34, s41, 8192
  buffer_load_dwordx4 v2, s[8:11], s34 offen nt lds
  s_add_u32 m0, s37, 2112
  s_add_u32 s34, s41, 9216
  buffer_load_dwordx4 v2, s[8:11], s34 offen nt lds
  s_add_u32 m0, s37, 4224
  s_add_u32 s34, s41, 10240
  buffer_load_dwordx4 v2, s[8:11], s34 offen nt lds
  s_add_u32 m0, s37, 6336
  s_add_u32 s34, s41, 11264
  buffer_load_dwordx4 v2, s[8:11], s34 offen nt lds
  s_add_u32 m0, s37, 0
  s_add_u32 s34, s41, 8192
  buffer_load_dwordx4 v3, s[8:11], s34 offen offset:1024 nt lds
  s_add_u32 m0, s37, 2112
  s_add_u32 s34, s41, 9216
  buffer_load_dwordx4 v3, s[8:11], s34 offen offset:1024 nt lds
  s_add_u32 m0, s37, 4224
  s_add_u32 s34, s41, 10240
  buffer_load_dwordx4 v3, s[8:11], s34 offen offset:1024 nt lds
  s_add_u32 m0, s37, 6336
  s_add_u32 s34, s41, 11264
  buffer_load_dwordx4 v3, s[8:11], s34 offen offset:1024 nt lds
  s_waitcnt vmcnt(20)
  s_waitcnt vmcnt(18)
  s_waitcnt lgkmcnt(0)
  s_barrier
  ds_read_b128 a[128:131], v20 offset:0
  ds_read_b128 a[132:135], v20 offset:64
  ds_read_b128 a[136:139], v20 offset:128
  ds_read_b128 a[140:143], v20 offset:192
  ds_read_b128 a[160:163], v6 offset:0
  ds_read_b128 a[164:167], v6 offset:64
  ds_read_b128 a[168:171], v6 offset:128
  ds_read_b128 a[172:175], v6 offset:192
  ds_read_b128 a[176:179], v7 offset:0
  ds_read_b128 a[180:183], v7 offset:64
  ds_read_b128 a[184:187], v7 offset:128
  ds_read_b128 a[188:191], v7 offset:192
  s_waitcnt lgkmcnt(7)
  v_mfma_f32_16x16x32_bf16 v[68:71], a[160:163], a[128:131], 0
  s_waitcnt lgkmcnt(6)
  v_mfma_f32_16x16x32_bf16 v[68:71], a[164:167], a[132:135], v[68:71]
  s_waitcnt vmcnt(14)
  ds_read_b128 a[0:3], v18 offset:0
  ds_read_b128 a[4:7], v18 offset:64
  ds_read_b128 a[8:11], v18 offset:128
  ds_read_b128 a[12:15], v18 offset:192
  s_waitcnt lgkmcnt(9)
  v_mfma_f32_16x16x32_bf16 v[68:71], a[168:171], a[136:139], v[68:71]
  s_add_u32 m0, s24, 8448
  s_xor_b32 s33, s27, 8192
  buffer_load_dwordx4 v2, s[12:15], s33 offen nt lds
  s_waitcnt lgkmcnt(8)
  v_mfma_f32_16x16x32_bf16 v[68:71], a[172:175], a[140:143], v[68:71]
  s_waitcnt lgkmcnt(3)
  v_mfma_f32_16x16x32_bf16 v[52:55], a[160:163], a[0:3], 0
  s_waitcnt lgkmcnt(2)
  v_mfma_f32_16x16x32_bf16 v[52:55], a[164:167], a[4:7], v[52:55]
  s_waitcnt lgkmcnt(1)
  v_mfma_f32_16x16x32_bf16 v[52:55], a[168:171], a[8:11], v[52:55]
  buffer_load_dwordx4 v3, s[12:15], s33 offen offset:1024 nt lds
  s_nop 0
  v_max3_f32 v94, v68, v69, v70
  v_max_f32 v94, v94, v71
  v_mov_b32 v95, v94
  s_nop 1
  v_permlane32_swap_b32 v94, v95
  v_max_f32 v94, v94, v95
  v_mov_b32 v95, v94
  v_accvgpr_read_b32 v27, a248
  s_nop 0
  v_permlane16_swap_b32 v94, v95
  v_max_f32 v94, v94, v95
  v_mul_f32 v94, s31, v94
  v_min_f32 v27, v27, v94
  v_fma_f32 v92, v68, s30, v27
  v_fma_f32 v93, v69, s30, v27
  v_exp_f32 v28, v92
  v_fma_f32 v92, v70, s30, v27
  v_exp_f32 v29, v93
  v_fma_f32 v93, v71, s30, v27
  v_cvt_pk_bf16_f32 v88, v28, v29
  v_exp_f32 v30, v92
  s_waitcnt lgkmcnt(0)
  v_mfma_f32_16x16x32_bf16 v[52:55], a[172:175], a[12:15], v[52:55]
  s_waitcnt vmcnt(12)
  ds_read_b128 a[16:19], v18 offset:1024
  ds_read_b128 a[20:23], v18 offset:1088
  ds_read_b128 a[24:27], v18 offset:1152
  ds_read_b128 a[28:31], v18 offset:1216
  v_mfma_f32_16x16x32_bf16 v[56:59], a[176:179], a[0:3], 0
  v_mfma_f32_16x16x32_bf16 v[56:59], a[180:183], a[4:7], v[56:59]
  v_mfma_f32_16x16x32_bf16 v[56:59], a[184:187], a[8:11], v[56:59]
  s_add_u32 m0, s25, 8320
  s_xor_b32 s33, s27, 8192
  buffer_load_dwordx4 v4, s[16:19], s33 offen nt lds
  v_mfma_f32_16x16x32_bf16 v[56:59], a[188:191], a[12:15], v[56:59]
  s_waitcnt vmcnt(11)
  s_barrier
  s_waitcnt lgkmcnt(3)
  v_mfma_f32_16x16x32_bf16 v[60:63], a[160:163], a[16:19], 0
  ds_read_b64_tr_b16 a[192:193], v8 offset:0
  ds_read_b64_tr_b16 a[198:199], v8 offset:8
  s_waitcnt lgkmcnt(4)
  v_mfma_f32_16x16x32_bf16 v[60:63], a[164:167], a[20:23], v[60:63]
  ds_read_b64_tr_b16 a[204:205], v8 offset:64
  ds_read_b64_tr_b16 a[210:211], v8 offset:72
  s_waitcnt lgkmcnt(4)
  v_mfma_f32_16x16x32_bf16 v[60:63], a[168:171], a[24:27], v[60:63]
  buffer_load_dwordx4 v5, s[16:19], s33 offen offset:1024 nt lds
  v_max3_f32 v94, v52, v53, v54
  v_max3_f32 v95, v55, v56, v57
  v_max3_f32 v94, v94, v58, v59
  v_max_f32 v94, v94, v95
  v_mov_b32 v95, v94
  v_exp_f32 v31, v93
  s_nop 0
  v_permlane32_swap_b32 v94, v95
  v_max_f32 v94, v94, v95
  v_mov_b32 v95, v94
  v_accvgpr_read_b32 v23, a244
  v_mfma_f32_16x16x32_bf16 v[60:63], a[172:175], a[28:31], v[60:63]
  v_cvt_pk_bf16_f32 v89, v30, v31
  v_permlane16_swap_b32 v94, v95
  v_max_f32 v94, v94, v95
  v_mul_f32 v94, s31, v94
  v_min_f32 v23, v23, v94
  v_fma_f32 v92, v52, s30, v23
  v_fma_f32 v93, v53, s30, v23
  v_exp_f32 v28, v92
  v_fma_f32 v92, v54, s30, v23
  v_exp_f32 v29, v93
  v_fma_f32 v93, v55, s30, v23
  v_cvt_pk_bf16_f32 v72, v28, v29
  v_exp_f32 v30, v92
  v_fma_f32 v92, v56, s30, v23
  v_exp_f32 v31, v93
  v_fma_f32 v93, v57, s30, v23
  v_cvt_pk_bf16_f32 v73, v30, v31
  v_exp_f32 v28, v92
  s_waitcnt vmcnt(8)
  ds_read_b128 a[32:35], v19 offset:0
  ds_read_b128 a[36:39], v19 offset:64
  ds_read_b128 a[40:43], v19 offset:128
  ds_read_b128 a[44:47], v19 offset:192
  v_mfma_f32_16x16x32_bf16 v[64:67], a[176:179], a[16:19], 0
  v_fma_f32 v92, v58, s30, v23
  v_exp_f32 v29, v93
  v_mfma_f32_16x16x32_bf16 v[64:67], a[180:183], a[20:23], v[64:67]
  v_fma_f32 v93, v59, s30, v23
  v_cvt_pk_bf16_f32 v74, v28, v29
  v_mfma_f32_16x16x32_bf16 v[64:67], a[184:187], a[24:27], v[64:67]
  s_add_u32 m0, s24, 16896
  s_xor_b32 s33, s27, 16384
  buffer_load_dwordx4 v2, s[12:15], s33 offen nt lds
  v_exp_f32 v30, v92
  v_mfma_f32_16x16x32_bf16 v[64:67], a[188:191], a[28:31], v[64:67]
  ds_read_b64_tr_b16 a[216:217], v9 offset:0
  ds_read_b64_tr_b16 a[222:223], v9 offset:8
  s_waitcnt lgkmcnt(5)
  v_mfma_f32_16x16x32_bf16 v[52:55], a[160:163], a[32:35], 0
  ds_read_b64_tr_b16 a[228:229], v9 offset:64
  ds_read_b64_tr_b16 a[234:235], v9 offset:72
  s_waitcnt lgkmcnt(6)
  v_mfma_f32_16x16x32_bf16 v[52:55], a[164:167], a[36:39], v[52:55]
  ds_read_b64_tr_b16 a[194:195], v10 offset:0
  ds_read_b64_tr_b16 a[200:201], v10 offset:8
  s_waitcnt lgkmcnt(6)
  v_mfma_f32_16x16x32_bf16 v[52:55], a[168:171], a[40:43], v[52:55]
  buffer_load_dwordx4 v3, s[12:15], s33 offen offset:1024 nt lds
  v_max3_f32 v94, v60, v61, v62
  v_max3_f32 v95, v63, v64, v65
  v_max3_f32 v94, v94, v66, v67
  v_max_f32 v94, v94, v95
  v_mov_b32 v95, v94
  v_exp_f32 v31, v93
  s_nop 0
  v_permlane32_swap_b32 v94, v95
  v_max_f32 v94, v94, v95
  v_mov_b32 v95, v94
  v_accvgpr_read_b32 v24, a245
  v_mfma_f32_16x16x32_bf16 v[52:55], a[172:175], a[44:47], v[52:55]
  v_cvt_pk_bf16_f32 v75, v30, v31
  v_permlane16_swap_b32 v94, v95
  v_mfma_f32_16x16x32_bf16 v[56:59], a[176:179], a[32:35], 0
  ds_read_b64_tr_b16 a[206:207], v10 offset:64
  v_max_f32 v94, v94, v95
  v_mul_f32 v94, s31, v94
  v_min_f32 v24, v24, v94
  v_mfma_f32_16x16x32_bf16 v[56:59], a[180:183], a[36:39], v[56:59]
  ds_read_b64_tr_b16 a[212:213], v10 offset:72
  v_fma_f32 v92, v60, s30, v24
  v_fma_f32 v93, v61, s30, v24
  v_mfma_f32_16x16x32_bf16 v[56:59], a[184:187], a[40:43], v[56:59]
  s_add_u32 m0, s25, 16640
  s_xor_b32 s33, s27, 16384
  ds_read_b64_tr_b16 a[218:219], v11 offset:0
  buffer_load_dwordx4 v4, s[16:19], s33 offen nt lds
  v_exp_f32 v28, v92
  v_fma_f32 v92, v62, s30, v24
  v_mfma_f32_16x16x32_bf16 v[56:59], a[188:191], a[44:47], v[56:59]
  ds_read_b64_tr_b16 a[224:225], v11 offset:8
  v_exp_f32 v29, v93
  v_mfma_f32_16x16x32_bf16 v[32:35], a[240:243], v[72:75], 0
  ds_read_b64_tr_b16 a[230:231], v11 offset:64
  v_fma_f32 v93, v63, s30, v24
  v_cvt_pk_bf16_f32 v76, v28, v29
  s_waitcnt lgkmcnt(5)
  v_mfma_f32_16x16x32_bf16 v[96:99], a[192:195], v[72:75], 0
  ds_read_b64_tr_b16 a[236:237], v11 offset:72
  v_exp_f32 v30, v92
  v_fma_f32 v92, v64, s30, v24
  v_mfma_f32_16x16x32_bf16 v[100:103], a[198:201], v[72:75], 0
  buffer_load_dwordx4 v5, s[16:19], s33 offen offset:1024 nt lds
  v_exp_f32 v31, v93
  v_fma_f32 v93, v65, s30, v24
  s_waitcnt lgkmcnt(5)
  v_mfma_f32_16x16x32_bf16 v[104:107], a[204:207], v[72:75], 0
  v_cvt_pk_bf16_f32 v77, v30, v31
  v_exp_f32 v28, v92
  s_waitcnt lgkmcnt(4)
  v_mfma_f32_16x16x32_bf16 v[108:111], a[210:213], v[72:75], 0
  v_fma_f32 v92, v66, s30, v24
  v_exp_f32 v29, v93
  s_waitcnt vmcnt(8)
  ds_read_b128 a[48:51], v19 offset:1024
  ds_read_b128 a[52:55], v19 offset:1088
  ds_read_b128 a[56:59], v19 offset:1152
  ds_read_b128 a[60:63], v19 offset:1216
  s_waitcnt lgkmcnt(7)
  v_mfma_f32_16x16x32_bf16 v[112:115], a[216:219], v[72:75], 0
  v_fma_f32 v93, v67, s30, v24
  v_cvt_pk_bf16_f32 v78, v28, v29
  s_waitcnt lgkmcnt(6)
  v_mfma_f32_16x16x32_bf16 v[116:119], a[222:225], v[72:75], 0
  v_exp_f32 v30, v92
  s_waitcnt lgkmcnt(5)
  v_mfma_f32_16x16x32_bf16 v[120:123], a[228:231], v[72:75], 0
  v_max3_f32 v94, v52, v53, v54
  v_max3_f32 v95, v55, v56, v57
  s_waitcnt lgkmcnt(4)
  v_mfma_f32_16x16x32_bf16 v[124:127], a[234:237], v[72:75], 0
  v_max3_f32 v94, v94, v58, v59
  v_max_f32 v94, v94, v95
  v_mov_b32 v95, v94
  s_waitcnt vmcnt(4)
  s_waitcnt lgkmcnt(0)
  s_barrier
  v_mfma_f32_16x16x32_bf16 v[60:63], a[160:163], a[48:51], 0
  v_exp_f32 v31, v93
  v_mfma_f32_16x16x32_bf16 v[60:63], a[164:167], a[52:55], v[60:63]
  v_permlane32_swap_b32 v94, v95
  v_max_f32 v94, v94, v95
  v_mov_b32 v95, v94
  v_mfma_f32_16x16x32_bf16 v[60:63], a[168:171], a[56:59], v[60:63]
  v_accvgpr_read_b32 v25, a246
  v_cvt_pk_bf16_f32 v79, v30, v31
  v_mfma_f32_16x16x32_bf16 v[60:63], a[172:175], a[60:63], v[60:63]
  v_permlane16_swap_b32 v94, v95
  v_max_f32 v94, v94, v95
  v_mul_f32 v94, s31, v94
  v_mfma_f32_16x16x32_bf16 v[64:67], a[176:179], a[48:51], 0
  v_min_f32 v25, v25, v94
  v_fma_f32 v92, v52, s30, v25
  v_mfma_f32_16x16x32_bf16 v[64:67], a[180:183], a[52:55], v[64:67]
  v_fma_f32 v93, v53, s30, v25
  v_exp_f32 v28, v92
  v_mfma_f32_16x16x32_bf16 v[64:67], a[184:187], a[56:59], v[64:67]
  ds_read_b128 a[160:163], v6 offset:8448
  v_fma_f32 v92, v54, s30, v25
  v_mfma_f32_16x16x32_bf16 v[64:67], a[188:191], a[60:63], v[64:67]
  v_exp_f32 v29, v93
  v_fma_f32 v93, v55, s30, v25
  v_cvt_pk_bf16_f32 v80, v28, v29
  v_mfma_f32_16x16x32_bf16 v[36:39], a[240:243], v[76:79], 0
  v_exp_f32 v30, v92
  v_mfma_f32_16x16x32_bf16 v[128:131], a[192:195], v[76:79], 0
  v_fma_f32 v92, v56, s30, v25
  v_exp_f32 v31, v93
  v_mfma_f32_16x16x32_bf16 v[132:135], a[198:201], v[76:79], 0
  v_fma_f32 v93, v57, s30, v25
  v_cvt_pk_bf16_f32 v81, v30, v31
  v_mfma_f32_16x16x32_bf16 v[136:139], a[204:207], v[76:79], 0
  ds_read_b128 a[164:167], v6 offset:8512
  v_exp_f32 v28, v92
  v_fma_f32 v92, v58, s30, v25
  v_mfma_f32_16x16x32_bf16 v[140:143], a[210:213], v[76:79], 0
  s_add_u32 s34, s29, 18874368
  ds_read_b128 a[168:171], v6 offset:8576
  buffer_load_dwordx4 a[144:147], v12, s[8:11], s34 offen offset:0 nt
  buffer_load_dwordx4 a[148:151], v12, s[8:11], s34 offen offset:64 nt
  v_exp_f32 v29, v93
  v_mfma_f32_16x16x32_bf16 v[144:147], a[216:219], v[76:79], 0
  ds_read_b128 a[172:175], v6 offset:8640
  v_fma_f32 v93, v59, s30, v25
  v_cvt_pk_bf16_f32 v82, v28, v29
  v_mfma_f32_16x16x32_bf16 v[148:151], a[222:225], v[76:79], 0
  v_exp_f32 v30, v92
  v_max3_f32 v94, v60, v61, v62
  v_mfma_f32_16x16x32_bf16 v[152:155], a[228:231], v[76:79], 0
  v_max3_f32 v95, v63, v64, v65
  v_max3_f32 v94, v94, v66, v67
  v_max_f32 v94, v94, v95
  v_mfma_f32_16x16x32_bf16 v[156:159], a[234:237], v[76:79], 0
  ds_read_b128 a[176:179], v7 offset:8448
  v_mov_b32 v95, v94
  s_waitcnt lgkmcnt(4)
  v_mfma_f32_16x16x32_bf16 v[68:71], a[160:163], a[128:131], 0
  v_exp_f32 v31, v93
  v_permlane32_swap_b32 v94, v95
  v_max_f32 v94, v94, v95
  s_waitcnt lgkmcnt(3)
  v_mfma_f32_16x16x32_bf16 v[68:71], a[164:167], a[132:135], v[68:71]
  v_mov_b32 v95, v94
  v_accvgpr_read_b32 v26, a247
  v_cvt_pk_bf16_f32 v83, v30, v31
  s_waitcnt lgkmcnt(2)
  v_mfma_f32_16x16x32_bf16 v[68:71], a[168:171], a[136:139], v[68:71]
  v_permlane16_swap_b32 v94, v95
  v_max_f32 v94, v94, v95
  s_waitcnt lgkmcnt(1)
  v_mfma_f32_16x16x32_bf16 v[68:71], a[172:175], a[140:143], v[68:71]
  v_mul_f32 v94, s31, v94
  v_min_f32 v26, v26, v94
  v_mfma_f32_16x16x32_bf16 v[40:43], a[240:243], v[80:83], 0
  v_fma_f32 v92, v60, s30, v26
  v_fma_f32 v93, v61, s30, v26
  v_mfma_f32_16x16x32_bf16 v[160:163], a[192:195], v[80:83], 0
  v_exp_f32 v28, v92
  v_mfma_f32_16x16x32_bf16 v[164:167], a[198:201], v[80:83], 0
  ds_read_b128 a[180:183], v7 offset:8512
  v_fma_f32 v92, v62, s30, v26
  v_mfma_f32_16x16x32_bf16 v[168:171], a[204:207], v[80:83], 0
  v_exp_f32 v29, v93
  v_mfma_f32_16x16x32_bf16 v[172:175], a[210:213], v[80:83], 0
  v_fma_f32 v93, v63, s30, v26
  v_cvt_pk_bf16_f32 v84, v28, v29
  v_mfma_f32_16x16x32_bf16 v[176:179], a[216:219], v[80:83], 0
  v_exp_f32 v30, v92
  v_mfma_f32_16x16x32_bf16 v[180:183], a[222:225], v[80:83], 0
  ds_read_b128 a[184:187], v7 offset:8576
  v_fma_f32 v92, v64, s30, v26
  v_mfma_f32_16x16x32_bf16 v[184:187], a[228:231], v[80:83], 0
  v_exp_f32 v31, v93
  v_mfma_f32_16x16x32_bf16 v[188:191], a[234:237], v[80:83], 0
  v_fma_f32 v93, v65, s30, v26
  v_cvt_pk_bf16_f32 v85, v30, v31
  v_mfma_f32_16x16x32_bf16 v[52:55], a[160:163], a[0:3], 0
  ds_read_b128 a[188:191], v7 offset:8640
  v_exp_f32 v28, v92
  v_mfma_f32_16x16x32_bf16 v[52:55], a[164:167], a[4:7], v[52:55]
  ds_read_b64_tr_b16 a[196:197], v10 offset:8320
  v_fma_f32 v92, v66, s30, v26
  v_mfma_f32_16x16x32_bf16 v[52:55], a[168:171], a[8:11], v[52:55]
  v_exp_f32 v29, v93
  v_fma_f32 v93, v67, s30, v26
  v_cvt_pk_bf16_f32 v86, v28, v29
  v_mfma_f32_16x16x32_bf16 v[52:55], a[172:175], a[12:15], v[52:55]
  v_exp_f32 v30, v92
  s_waitcnt lgkmcnt(2)
  v_mfma_f32_16x16x32_bf16 v[56:59], a[176:179], a[0:3], 0
  v_fma_f32 v92, v68, s30, v27
  v_exp_f32 v31, v93
  v_mfma_f32_16x16x32_bf16 v[56:59], a[180:183], a[4:7], v[56:59]
  ds_read_b64_tr_b16 a[202:203], v10 offset:8328
  v_cvt_pk_bf16_f32 v87, v30, v31
  v_mfma_f32_16x16x32_bf16 v[56:59], a[184:187], a[8:11], v[56:59]
  ds_read_b64_tr_b16 a[208:209], v10 offset:8384
  v_fma_f32 v93, v69, s30, v27
  s_waitcnt lgkmcnt(3)
  v_mfma_f32_16x16x32_bf16 v[56:59], a[188:191], a[12:15], v[56:59]
  ds_read_b64_tr_b16 a[214:215], v10 offset:8392
  ds_read_b64_tr_b16 a[220:221], v11 offset:8320
  v_mfma_f32_16x16x32_bf16 v[44:47], a[240:243], v[84:87], 0
  v_exp_f32 v28, v92
  v_mfma_f32_16x16x32_bf16 v[192:195], a[192:195], v[84:87], 0
  ds_read_b64_tr_b16 a[226:227], v11 offset:8328
  v_fma_f32 v92, v70, s30, v27
  v_mfma_f32_16x16x32_bf16 v[196:199], a[198:201], v[84:87], 0
  ds_read_b64_tr_b16 a[232:233], v11 offset:8384
  ds_read_b64_tr_b16 a[238:239], v11 offset:8392
  v_mfma_f32_16x16x32_bf16 v[200:203], a[204:207], v[84:87], 0
  v_exp_f32 v29, v93
  v_mfma_f32_16x16x32_bf16 v[204:207], a[210:213], v[84:87], 0
  ds_read_b64_tr_b16 a[194:195], v8 offset:8320
  v_fma_f32 v93, v71, s30, v27
  v_mfma_f32_16x16x32_bf16 v[208:211], a[216:219], v[84:87], 0
  ds_read_b64_tr_b16 a[200:201], v8 offset:8328
  v_cvt_pk_bf16_f32 v90, v28, v29
  v_mfma_f32_16x16x32_bf16 v[212:215], a[222:225], v[84:87], 0
  v_exp_f32 v30, v92
  v_mfma_f32_16x16x32_bf16 v[216:219], a[228:231], v[84:87], 0
  ds_read_b64_tr_b16 a[206:207], v8 offset:8384
  v_fma_f32 v92, v52, s30, v23
  v_mfma_f32_16x16x32_bf16 v[220:223], a[234:237], v[84:87], 0
  v_exp_f32 v31, v93
  v_mfma_f32_16x16x32_bf16 v[60:63], a[160:163], a[16:19], 0
  ds_read_b64_tr_b16 a[212:213], v8 offset:8392
  v_cvt_pk_bf16_f32 v91, v30, v31
  v_mfma_f32_16x16x32_bf16 v[60:63], a[164:167], a[20:23], v[60:63]
  ds_read_b64_tr_b16 a[218:219], v9 offset:8320
  ds_read_b64_tr_b16 a[224:225], v9 offset:8328
  v_mfma_f32_16x16x32_bf16 v[60:63], a[168:171], a[24:27], v[60:63]
  ds_read_b64_tr_b16 a[230:231], v9 offset:8384
  ds_read_b64_tr_b16 a[236:237], v9 offset:8392
  v_mfma_f32_16x16x32_bf16 v[60:63], a[172:175], a[28:31], v[60:63]
  s_add_u32 m0, s24, 25344
  v_fma_f32 v93, v53, s30, v23
  v_mfma_f32_16x16x32_bf16 v[64:67], a[176:179], a[16:19], 0
  v_exp_f32 v28, v92
  v_mfma_f32_16x16x32_bf16 v[64:67], a[180:183], a[20:23], v[64:67]
  s_xor_b32 s33, s27, 24576
  v_fma_f32 v92, v54, s30, v23
  v_mfma_f32_16x16x32_bf16 v[64:67], a[184:187], a[24:27], v[64:67]
  v_exp_f32 v29, v93
  v_mfma_f32_16x16x32_bf16 v[64:67], a[188:191], a[28:31], v[64:67]
  v_fma_f32 v93, v55, s30, v23
  v_cvt_pk_bf16_f32 v72, v28, v29
  v_mfma_f32_16x16x32_bf16 v[48:51], a[240:243], v[88:91], 0
  buffer_load_dwordx4 a[152:155], v12, s[8:11], s34 offen offset:128 nt
  buffer_load_dwordx4 a[156:159], v12, s[8:11], s34 offen offset:192 nt
  s_waitcnt lgkmcnt(0)
  v_mfma_f32_16x16x32_bf16 v[224:227], a[192:195], v[88:91], 0
  v_exp_f32 v30, v92
  v_mfma_f32_16x16x32_bf16 v[228:231], a[198:201], v[88:91], 0
  buffer_load_dwordx4 v2, s[12:15], s33 offen nt lds
  v_fma_f32 v92, v56, s30, v23
  v_mfma_f32_16x16x32_bf16 v[232:235], a[204:207], v[88:91], 0
  v_exp_f32 v31, v93
  v_mfma_f32_16x16x32_bf16 v[236:239], a[210:213], v[88:91], 0
  v_fma_f32 v93, v57, s30, v23
  v_cvt_pk_bf16_f32 v73, v30, v31
  v_mfma_f32_16x16x32_bf16 v[240:243], a[216:219], v[88:91], 0
  v_exp_f32 v28, v92
  v_mfma_f32_16x16x32_bf16 v[244:247], a[222:225], v[88:91], 0
  buffer_load_dwordx4 v3, s[12:15], s33 offen offset:1024 nt lds
  v_fma_f32 v92, v58, s30, v23
  v_mfma_f32_16x16x32_bf16 v[248:251], a[228:231], v[88:91], 0
  v_exp_f32 v29, v93
  v_mfma_f32_16x16x32_bf16 v[252:255], a[234:237], v[88:91], 0
  v_fma_f32 v93, v59, s30, v23
  v_cvt_pk_bf16_f32 v74, v28, v29
  v_mfma_f32_16x16x32_bf16 v[52:55], a[160:163], a[32:35], 0
  v_exp_f32 v30, v92
  v_mfma_f32_16x16x32_bf16 v[52:55], a[164:167], a[36:39], v[52:55]
  s_add_u32 m0, s25, 24960
  v_fma_f32 v92, v60, s30, v24
  v_mfma_f32_16x16x32_bf16 v[52:55], a[168:171], a[40:43], v[52:55]
  v_exp_f32 v31, v93
  v_mfma_f32_16x16x32_bf16 v[52:55], a[172:175], a[44:47], v[52:55]
  v_cvt_pk_bf16_f32 v75, v30, v31
  v_fma_f32 v93, v61, s30, v24
  v_mfma_f32_16x16x32_bf16 v[56:59], a[176:179], a[32:35], 0
  v_exp_f32 v28, v92
  v_mfma_f32_16x16x32_bf16 v[56:59], a[180:183], a[36:39], v[56:59]
  buffer_load_dwordx4 v4, s[16:19], s33 offen nt lds
  v_fma_f32 v92, v62, s30, v24
  v_mfma_f32_16x16x32_bf16 v[56:59], a[184:187], a[40:43], v[56:59]
  buffer_load_dwordx4 v5, s[16:19], s33 offen offset:1024 nt lds
  s_add_u32 m0, s24, 33792
  v_mfma_f32_16x16x32_bf16 v[56:59], a[188:191], a[44:47], v[56:59]
  v_exp_f32 v29, v93
  v_mfma_f32_16x16x32_bf16 v[32:35], a[240:243], v[72:75], v[32:35]
  s_xor_b32 s33, s27, 32768
  v_fma_f32 v93, v63, s30, v24
  v_mfma_f32_16x16x32_bf16 v[96:99], a[194:197], v[72:75], v[96:99]
  buffer_load_dwordx4 v2, s[12:15], s33 offen nt lds
  v_cvt_pk_bf16_f32 v76, v28, v29
  v_mfma_f32_16x16x32_bf16 v[100:103], a[200:203], v[72:75], v[100:103]
  buffer_load_dwordx4 v3, s[12:15], s33 offen offset:1024 nt lds
  s_add_u32 m0, s25, 33280
  v_mfma_f32_16x16x32_bf16 v[104:107], a[206:209], v[72:75], v[104:107]
  v_exp_f32 v30, v92
  v_mfma_f32_16x16x32_bf16 v[108:111], a[212:215], v[72:75], v[108:111]
  buffer_load_dwordx4 v4, s[16:19], s33 offen nt lds
  v_fma_f32 v92, v64, s30, v24
  v_mfma_f32_16x16x32_bf16 v[112:115], a[218:221], v[72:75], v[112:115]
  buffer_load_dwordx4 v5, s[16:19], s33 offen offset:1024 nt lds
  v_exp_f32 v31, v93
  v_mfma_f32_16x16x32_bf16 v[116:119], a[224:227], v[72:75], v[116:119]
  v_fma_f32 v93, v65, s30, v24
  v_cvt_pk_bf16_f32 v77, v30, v31
  v_mfma_f32_16x16x32_bf16 v[120:123], a[230:233], v[72:75], v[120:123]
  v_exp_f32 v28, v92
  v_mfma_f32_16x16x32_bf16 v[124:127], a[236:239], v[72:75], v[124:127]
  v_fma_f32 v92, v66, s30, v24
  v_exp_f32 v29, v93
  s_waitcnt vmcnt(12)
  s_barrier
  v_mfma_f32_16x16x32_bf16 v[60:63], a[160:163], a[48:51], 0
  v_fma_f32 v93, v67, s30, v24
  v_cvt_pk_bf16_f32 v78, v28, v29
  v_mfma_f32_16x16x32_bf16 v[60:63], a[164:167], a[52:55], v[60:63]
  v_exp_f32 v30, v92
  v_mfma_f32_16x16x32_bf16 v[60:63], a[168:171], a[56:59], v[60:63]
  ds_read_b128 a[160:163], v6 offset:16896
  v_fma_f32 v92, v52, s30, v25
  v_mfma_f32_16x16x32_bf16 v[60:63], a[172:175], a[60:63], v[60:63]
  v_exp_f32 v31, v93
  v_mfma_f32_16x16x32_bf16 v[64:67], a[176:179], a[48:51], 0
  v_cvt_pk_bf16_f32 v79, v30, v31
  v_fma_f32 v93, v53, s30, v25
  v_mfma_f32_16x16x32_bf16 v[64:67], a[180:183], a[52:55], v[64:67]
  v_exp_f32 v28, v92
  v_mfma_f32_16x16x32_bf16 v[64:67], a[184:187], a[56:59], v[64:67]
  ds_read_b128 a[164:167], v6 offset:16960
  v_fma_f32 v92, v54, s30, v25
  v_mfma_f32_16x16x32_bf16 v[64:67], a[188:191], a[60:63], v[64:67]
  v_exp_f32 v29, v93
  v_mfma_f32_16x16x32_bf16 v[36:39], a[240:243], v[76:79], v[36:39]
  v_fma_f32 v93, v55, s30, v25
  v_cvt_pk_bf16_f32 v80, v28, v29
  v_mfma_f32_16x16x32_bf16 v[128:131], a[194:197], v[76:79], v[128:131]
  v_exp_f32 v30, v92
  v_mfma_f32_16x16x32_bf16 v[132:135], a[200:203], v[76:79], v[132:135]
  ds_read_b128 a[168:171], v6 offset:17024
  v_fma_f32 v92, v56, s30, v25
  v_mfma_f32_16x16x32_bf16 v[136:139], a[206:209], v[76:79], v[136:139]
  v_exp_f32 v31, v93
  v_mfma_f32_16x16x32_bf16 v[140:143], a[212:215], v[76:79], v[140:143]
  v_fma_f32 v93, v57, s30, v25
  v_cvt_pk_bf16_f32 v81, v30, v31
  v_mfma_f32_16x16x32_bf16 v[144:147], a[218:221], v[76:79], v[144:147]
  ds_read_b128 a[172:175], v6 offset:17088
  v_exp_f32 v28, v92
  v_mfma_f32_16x16x32_bf16 v[148:151], a[224:227], v[76:79], v[148:151]
  s_add_u32 s34, s28, 18874368
  v_fma_f32 v92, v58, s30, v25
  v_mfma_f32_16x16x32_bf16 v[152:155], a[230:233], v[76:79], v[152:155]
  v_exp_f32 v29, v93
  v_fma_f32 v93, v59, s30, v25
  v_cvt_pk_bf16_f32 v82, v28, v29
  v_mfma_f32_16x16x32_bf16 v[156:159], a[236:239], v[76:79], v[156:159]
  v_exp_f32 v30, v92
  s_waitcnt lgkmcnt(1)
  v_mfma_f32_16x16x32_bf16 v[68:71], a[160:163], a[128:131], 0
  v_fma_f32 v92, v60, s30, v26
  v_exp_f32 v31, v93
  v_mfma_f32_16x16x32_bf16 v[68:71], a[164:167], a[132:135], v[68:71]
  v_cvt_pk_bf16_f32 v83, v30, v31
  v_fma_f32 v93, v61, s30, v26
  v_mfma_f32_16x16x32_bf16 v[68:71], a[168:171], a[136:139], v[68:71]
  v_exp_f32 v28, v92
  s_waitcnt lgkmcnt(0)
  v_mfma_f32_16x16x32_bf16 v[68:71], a[172:175], a[140:143], v[68:71]
  ds_read_b128 a[176:179], v7 offset:16896
  v_fma_f32 v92, v62, s30, v26
  v_mfma_f32_16x16x32_bf16 v[40:43], a[240:243], v[80:83], v[40:43]
  v_exp_f32 v29, v93
  v_mfma_f32_16x16x32_bf16 v[160:163], a[194:197], v[80:83], v[160:163]
  v_fma_f32 v93, v63, s30, v26
  v_cvt_pk_bf16_f32 v84, v28, v29
  v_mfma_f32_16x16x32_bf16 v[164:167], a[200:203], v[80:83], v[164:167]
  buffer_load_dwordx4 a[64:67], v12, s[8:11], s34 offen offset:0 nt
  buffer_load_dwordx4 a[68:71], v12, s[8:11], s34 offen offset:64 nt
  v_mfma_f32_16x16x32_bf16 v[168:171], a[206:209], v[80:83], v[168:171]
  v_exp_f32 v30, v92
  v_mfma_f32_16x16x32_bf16 v[172:175], a[212:215], v[80:83], v[172:175]
  ds_read_b128 a[180:183], v7 offset:16960
  v_fma_f32 v92, v64, s30, v26
  v_mfma_f32_16x16x32_bf16 v[176:179], a[218:221], v[80:83], v[176:179]
  v_exp_f32 v31, v93
  v_mfma_f32_16x16x32_bf16 v[180:183], a[224:227], v[80:83], v[180:183]
  ds_read_b128 a[184:187], v7 offset:17024
  v_fma_f32 v93, v65, s30, v26
  v_mfma_f32_16x16x32_bf16 v[184:187], a[230:233], v[80:83], v[184:187]
  ds_read_b128 a[188:191], v7 offset:17088
  v_cvt_pk_bf16_f32 v85, v30, v31
  v_mfma_f32_16x16x32_bf16 v[188:191], a[236:239], v[80:83], v[188:191]
  v_exp_f32 v28, v92
  v_mfma_f32_16x16x32_bf16 v[52:55], a[160:163], a[0:3], 0
  ds_read_b64_tr_b16 a[192:193], v8 offset:16640
  v_fma_f32 v92, v66, s30, v26
  v_mfma_f32_16x16x32_bf16 v[52:55], a[164:167], a[4:7], v[52:55]
  v_exp_f32 v29, v93
  v_mfma_f32_16x16x32_bf16 v[52:55], a[168:171], a[8:11], v[52:55]
  v_fma_f32 v93, v67, s30, v26
  v_cvt_pk_bf16_f32 v86, v28, v29
  v_mfma_f32_16x16x32_bf16 v[52:55], a[172:175], a[12:15], v[52:55]
  v_exp_f32 v30, v92
  s_waitcnt lgkmcnt(2)
  v_mfma_f32_16x16x32_bf16 v[56:59], a[176:179], a[0:3], 0
  v_fma_f32 v92, v68, s30, v27
  v_exp_f32 v31, v93
  v_mfma_f32_16x16x32_bf16 v[56:59], a[180:183], a[4:7], v[56:59]
  v_cvt_pk_bf16_f32 v87, v30, v31
  v_fma_f32 v93, v69, s30, v27
  v_mfma_f32_16x16x32_bf16 v[56:59], a[184:187], a[8:11], v[56:59]
  v_exp_f32 v28, v92
  s_waitcnt lgkmcnt(0)
  v_mfma_f32_16x16x32_bf16 v[56:59], a[188:191], a[12:15], v[56:59]
  ds_read_b64_tr_b16 a[198:199], v8 offset:16648
  v_fma_f32 v92, v70, s30, v27
  v_mfma_f32_16x16x32_bf16 v[44:47], a[240:243], v[84:87], v[44:47]
  v_exp_f32 v29, v93
  v_mfma_f32_16x16x32_bf16 v[192:195], a[194:197], v[84:87], v[192:195]
  v_fma_f32 v93, v71, s30, v27
  v_cvt_pk_bf16_f32 v88, v28, v29
  v_mfma_f32_16x16x32_bf16 v[196:199], a[200:203], v[84:87], v[196:199]
  v_exp_f32 v30, v92
  v_mfma_f32_16x16x32_bf16 v[200:203], a[206:209], v[84:87], v[200:203]
  ds_read_b64_tr_b16 a[204:205], v8 offset:16704
  v_fma_f32 v92, v52, s30, v23
  v_mfma_f32_16x16x32_bf16 v[204:207], a[212:215], v[84:87], v[204:207]
  v_exp_f32 v31, v93
  v_mfma_f32_16x16x32_bf16 v[208:211], a[218:221], v[84:87], v[208:211]
  v_cvt_pk_bf16_f32 v89, v30, v31
  v_fma_f32 v93, v53, s30, v23
  v_mfma_f32_16x16x32_bf16 v[212:215], a[224:227], v[84:87], v[212:215]
  v_exp_f32 v28, v92
  v_mfma_f32_16x16x32_bf16 v[216:219], a[230:233], v[84:87], v[216:219]
  ds_read_b64_tr_b16 a[210:211], v8 offset:16712
  v_fma_f32 v92, v54, s30, v23
  v_mfma_f32_16x16x32_bf16 v[220:223], a[236:239], v[84:87], v[220:223]
  v_exp_f32 v29, v93
  v_mfma_f32_16x16x32_bf16 v[60:63], a[160:163], a[16:19], 0
  v_fma_f32 v93, v55, s30, v23
  v_cvt_pk_bf16_f32 v72, v28, v29
  v_mfma_f32_16x16x32_bf16 v[60:63], a[164:167], a[20:23], v[60:63]
  v_exp_f32 v30, v92
  v_mfma_f32_16x16x32_bf16 v[60:63], a[168:171], a[24:27], v[60:63]
  ds_read_b64_tr_b16 a[216:217], v9 offset:16640
  v_fma_f32 v92, v56, s30, v23
  v_mfma_f32_16x16x32_bf16 v[60:63], a[172:175], a[28:31], v[60:63]
  v_exp_f32 v31, v93
  v_mfma_f32_16x16x32_bf16 v[64:67], a[176:179], a[16:19], 0
  v_fma_f32 v93, v57, s30, v23
  v_cvt_pk_bf16_f32 v73, v30, v31
  v_mfma_f32_16x16x32_bf16 v[64:67], a[180:183], a[20:23], v[64:67]
  v_exp_f32 v28, v92
  v_mfma_f32_16x16x32_bf16 v[64:67], a[184:187], a[24:27], v[64:67]
  ds_read_b64_tr_b16 a[222:223], v9 offset:16648
  v_fma_f32 v92, v58, s30, v23
  v_mfma_f32_16x16x32_bf16 v[64:67], a[188:191], a[28:31], v[64:67]
  v_exp_f32 v29, v93
  v_mfma_f32_16x16x32_bf16 v[52:55], a[160:163], a[32:35], 0
  ds_read_b64_tr_b16 a[228:229], v9 offset:16704
  v_fma_f32 v93, v59, s30, v23
  v_mfma_f32_16x16x32_bf16 v[52:55], a[164:167], a[36:39], v[52:55]
  ds_read_b64_tr_b16 a[234:235], v9 offset:16712
  v_cvt_pk_bf16_f32 v74, v28, v29
  v_mfma_f32_16x16x32_bf16 v[52:55], a[168:171], a[40:43], v[52:55]
  ds_read_b64_tr_b16 a[194:195], v10 offset:16640
  ds_read_b64_tr_b16 a[200:201], v10 offset:16648
  v_mfma_f32_16x16x32_bf16 v[52:55], a[172:175], a[44:47], v[52:55]
  v_exp_f32 v30, v92
  v_mfma_f32_16x16x32_bf16 v[56:59], a[176:179], a[32:35], 0
  ds_read_b64_tr_b16 a[206:207], v10 offset:16704
  v_fma_f32 v92, v60, s30, v24
  v_exp_f32 v31, v93
  v_mfma_f32_16x16x32_bf16 v[56:59], a[180:183], a[36:39], v[56:59]
  ds_read_b64_tr_b16 a[212:213], v10 offset:16712
  v_cvt_pk_bf16_f32 v75, v30, v31
  v_mfma_f32_16x16x32_bf16 v[56:59], a[184:187], a[40:43], v[56:59]
  ds_read_b64_tr_b16 a[218:219], v11 offset:16640
  ds_read_b64_tr_b16 a[224:225], v11 offset:16648
  v_mfma_f32_16x16x32_bf16 v[56:59], a[188:191], a[44:47], v[56:59]
  ds_read_b64_tr_b16 a[230:231], v11 offset:16704
  ds_read_b64_tr_b16 a[236:237], v11 offset:16712
  v_mfma_f32_16x16x32_bf16 v[32:35], a[240:243], v[72:75], v[32:35]
  s_add_u32 m0, s24, 42240
  v_fma_f32 v93, v61, s30, v24
  s_waitcnt lgkmcnt(6)
  v_mfma_f32_16x16x32_bf16 v[96:99], a[192:195], v[72:75], v[96:99]
  v_exp_f32 v28, v92
  v_mfma_f32_16x16x32_bf16 v[100:103], a[198:201], v[72:75], v[100:103]
  s_xor_b32 s33, s27, 40960
  v_fma_f32 v92, v62, s30, v24
  s_waitcnt lgkmcnt(5)
  v_mfma_f32_16x16x32_bf16 v[104:107], a[204:207], v[72:75], v[104:107]
  v_exp_f32 v29, v93
  s_waitcnt lgkmcnt(4)
  v_mfma_f32_16x16x32_bf16 v[108:111], a[210:213], v[72:75], v[108:111]
  v_fma_f32 v93, v63, s30, v24
  v_cvt_pk_bf16_f32 v76, v28, v29
  s_waitcnt lgkmcnt(2)
  v_mfma_f32_16x16x32_bf16 v[112:115], a[216:219], v[72:75], v[112:115]
  buffer_load_dwordx4 v2, s[12:15], s33 offen nt lds
  buffer_load_dwordx4 v3, s[12:15], s33 offen offset:1024 nt lds
  v_mfma_f32_16x16x32_bf16 v[116:119], a[222:225], v[72:75], v[116:119]
  buffer_load_dwordx4 a[72:75], v12, s[8:11], s34 offen offset:128 nt
  buffer_load_dwordx4 a[76:79], v12, s[8:11], s34 offen offset:192 nt
  s_waitcnt lgkmcnt(0)
  v_mfma_f32_16x16x32_bf16 v[120:123], a[228:231], v[72:75], v[120:123]
  s_add_u32 m0, s25, 41600
  s_nop 0
  buffer_load_dwordx4 v4, s[16:19], s33 offen nt lds
  buffer_load_dwordx4 v5, s[16:19], s33 offen offset:1024 nt lds
  v_exp_f32 v30, v92
  v_fma_f32 v92, v64, s30, v24
  v_mfma_f32_16x16x32_bf16 v[124:127], a[234:237], v[72:75], v[124:127]
  v_exp_f32 v31, v93
  v_fma_f32 v93, v65, s30, v24
  s_waitcnt vmcnt(12)
  s_barrier
  v_mfma_f32_16x16x32_bf16 v[60:63], a[160:163], a[48:51], 0
  v_cvt_pk_bf16_f32 v77, v30, v31
  v_exp_f32 v28, v92
  v_mfma_f32_16x16x32_bf16 v[60:63], a[164:167], a[52:55], v[60:63]
  ds_read_b128 a[160:163], v6 offset:25344
  v_fma_f32 v92, v66, s30, v24
  v_mfma_f32_16x16x32_bf16 v[60:63], a[168:171], a[56:59], v[60:63]
  v_exp_f32 v29, v93
  v_fma_f32 v93, v67, s30, v24
  v_cvt_pk_bf16_f32 v78, v28, v29
  v_mfma_f32_16x16x32_bf16 v[60:63], a[172:175], a[60:63], v[60:63]
  v_exp_f32 v30, v92
  v_mfma_f32_16x16x32_bf16 v[64:67], a[176:179], a[48:51], 0
  v_fma_f32 v92, v52, s30, v25
  v_exp_f32 v31, v93
  v_mfma_f32_16x16x32_bf16 v[64:67], a[180:183], a[52:55], v[64:67]
  v_cvt_pk_bf16_f32 v79, v30, v31
  v_fma_f32 v93, v53, s30, v25
  v_mfma_f32_16x16x32_bf16 v[64:67], a[184:187], a[56:59], v[64:67]
  v_exp_f32 v28, v92
  v_mfma_f32_16x16x32_bf16 v[64:67], a[188:191], a[60:63], v[64:67]
  ds_read_b128 a[164:167], v6 offset:25408
  v_fma_f32 v92, v54, s30, v25
  v_mfma_f32_16x16x32_bf16 v[36:39], a[240:243], v[76:79], v[36:39]
  v_exp_f32 v29, v93
  v_mfma_f32_16x16x32_bf16 v[128:131], a[192:195], v[76:79], v[128:131]
  v_fma_f32 v93, v55, s30, v25
  v_cvt_pk_bf16_f32 v80, v28, v29
  v_mfma_f32_16x16x32_bf16 v[132:135], a[198:201], v[76:79], v[132:135]
  v_exp_f32 v30, v92
  v_mfma_f32_16x16x32_bf16 v[136:139], a[204:207], v[76:79], v[136:139]
  ds_read_b128 a[168:171], v6 offset:25472
  v_fma_f32 v92, v56, s30, v25
  v_mfma_f32_16x16x32_bf16 v[140:143], a[210:213], v[76:79], v[140:143]
  v_exp_f32 v31, v93
  v_fma_f32 v93, v57, s30, v25
  v_mfma_f32_16x16x32_bf16 v[144:147], a[216:219], v[76:79], v[144:147]
  ds_read_b128 a[172:175], v6 offset:25536
  v_cvt_pk_bf16_f32 v81, v30, v31
  v_exp_f32 v28, v92
  v_mfma_f32_16x16x32_bf16 v[148:151], a[222:225], v[76:79], v[148:151]
  ds_read_b128 a[176:179], v7 offset:25344
  v_fma_f32 v92, v58, s30, v25
  v_mfma_f32_16x16x32_bf16 v[152:155], a[228:231], v[76:79], v[152:155]
  v_exp_f32 v29, v93
  v_fma_f32 v93, v59, s30, v25
  v_cvt_pk_bf16_f32 v82, v28, v29
  v_mfma_f32_16x16x32_bf16 v[156:159], a[234:237], v[76:79], v[156:159]
  v_exp_f32 v30, v92
  s_waitcnt lgkmcnt(3)
  v_mfma_f32_16x16x32_bf16 v[68:71], a[160:163], a[128:131], 0
  v_fma_f32 v92, v60, s30, v26
  v_exp_f32 v31, v93
  v_mfma_f32_16x16x32_bf16 v[68:71], a[164:167], a[132:135], v[68:71]
  v_cvt_pk_bf16_f32 v83, v30, v31
  v_fma_f32 v93, v61, s30, v26
  s_waitcnt lgkmcnt(2)
  v_mfma_f32_16x16x32_bf16 v[68:71], a[168:171], a[136:139], v[68:71]
  v_exp_f32 v28, v92
  s_waitcnt lgkmcnt(1)
  v_mfma_f32_16x16x32_bf16 v[68:71], a[172:175], a[140:143], v[68:71]
  ds_read_b128 a[180:183], v7 offset:25408
  v_fma_f32 v92, v62, s30, v26
  v_mfma_f32_16x16x32_bf16 v[40:43], a[240:243], v[80:83], v[40:43]
  v_exp_f32 v29, v93
  v_mfma_f32_16x16x32_bf16 v[160:163], a[192:195], v[80:83], v[160:163]
  v_fma_f32 v93, v63, s30, v26
  v_cvt_pk_bf16_f32 v84, v28, v29
  v_mfma_f32_16x16x32_bf16 v[164:167], a[198:201], v[80:83], v[164:167]
  v_exp_f32 v30, v92
  v_mfma_f32_16x16x32_bf16 v[168:171], a[204:207], v[80:83], v[168:171]
  ds_read_b128 a[184:187], v7 offset:25472
  v_fma_f32 v92, v64, s30, v26
  v_mfma_f32_16x16x32_bf16 v[172:175], a[210:213], v[80:83], v[172:175]
  v_exp_f32 v31, v93
  v_mfma_f32_16x16x32_bf16 v[176:179], a[216:219], v[80:83], v[176:179]
  v_fma_f32 v93, v65, s30, v26
  v_cvt_pk_bf16_f32 v85, v30, v31
  v_mfma_f32_16x16x32_bf16 v[180:183], a[222:225], v[80:83], v[180:183]
  v_exp_f32 v28, v92
  v_mfma_f32_16x16x32_bf16 v[184:187], a[228:231], v[80:83], v[184:187]
  ds_read_b128 a[188:191], v7 offset:25536
  v_fma_f32 v92, v66, s30, v26
  v_mfma_f32_16x16x32_bf16 v[188:191], a[234:237], v[80:83], v[188:191]
  v_exp_f32 v29, v93
  v_mfma_f32_16x16x32_bf16 v[52:55], a[160:163], a[0:3], 0
  v_fma_f32 v93, v67, s30, v26
  v_cvt_pk_bf16_f32 v86, v28, v29
  v_mfma_f32_16x16x32_bf16 v[52:55], a[164:167], a[4:7], v[52:55]
  v_exp_f32 v30, v92
  v_mfma_f32_16x16x32_bf16 v[52:55], a[168:171], a[8:11], v[52:55]
  s_add_u32 s34, s28, 18878464
  v_fma_f32 v92, v68, s30, v27
  v_mfma_f32_16x16x32_bf16 v[52:55], a[172:175], a[12:15], v[52:55]
  v_exp_f32 v31, v93
  s_waitcnt lgkmcnt(1)
  v_mfma_f32_16x16x32_bf16 v[56:59], a[176:179], a[0:3], 0
  ds_read_b64_tr_b16 a[196:197], v10 offset:24960
  v_cvt_pk_bf16_f32 v87, v30, v31
  v_mfma_f32_16x16x32_bf16 v[56:59], a[180:183], a[4:7], v[56:59]
  buffer_load_dwordx4 a[80:83], v12, s[8:11], s34 offen offset:0 nt
  buffer_load_dwordx4 a[84:87], v12, s[8:11], s34 offen offset:64 nt
  v_mfma_f32_16x16x32_bf16 v[56:59], a[184:187], a[8:11], v[56:59]
  ds_read_b64_tr_b16 a[202:203], v10 offset:24968
  v_fma_f32 v93, v69, s30, v27
  s_waitcnt lgkmcnt(2)
  v_mfma_f32_16x16x32_bf16 v[56:59], a[188:191], a[12:15], v[56:59]
  ds_read_b64_tr_b16 a[208:209], v10 offset:25024
  ds_read_b64_tr_b16 a[214:215], v10 offset:25032
  v_mfma_f32_16x16x32_bf16 v[44:47], a[240:243], v[84:87], v[44:47]
  v_exp_f32 v28, v92
  v_mfma_f32_16x16x32_bf16 v[192:195], a[192:195], v[84:87], v[192:195]
  ds_read_b64_tr_b16 a[220:221], v11 offset:24960
  v_fma_f32 v92, v70, s30, v27
  v_mfma_f32_16x16x32_bf16 v[196:199], a[198:201], v[84:87], v[196:199]
  ds_read_b64_tr_b16 a[226:227], v11 offset:24968
  ds_read_b64_tr_b16 a[232:233], v11 offset:25024
  v_mfma_f32_16x16x32_bf16 v[200:203], a[204:207], v[84:87], v[200:203]
  v_exp_f32 v29, v93
  v_mfma_f32_16x16x32_bf16 v[204:207], a[210:213], v[84:87], v[204:207]
  ds_read_b64_tr_b16 a[238:239], v11 offset:25032
  v_fma_f32 v93, v71, s30, v27
  v_mfma_f32_16x16x32_bf16 v[208:211], a[216:219], v[84:87], v[208:211]
  ds_read_b64_tr_b16 a[194:195], v8 offset:24960
  v_cvt_pk_bf16_f32 v90, v28, v29
  v_mfma_f32_16x16x32_bf16 v[212:215], a[222:225], v[84:87], v[212:215]
  v_exp_f32 v30, v92
  v_mfma_f32_16x16x32_bf16 v[216:219], a[228:231], v[84:87], v[216:219]
  ds_read_b64_tr_b16 a[200:201], v8 offset:24968
  v_fma_f32 v92, v52, s30, v23
  v_mfma_f32_16x16x32_bf16 v[220:223], a[234:237], v[84:87], v[220:223]
  ds_read_b64_tr_b16 a[206:207], v8 offset:25024
  ds_read_b64_tr_b16 a[212:213], v8 offset:25032
  v_mfma_f32_16x16x32_bf16 v[60:63], a[160:163], a[16:19], 0
  v_exp_f32 v31, v93
  v_mfma_f32_16x16x32_bf16 v[60:63], a[164:167], a[20:23], v[60:63]
  ds_read_b64_tr_b16 a[218:219], v9 offset:24960
  v_cvt_pk_bf16_f32 v91, v30, v31
  v_mfma_f32_16x16x32_bf16 v[60:63], a[168:171], a[24:27], v[60:63]
  ds_read_b64_tr_b16 a[224:225], v9 offset:24968
  ds_read_b64_tr_b16 a[230:231], v9 offset:25024
  v_mfma_f32_16x16x32_bf16 v[60:63], a[172:175], a[28:31], v[60:63]
  ds_read_b64_tr_b16 a[236:237], v9 offset:25032
  v_fma_f32 v93, v53, s30, v23
  v_mfma_f32_16x16x32_bf16 v[64:67], a[176:179], a[16:19], 0
  v_exp_f32 v28, v92
  v_mfma_f32_16x16x32_bf16 v[64:67], a[180:183], a[20:23], v[64:67]
  s_add_u32 m0, s24, 50688
  v_fma_f32 v92, v54, s30, v23
  v_mfma_f32_16x16x32_bf16 v[64:67], a[184:187], a[24:27], v[64:67]
  v_exp_f32 v29, v93
  v_mfma_f32_16x16x32_bf16 v[64:67], a[188:191], a[28:31], v[64:67]
  v_fma_f32 v93, v55, s30, v23
  v_cvt_pk_bf16_f32 v72, v28, v29
  v_mfma_f32_16x16x32_bf16 v[48:51], a[240:243], v[88:91], v[48:51]
  v_exp_f32 v30, v92
  s_waitcnt lgkmcnt(1)
  v_mfma_f32_16x16x32_bf16 v[224:227], a[192:195], v[88:91], v[224:227]
  s_xor_b32 s33, s27, 49152
  v_fma_f32 v92, v56, s30, v23
  v_mfma_f32_16x16x32_bf16 v[228:231], a[198:201], v[88:91], v[228:231]
  v_exp_f32 v31, v93
  v_mfma_f32_16x16x32_bf16 v[232:235], a[204:207], v[88:91], v[232:235]
  v_fma_f32 v93, v57, s30, v23
  v_cvt_pk_bf16_f32 v73, v30, v31
  v_mfma_f32_16x16x32_bf16 v[236:239], a[210:213], v[88:91], v[236:239]
  v_exp_f32 v28, v92
  v_mfma_f32_16x16x32_bf16 v[240:243], a[216:219], v[88:91], v[240:243]
  buffer_load_dwordx4 v2, s[12:15], s33 offen nt lds
  v_fma_f32 v92, v58, s30, v23
  v_mfma_f32_16x16x32_bf16 v[244:247], a[222:225], v[88:91], v[244:247]
  v_exp_f32 v29, v93
  v_mfma_f32_16x16x32_bf16 v[248:251], a[228:231], v[88:91], v[248:251]
  v_fma_f32 v93, v59, s30, v23
  v_cvt_pk_bf16_f32 v74, v28, v29
  s_waitcnt lgkmcnt(0)
  v_mfma_f32_16x16x32_bf16 v[252:255], a[234:237], v[88:91], v[252:255]
  v_exp_f32 v30, v92
  v_mfma_f32_16x16x32_bf16 v[52:55], a[160:163], a[32:35], 0
  buffer_load_dwordx4 v3, s[12:15], s33 offen offset:1024 nt lds
  v_fma_f32 v92, v60, s30, v24
  v_mfma_f32_16x16x32_bf16 v[52:55], a[164:167], a[36:39], v[52:55]
  v_exp_f32 v31, v93
  v_mfma_f32_16x16x32_bf16 v[52:55], a[168:171], a[40:43], v[52:55]
  v_cvt_pk_bf16_f32 v75, v30, v31
  v_fma_f32 v93, v61, s30, v24
  v_mfma_f32_16x16x32_bf16 v[52:55], a[172:175], a[44:47], v[52:55]
  v_exp_f32 v28, v92
  v_mfma_f32_16x16x32_bf16 v[56:59], a[176:179], a[32:35], 0
  s_add_u32 m0, s25, 49920
  v_fma_f32 v92, v62, s30, v24
  v_mfma_f32_16x16x32_bf16 v[56:59], a[180:183], a[36:39], v[56:59]
  v_exp_f32 v29, v93
  v_mfma_f32_16x16x32_bf16 v[56:59], a[184:187], a[40:43], v[56:59]
  v_fma_f32 v93, v63, s30, v24
  v_cvt_pk_bf16_f32 v76, v28, v29
  v_mfma_f32_16x16x32_bf16 v[56:59], a[188:191], a[44:47], v[56:59]
  v_exp_f32 v30, v92
  v_mfma_f32_16x16x32_bf16 v[32:35], a[240:243], v[72:75], v[32:35]
  buffer_load_dwordx4 v4, s[16:19], s33 offen nt lds
  v_fma_f32 v92, v64, s30, v24
  v_mfma_f32_16x16x32_bf16 v[96:99], a[194:197], v[72:75], v[96:99]
  buffer_load_dwordx4 v5, s[16:19], s33 offen offset:1024 nt lds
  v_exp_f32 v31, v93
  v_mfma_f32_16x16x32_bf16 v[100:103], a[200:203], v[72:75], v[100:103]
  v_fma_f32 v93, v65, s30, v24
  v_cvt_pk_bf16_f32 v77, v30, v31
  v_mfma_f32_16x16x32_bf16 v[104:107], a[206:209], v[72:75], v[104:107]
  v_exp_f32 v28, v92
  v_mfma_f32_16x16x32_bf16 v[108:111], a[212:215], v[72:75], v[108:111]
  v_fma_f32 v92, v66, s30, v24
  v_exp_f32 v29, v93
  v_mfma_f32_16x16x32_bf16 v[112:115], a[218:221], v[72:75], v[112:115]
  v_fma_f32 v93, v67, s30, v24
  v_cvt_pk_bf16_f32 v78, v28, v29
  v_mfma_f32_16x16x32_bf16 v[116:119], a[224:227], v[72:75], v[116:119]
  v_exp_f32 v30, v92
  v_mfma_f32_16x16x32_bf16 v[120:123], a[230:233], v[72:75], v[120:123]
  v_fma_f32 v92, v52, s30, v25
  v_exp_f32 v31, v93
  v_mfma_f32_16x16x32_bf16 v[124:127], a[236:239], v[72:75], v[124:127]
  v_cvt_pk_bf16_f32 v79, v30, v31
  v_fma_f32 v93, v53, s30, v25
  s_waitcnt vmcnt(14)
  s_barrier
  v_mfma_f32_16x16x32_bf16 v[60:63], a[160:163], a[48:51], 0
  v_exp_f32 v28, v92
  v_mfma_f32_16x16x32_bf16 v[60:63], a[164:167], a[52:55], v[60:63]
  ds_read_b128 a[160:163], v6 offset:33792
  v_fma_f32 v92, v54, s30, v25
  v_mfma_f32_16x16x32_bf16 v[60:63], a[168:171], a[56:59], v[60:63]
  v_exp_f32 v29, v93
  v_mfma_f32_16x16x32_bf16 v[60:63], a[172:175], a[60:63], v[60:63]
  v_fma_f32 v93, v55, s30, v25
  v_cvt_pk_bf16_f32 v80, v28, v29
  v_mfma_f32_16x16x32_bf16 v[64:67], a[176:179], a[48:51], 0
  v_exp_f32 v30, v92
  v_mfma_f32_16x16x32_bf16 v[64:67], a[180:183], a[52:55], v[64:67]
  ds_read_b128 a[164:167], v6 offset:33856
  v_fma_f32 v92, v56, s30, v25
  v_mfma_f32_16x16x32_bf16 v[64:67], a[184:187], a[56:59], v[64:67]
  v_exp_f32 v31, v93
  v_mfma_f32_16x16x32_bf16 v[64:67], a[188:191], a[60:63], v[64:67]
  ds_read_b128 a[168:171], v6 offset:33920
  v_fma_f32 v93, v57, s30, v25
  v_mfma_f32_16x16x32_bf16 v[36:39], a[240:243], v[76:79], v[36:39]
  buffer_load_dwordx4 a[88:91], v12, s[8:11], s34 offen offset:128 nt
  buffer_load_dwordx4 a[92:95], v12, s[8:11], s34 offen offset:192 nt
  v_mfma_f32_16x16x32_bf16 v[128:131], a[194:197], v[76:79], v[128:131]
  ds_read_b128 a[172:175], v6 offset:33984
  v_cvt_pk_bf16_f32 v81, v30, v31
  v_mfma_f32_16x16x32_bf16 v[132:135], a[200:203], v[76:79], v[132:135]
  v_exp_f32 v28, v92
  v_mfma_f32_16x16x32_bf16 v[136:139], a[206:209], v[76:79], v[136:139]
  ds_read_b128 a[176:179], v7 offset:33792
  v_fma_f32 v92, v58, s30, v25
  v_mfma_f32_16x16x32_bf16 v[140:143], a[212:215], v[76:79], v[140:143]
  v_exp_f32 v29, v93
  v_mfma_f32_16x16x32_bf16 v[144:147], a[218:221], v[76:79], v[144:147]
  v_fma_f32 v93, v59, s30, v25
  v_cvt_pk_bf16_f32 v82, v28, v29
  v_mfma_f32_16x16x32_bf16 v[148:151], a[224:227], v[76:79], v[148:151]
  v_exp_f32 v30, v92
  v_mfma_f32_16x16x32_bf16 v[152:155], a[230:233], v[76:79], v[152:155]
  ds_read_b128 a[180:183], v7 offset:33856
  v_fma_f32 v92, v60, s30, v26
  v_mfma_f32_16x16x32_bf16 v[156:159], a[236:239], v[76:79], v[156:159]
  v_exp_f32 v31, v93
  s_waitcnt lgkmcnt(2)
  v_mfma_f32_16x16x32_bf16 v[68:71], a[160:163], a[128:131], 0
  v_cvt_pk_bf16_f32 v83, v30, v31
  v_fma_f32 v93, v61, s30, v26
  v_mfma_f32_16x16x32_bf16 v[68:71], a[164:167], a[132:135], v[68:71]
  v_exp_f32 v28, v92
  v_mfma_f32_16x16x32_bf16 v[68:71], a[168:171], a[136:139], v[68:71]
  ds_read_b128 a[184:187], v7 offset:33920
  v_fma_f32 v92, v62, s30, v26
  v_mfma_f32_16x16x32_bf16 v[68:71], a[172:175], a[140:143], v[68:71]
  v_exp_f32 v29, v93
  v_mfma_f32_16x16x32_bf16 v[40:43], a[240:243], v[80:83], v[40:43]
  v_fma_f32 v93, v63, s30, v26
  v_cvt_pk_bf16_f32 v84, v28, v29
  v_mfma_f32_16x16x32_bf16 v[160:163], a[194:197], v[80:83], v[160:163]
  v_exp_f32 v30, v92
  v_mfma_f32_16x16x32_bf16 v[164:167], a[200:203], v[80:83], v[164:167]
  ds_read_b128 a[188:191], v7 offset:33984
  v_fma_f32 v92, v64, s30, v26
  v_mfma_f32_16x16x32_bf16 v[168:171], a[206:209], v[80:83], v[168:171]
  v_exp_f32 v31, v93
  v_mfma_f32_16x16x32_bf16 v[172:175], a[212:215], v[80:83], v[172:175]
  v_fma_f32 v93, v65, s30, v26
  v_cvt_pk_bf16_f32 v85, v30, v31
  v_mfma_f32_16x16x32_bf16 v[176:179], a[218:221], v[80:83], v[176:179]
  v_exp_f32 v28, v92
  v_mfma_f32_16x16x32_bf16 v[180:183], a[224:227], v[80:83], v[180:183]
  ds_read_b64_tr_b16 a[192:193], v8 offset:33280
  v_fma_f32 v92, v66, s30, v26
  v_mfma_f32_16x16x32_bf16 v[184:187], a[230:233], v[80:83], v[184:187]
  v_exp_f32 v29, v93
  v_mfma_f32_16x16x32_bf16 v[188:191], a[236:239], v[80:83], v[188:191]
  v_fma_f32 v93, v67, s30, v26
  v_cvt_pk_bf16_f32 v86, v28, v29
  v_mfma_f32_16x16x32_bf16 v[52:55], a[160:163], a[0:3], 0
  v_exp_f32 v30, v92
  v_mfma_f32_16x16x32_bf16 v[52:55], a[164:167], a[4:7], v[52:55]
  ds_read_b64_tr_b16 a[198:199], v8 offset:33288
  v_fma_f32 v92, v68, s30, v27
  v_mfma_f32_16x16x32_bf16 v[52:55], a[168:171], a[8:11], v[52:55]
  v_exp_f32 v31, v93
  v_mfma_f32_16x16x32_bf16 v[52:55], a[172:175], a[12:15], v[52:55]
  v_cvt_pk_bf16_f32 v87, v30, v31
  v_fma_f32 v93, v69, s30, v27
  s_waitcnt lgkmcnt(1)
  v_mfma_f32_16x16x32_bf16 v[56:59], a[176:179], a[0:3], 0
  v_exp_f32 v28, v92
  v_mfma_f32_16x16x32_bf16 v[56:59], a[180:183], a[4:7], v[56:59]
  ds_read_b64_tr_b16 a[204:205], v8 offset:33344
  v_fma_f32 v92, v70, s30, v27
  v_mfma_f32_16x16x32_bf16 v[56:59], a[184:187], a[8:11], v[56:59]
  v_exp_f32 v29, v93
  v_mfma_f32_16x16x32_bf16 v[56:59], a[188:191], a[12:15], v[56:59]
  v_fma_f32 v93, v71, s30, v27
  v_cvt_pk_bf16_f32 v88, v28, v29
  v_mfma_f32_16x16x32_bf16 v[44:47], a[240:243], v[84:87], v[44:47]
  v_exp_f32 v30, v92
  v_mfma_f32_16x16x32_bf16 v[192:195], a[194:197], v[84:87], v[192:195]
  ds_read_b64_tr_b16 a[210:211], v8 offset:33352
  v_fma_f32 v92, v52, s30, v23
  v_mfma_f32_16x16x32_bf16 v[196:199], a[200:203], v[84:87], v[196:199]
  v_exp_f32 v31, v93
  v_mfma_f32_16x16x32_bf16 v[200:203], a[206:209], v[84:87], v[200:203]
  v_cvt_pk_bf16_f32 v89, v30, v31
  v_fma_f32 v93, v53, s30, v23
  v_mfma_f32_16x16x32_bf16 v[204:207], a[212:215], v[84:87], v[204:207]
  v_exp_f32 v28, v92
  v_mfma_f32_16x16x32_bf16 v[208:211], a[218:221], v[84:87], v[208:211]
  s_add_u32 s34, s28, 18882560
  v_fma_f32 v92, v54, s30, v23
  v_mfma_f32_16x16x32_bf16 v[212:215], a[224:227], v[84:87], v[212:215]
  v_exp_f32 v29, v93
  v_mfma_f32_16x16x32_bf16 v[216:219], a[230:233], v[84:87], v[216:219]
  v_fma_f32 v93, v55, s30, v23
  v_cvt_pk_bf16_f32 v72, v28, v29
  v_mfma_f32_16x16x32_bf16 v[220:223], a[236:239], v[84:87], v[220:223]
  v_exp_f32 v30, v92
  v_mfma_f32_16x16x32_bf16 v[60:63], a[160:163], a[16:19], 0
  ds_read_b64_tr_b16 a[216:217], v9 offset:33280
  v_fma_f32 v92, v56, s30, v23
  v_mfma_f32_16x16x32_bf16 v[60:63], a[164:167], a[20:23], v[60:63]
  v_exp_f32 v31, v93
  v_mfma_f32_16x16x32_bf16 v[60:63], a[168:171], a[24:27], v[60:63]
  v_fma_f32 v93, v57, s30, v23
  v_cvt_pk_bf16_f32 v73, v30, v31
  v_mfma_f32_16x16x32_bf16 v[60:63], a[172:175], a[28:31], v[60:63]
  buffer_load_dwordx4 a[96:99], v12, s[8:11], s34 offen offset:0 nt
  buffer_load_dwordx4 a[100:103], v12, s[8:11], s34 offen offset:64 nt
  v_mfma_f32_16x16x32_bf16 v[64:67], a[176:179], a[16:19], 0
  v_exp_f32 v28, v92
  v_mfma_f32_16x16x32_bf16 v[64:67], a[180:183], a[20:23], v[64:67]
  ds_read_b64_tr_b16 a[222:223], v9 offset:33288
  v_fma_f32 v92, v58, s30, v23
  v_mfma_f32_16x16x32_bf16 v[64:67], a[184:187], a[24:27], v[64:67]
  ds_read_b64_tr_b16 a[228:229], v9 offset:33344
  ds_read_b64_tr_b16 a[234:235], v9 offset:33352
  v_mfma_f32_16x16x32_bf16 v[64:67], a[188:191], a[28:31], v[64:67]
  v_exp_f32 v29, v93
  v_mfma_f32_16x16x32_bf16 v[52:55], a[160:163], a[32:35], 0
  ds_read_b64_tr_b16 a[194:195], v10 offset:33280
  v_fma_f32 v93, v59, s30, v23
  v_mfma_f32_16x16x32_bf16 v[52:55], a[164:167], a[36:39], v[52:55]
  ds_read_b64_tr_b16 a[200:201], v10 offset:33288
  v_cvt_pk_bf16_f32 v74, v28, v29
  v_mfma_f32_16x16x32_bf16 v[52:55], a[168:171], a[40:43], v[52:55]
  v_exp_f32 v30, v92
  v_mfma_f32_16x16x32_bf16 v[52:55], a[172:175], a[44:47], v[52:55]
  ds_read_b64_tr_b16 a[206:207], v10 offset:33344
  v_fma_f32 v92, v60, s30, v24
  v_mfma_f32_16x16x32_bf16 v[56:59], a[176:179], a[32:35], 0
  v_exp_f32 v31, v93
  v_mfma_f32_16x16x32_bf16 v[56:59], a[180:183], a[36:39], v[56:59]
  ds_read_b64_tr_b16 a[212:213], v10 offset:33352
  v_cvt_pk_bf16_f32 v75, v30, v31
  v_mfma_f32_16x16x32_bf16 v[56:59], a[184:187], a[40:43], v[56:59]
  ds_read_b64_tr_b16 a[218:219], v11 offset:33280
  ds_read_b64_tr_b16 a[224:225], v11 offset:33288
  v_mfma_f32_16x16x32_bf16 v[56:59], a[188:191], a[44:47], v[56:59]
  ds_read_b64_tr_b16 a[230:231], v11 offset:33344
  ds_read_b64_tr_b16 a[236:237], v11 offset:33352
  v_mfma_f32_16x16x32_bf16 v[32:35], a[240:243], v[72:75], v[32:35]
  s_add_u32 m0, s24, 0
  v_fma_f32 v93, v61, s30, v24
  s_waitcnt lgkmcnt(6)
  v_mfma_f32_16x16x32_bf16 v[96:99], a[192:195], v[72:75], v[96:99]
  v_exp_f32 v28, v92
  v_mfma_f32_16x16x32_bf16 v[100:103], a[198:201], v[72:75], v[100:103]
  s_xor_b32 s33, s27, 57344
  v_fma_f32 v92, v62, s30, v24
  s_waitcnt lgkmcnt(5)
  v_mfma_f32_16x16x32_bf16 v[104:107], a[204:207], v[72:75], v[104:107]
  v_exp_f32 v29, v93
  s_waitcnt lgkmcnt(4)
  v_mfma_f32_16x16x32_bf16 v[108:111], a[210:213], v[72:75], v[108:111]
  buffer_load_dwordx4 v2, s[12:15], s33 offen nt lds
  v_fma_f32 v93, v63, s30, v24
  s_waitcnt lgkmcnt(2)
  v_mfma_f32_16x16x32_bf16 v[112:115], a[216:219], v[72:75], v[112:115]
  buffer_load_dwordx4 v3, s[12:15], s33 offen offset:1024 nt lds
  v_cvt_pk_bf16_f32 v76, v28, v29
  v_mfma_f32_16x16x32_bf16 v[116:119], a[222:225], v[72:75], v[116:119]
  s_add_u32 m0, s25, 0
  s_nop 0
  buffer_load_dwordx4 v4, s[16:19], s33 offen nt lds
  s_waitcnt lgkmcnt(0)
  v_mfma_f32_16x16x32_bf16 v[120:123], a[228:231], v[72:75], v[120:123]
  buffer_load_dwordx4 v5, s[16:19], s33 offen offset:1024 nt lds
  v_exp_f32 v30, v92
  v_fma_f32 v92, v64, s30, v24
  v_mfma_f32_16x16x32_bf16 v[124:127], a[234:237], v[72:75], v[124:127]
  v_exp_f32 v31, v93
  v_fma_f32 v93, v65, s30, v24
  s_waitcnt vmcnt(14)
  s_barrier
  v_mfma_f32_16x16x32_bf16 v[60:63], a[160:163], a[48:51], 0
  ds_read_b128 a[160:163], v6 offset:42240
  v_cvt_pk_bf16_f32 v77, v30, v31
  v_mfma_f32_16x16x32_bf16 v[60:63], a[164:167], a[52:55], v[60:63]
  v_exp_f32 v28, v92
  v_fma_f32 v92, v66, s30, v24
  v_mfma_f32_16x16x32_bf16 v[60:63], a[168:171], a[56:59], v[60:63]
  v_exp_f32 v29, v93
  v_fma_f32 v93, v67, s30, v24
  v_cvt_pk_bf16_f32 v78, v28, v29
  v_mfma_f32_16x16x32_bf16 v[60:63], a[172:175], a[60:63], v[60:63]
  v_exp_f32 v30, v92
  v_mfma_f32_16x16x32_bf16 v[64:67], a[176:179], a[48:51], 0
  v_fma_f32 v92, v52, s30, v25
  v_exp_f32 v31, v93
  v_mfma_f32_16x16x32_bf16 v[64:67], a[180:183], a[52:55], v[64:67]
  v_cvt_pk_bf16_f32 v79, v30, v31
  v_fma_f32 v93, v53, s30, v25
  v_mfma_f32_16x16x32_bf16 v[64:67], a[184:187], a[56:59], v[64:67]
  v_exp_f32 v28, v92
  v_mfma_f32_16x16x32_bf16 v[64:67], a[188:191], a[60:63], v[64:67]
  ds_read_b128 a[164:167], v6 offset:42304
  v_fma_f32 v92, v54, s30, v25
  v_mfma_f32_16x16x32_bf16 v[36:39], a[240:243], v[76:79], v[36:39]
  v_exp_f32 v29, v93
  v_mfma_f32_16x16x32_bf16 v[128:131], a[192:195], v[76:79], v[128:131]
  v_fma_f32 v93, v55, s30, v25
  v_cvt_pk_bf16_f32 v80, v28, v29
  v_mfma_f32_16x16x32_bf16 v[132:135], a[198:201], v[76:79], v[132:135]
  v_exp_f32 v30, v92
  v_mfma_f32_16x16x32_bf16 v[136:139], a[204:207], v[76:79], v[136:139]
  ds_read_b128 a[168:171], v6 offset:42368
  v_fma_f32 v92, v56, s30, v25
  v_mfma_f32_16x16x32_bf16 v[140:143], a[210:213], v[76:79], v[140:143]
  v_exp_f32 v31, v93
  v_fma_f32 v93, v57, s30, v25
  v_mfma_f32_16x16x32_bf16 v[144:147], a[216:219], v[76:79], v[144:147]
  ds_read_b128 a[172:175], v6 offset:42432
  v_cvt_pk_bf16_f32 v81, v30, v31
  v_mfma_f32_16x16x32_bf16 v[148:151], a[222:225], v[76:79], v[148:151]
  v_exp_f32 v28, v92
  v_fma_f32 v92, v58, s30, v25
  v_mfma_f32_16x16x32_bf16 v[152:155], a[228:231], v[76:79], v[152:155]
  v_exp_f32 v29, v93
  v_fma_f32 v93, v59, s30, v25
  v_cvt_pk_bf16_f32 v82, v28, v29
  v_mfma_f32_16x16x32_bf16 v[156:159], a[234:237], v[76:79], v[156:159]
  v_exp_f32 v30, v92
  s_waitcnt lgkmcnt(2)
  v_mfma_f32_16x16x32_bf16 v[68:71], a[160:163], a[128:131], 0
  v_fma_f32 v92, v60, s30, v26
  v_exp_f32 v31, v93
  v_mfma_f32_16x16x32_bf16 v[68:71], a[164:167], a[132:135], v[68:71]
  v_cvt_pk_bf16_f32 v83, v30, v31
  v_fma_f32 v93, v61, s30, v26
  s_waitcnt lgkmcnt(1)
  v_mfma_f32_16x16x32_bf16 v[68:71], a[168:171], a[136:139], v[68:71]
  v_exp_f32 v28, v92
  s_waitcnt lgkmcnt(0)
  v_mfma_f32_16x16x32_bf16 v[68:71], a[172:175], a[140:143], v[68:71]
  ds_read_b128 a[176:179], v7 offset:42240
  v_fma_f32 v92, v62, s30, v26
  v_mfma_f32_16x16x32_bf16 v[40:43], a[240:243], v[80:83], v[40:43]
  v_exp_f32 v29, v93
  v_mfma_f32_16x16x32_bf16 v[160:163], a[192:195], v[80:83], v[160:163]
  v_fma_f32 v93, v63, s30, v26
  v_cvt_pk_bf16_f32 v84, v28, v29
  v_mfma_f32_16x16x32_bf16 v[164:167], a[198:201], v[80:83], v[164:167]
  v_exp_f32 v30, v92
  v_mfma_f32_16x16x32_bf16 v[168:171], a[204:207], v[80:83], v[168:171]
  ds_read_b128 a[180:183], v7 offset:42304
  v_fma_f32 v92, v64, s30, v26
  v_mfma_f32_16x16x32_bf16 v[172:175], a[210:213], v[80:83], v[172:175]
  buffer_load_dwordx4 a[104:107], v12, s[8:11], s34 offen offset:128 nt
  buffer_load_dwordx4 a[108:111], v12, s[8:11], s34 offen offset:192 nt
  v_mfma_f32_16x16x32_bf16 v[176:179], a[216:219], v[80:83], v[176:179]
  v_exp_f32 v31, v93
  v_mfma_f32_16x16x32_bf16 v[180:183], a[222:225], v[80:83], v[180:183]
  ds_read_b128 a[184:187], v7 offset:42368
  v_fma_f32 v93, v65, s30, v26
  v_mfma_f32_16x16x32_bf16 v[184:187], a[228:231], v[80:83], v[184:187]
  ds_read_b128 a[188:191], v7 offset:42432
  v_cvt_pk_bf16_f32 v85, v30, v31
  v_mfma_f32_16x16x32_bf16 v[188:191], a[234:237], v[80:83], v[188:191]
  v_exp_f32 v28, v92
  v_mfma_f32_16x16x32_bf16 v[52:55], a[160:163], a[0:3], 0
  ds_read_b64_tr_b16 a[196:197], v10 offset:41600
  v_fma_f32 v92, v66, s30, v26
  v_mfma_f32_16x16x32_bf16 v[52:55], a[164:167], a[4:7], v[52:55]
  v_exp_f32 v29, v93
  v_mfma_f32_16x16x32_bf16 v[52:55], a[168:171], a[8:11], v[52:55]
  v_fma_f32 v93, v67, s30, v26
  v_cvt_pk_bf16_f32 v86, v28, v29
  v_mfma_f32_16x16x32_bf16 v[52:55], a[172:175], a[12:15], v[52:55]
  v_exp_f32 v30, v92
  s_waitcnt lgkmcnt(2)
  v_mfma_f32_16x16x32_bf16 v[56:59], a[176:179], a[0:3], 0
  v_fma_f32 v92, v68, s30, v27
  v_exp_f32 v31, v93
  v_mfma_f32_16x16x32_bf16 v[56:59], a[180:183], a[4:7], v[56:59]
  v_cvt_pk_bf16_f32 v87, v30, v31
  v_fma_f32 v93, v69, s30, v27
  v_mfma_f32_16x16x32_bf16 v[56:59], a[184:187], a[8:11], v[56:59]
  ds_read_b64_tr_b16 a[202:203], v10 offset:41608
  ds_read_b64_tr_b16 a[208:209], v10 offset:41664
  s_waitcnt lgkmcnt(2)
  v_mfma_f32_16x16x32_bf16 v[56:59], a[188:191], a[12:15], v[56:59]
  v_exp_f32 v28, v92
  v_mfma_f32_16x16x32_bf16 v[44:47], a[240:243], v[84:87], v[44:47]
  ds_read_b64_tr_b16 a[214:215], v10 offset:41672
  v_fma_f32 v92, v70, s30, v27
  v_mfma_f32_16x16x32_bf16 v[192:195], a[192:195], v[84:87], v[192:195]
  ds_read_b64_tr_b16 a[220:221], v11 offset:41600
  ds_read_b64_tr_b16 a[226:227], v11 offset:41608
  v_mfma_f32_16x16x32_bf16 v[196:199], a[198:201], v[84:87], v[196:199]
  ds_read_b64_tr_b16 a[232:233], v11 offset:41664
  ds_read_b64_tr_b16 a[238:239], v11 offset:41672
  v_mfma_f32_16x16x32_bf16 v[200:203], a[204:207], v[84:87], v[200:203]
  v_exp_f32 v29, v93
  v_mfma_f32_16x16x32_bf16 v[204:207], a[210:213], v[84:87], v[204:207]
  ds_read_b64_tr_b16 a[194:195], v8 offset:41600
  v_fma_f32 v93, v71, s30, v27
  v_mfma_f32_16x16x32_bf16 v[208:211], a[216:219], v[84:87], v[208:211]
  ds_read_b64_tr_b16 a[200:201], v8 offset:41608
  v_cvt_pk_bf16_f32 v90, v28, v29
  v_mfma_f32_16x16x32_bf16 v[212:215], a[222:225], v[84:87], v[212:215]
  v_exp_f32 v30, v92
  v_mfma_f32_16x16x32_bf16 v[216:219], a[228:231], v[84:87], v[216:219]
  ds_read_b64_tr_b16 a[206:207], v8 offset:41664
  v_fma_f32 v92, v52, s30, v23
  v_mfma_f32_16x16x32_bf16 v[220:223], a[234:237], v[84:87], v[220:223]
  v_exp_f32 v31, v93
  v_mfma_f32_16x16x32_bf16 v[60:63], a[160:163], a[16:19], 0
  ds_read_b64_tr_b16 a[212:213], v8 offset:41672
  v_cvt_pk_bf16_f32 v91, v30, v31
  v_mfma_f32_16x16x32_bf16 v[60:63], a[164:167], a[20:23], v[60:63]
  ds_read_b64_tr_b16 a[218:219], v9 offset:41600
  ds_read_b64_tr_b16 a[224:225], v9 offset:41608
  v_mfma_f32_16x16x32_bf16 v[60:63], a[168:171], a[24:27], v[60:63]
  ds_read_b64_tr_b16 a[230:231], v9 offset:41664
  ds_read_b64_tr_b16 a[236:237], v9 offset:41672
  v_mfma_f32_16x16x32_bf16 v[60:63], a[172:175], a[28:31], v[60:63]
  s_add_u32 m0, s24, 8448
  v_fma_f32 v93, v53, s30, v23
  v_mfma_f32_16x16x32_bf16 v[64:67], a[176:179], a[16:19], 0
  v_exp_f32 v28, v92
  v_mfma_f32_16x16x32_bf16 v[64:67], a[180:183], a[20:23], v[64:67]
  s_xor_b32 s33, s27, 65536
  v_fma_f32 v92, v54, s30, v23
  v_mfma_f32_16x16x32_bf16 v[64:67], a[184:187], a[24:27], v[64:67]
  v_exp_f32 v29, v93
  v_mfma_f32_16x16x32_bf16 v[64:67], a[188:191], a[28:31], v[64:67]
  v_fma_f32 v93, v55, s30, v23
  v_cvt_pk_bf16_f32 v72, v28, v29
  v_mfma_f32_16x16x32_bf16 v[48:51], a[240:243], v[88:91], v[48:51]
  v_exp_f32 v30, v92
  s_waitcnt lgkmcnt(0)
  v_mfma_f32_16x16x32_bf16 v[224:227], a[192:195], v[88:91], v[224:227]
  buffer_load_dwordx4 v2, s[12:15], s33 offen nt lds
  v_fma_f32 v92, v56, s30, v23
  v_mfma_f32_16x16x32_bf16 v[228:231], a[198:201], v[88:91], v[228:231]
  v_exp_f32 v31, v93
  v_mfma_f32_16x16x32_bf16 v[232:235], a[204:207], v[88:91], v[232:235]
  v_fma_f32 v93, v57, s30, v23
  v_cvt_pk_bf16_f32 v73, v30, v31
  v_mfma_f32_16x16x32_bf16 v[236:239], a[210:213], v[88:91], v[236:239]
  v_exp_f32 v28, v92
  v_mfma_f32_16x16x32_bf16 v[240:243], a[216:219], v[88:91], v[240:243]
  buffer_load_dwordx4 v3, s[12:15], s33 offen offset:1024 nt lds
  v_fma_f32 v92, v58, s30, v23
  v_mfma_f32_16x16x32_bf16 v[244:247], a[222:225], v[88:91], v[244:247]
  v_exp_f32 v29, v93
  v_mfma_f32_16x16x32_bf16 v[248:251], a[228:231], v[88:91], v[248:251]
  v_fma_f32 v93, v59, s30, v23
  v_cvt_pk_bf16_f32 v74, v28, v29
  v_mfma_f32_16x16x32_bf16 v[252:255], a[234:237], v[88:91], v[252:255]
  v_exp_f32 v30, v92
  v_mfma_f32_16x16x32_bf16 v[52:55], a[160:163], a[32:35], 0
  s_add_u32 m0, s25, 8320
  v_fma_f32 v92, v60, s30, v24
  v_mfma_f32_16x16x32_bf16 v[52:55], a[164:167], a[36:39], v[52:55]
  v_exp_f32 v31, v93
  v_mfma_f32_16x16x32_bf16 v[52:55], a[168:171], a[40:43], v[52:55]
  v_cvt_pk_bf16_f32 v75, v30, v31
  v_fma_f32 v93, v61, s30, v24
  v_mfma_f32_16x16x32_bf16 v[52:55], a[172:175], a[44:47], v[52:55]
  v_exp_f32 v28, v92
  v_mfma_f32_16x16x32_bf16 v[56:59], a[176:179], a[32:35], 0
  buffer_load_dwordx4 v4, s[16:19], s33 offen nt lds
  v_fma_f32 v92, v62, s30, v24
  v_mfma_f32_16x16x32_bf16 v[56:59], a[180:183], a[36:39], v[56:59]
  v_exp_f32 v29, v93
  v_mfma_f32_16x16x32_bf16 v[56:59], a[184:187], a[40:43], v[56:59]
  v_fma_f32 v93, v63, s30, v24
  v_cvt_pk_bf16_f32 v76, v28, v29
  v_mfma_f32_16x16x32_bf16 v[56:59], a[188:191], a[44:47], v[56:59]
  v_exp_f32 v30, v92
  v_mfma_f32_16x16x32_bf16 v[32:35], a[240:243], v[72:75], v[32:35]
  buffer_load_dwordx4 v5, s[16:19], s33 offen offset:1024 nt lds
  v_fma_f32 v92, v64, s30, v24
  v_mfma_f32_16x16x32_bf16 v[96:99], a[194:197], v[72:75], v[96:99]
  v_exp_f32 v31, v93
  v_mfma_f32_16x16x32_bf16 v[100:103], a[200:203], v[72:75], v[100:103]
  v_fma_f32 v93, v65, s30, v24
  v_cvt_pk_bf16_f32 v77, v30, v31
  v_mfma_f32_16x16x32_bf16 v[104:107], a[206:209], v[72:75], v[104:107]
  v_exp_f32 v28, v92
  v_mfma_f32_16x16x32_bf16 v[108:111], a[212:215], v[72:75], v[108:111]
  v_fma_f32 v92, v66, s30, v24
  v_exp_f32 v29, v93
  v_mfma_f32_16x16x32_bf16 v[112:115], a[218:221], v[72:75], v[112:115]
  v_fma_f32 v93, v67, s30, v24
  v_cvt_pk_bf16_f32 v78, v28, v29
  v_mfma_f32_16x16x32_bf16 v[116:119], a[224:227], v[72:75], v[116:119]
  v_exp_f32 v30, v92
  v_mfma_f32_16x16x32_bf16 v[120:123], a[230:233], v[72:75], v[120:123]
  v_fma_f32 v92, v52, s30, v25
  v_exp_f32 v31, v93
  v_mfma_f32_16x16x32_bf16 v[124:127], a[236:239], v[72:75], v[124:127]
  v_cvt_pk_bf16_f32 v79, v30, v31
  v_fma_f32 v93, v53, s30, v25
  s_waitcnt vmcnt(14)
  s_barrier
  v_mfma_f32_16x16x32_bf16 v[60:63], a[160:163], a[48:51], 0
  v_exp_f32 v28, v92
  v_mfma_f32_16x16x32_bf16 v[60:63], a[164:167], a[52:55], v[60:63]
  ds_read_b128 a[160:163], v6 offset:50688
  v_fma_f32 v92, v54, s30, v25
  v_mfma_f32_16x16x32_bf16 v[60:63], a[168:171], a[56:59], v[60:63]
  v_exp_f32 v29, v93
  v_mfma_f32_16x16x32_bf16 v[60:63], a[172:175], a[60:63], v[60:63]
  v_fma_f32 v93, v55, s30, v25
  v_cvt_pk_bf16_f32 v80, v28, v29
  v_mfma_f32_16x16x32_bf16 v[64:67], a[176:179], a[48:51], 0
  v_exp_f32 v30, v92
  v_mfma_f32_16x16x32_bf16 v[64:67], a[180:183], a[52:55], v[64:67]
  ds_read_b128 a[164:167], v6 offset:50752
  v_fma_f32 v92, v56, s30, v25
  v_mfma_f32_16x16x32_bf16 v[64:67], a[184:187], a[56:59], v[64:67]
  v_exp_f32 v31, v93
  v_mfma_f32_16x16x32_bf16 v[64:67], a[188:191], a[60:63], v[64:67]
  ds_read_b128 a[168:171], v6 offset:50816
  v_fma_f32 v93, v57, s30, v25
  v_mfma_f32_16x16x32_bf16 v[36:39], a[240:243], v[76:79], v[36:39]
  ds_read_b128 a[172:175], v6 offset:50880
  v_cvt_pk_bf16_f32 v81, v30, v31
  v_mfma_f32_16x16x32_bf16 v[128:131], a[194:197], v[76:79], v[128:131]
  v_exp_f32 v28, v92
  v_mfma_f32_16x16x32_bf16 v[132:135], a[200:203], v[76:79], v[132:135]
  ds_read_b128 a[176:179], v7 offset:50688
  v_fma_f32 v92, v58, s30, v25
  v_mfma_f32_16x16x32_bf16 v[136:139], a[206:209], v[76:79], v[136:139]
  v_exp_f32 v29, v93
  v_mfma_f32_16x16x32_bf16 v[140:143], a[212:215], v[76:79], v[140:143]
  v_fma_f32 v93, v59, s30, v25
  v_cvt_pk_bf16_f32 v82, v28, v29
  v_mfma_f32_16x16x32_bf16 v[144:147], a[218:221], v[76:79], v[144:147]
  v_exp_f32 v30, v92
  v_mfma_f32_16x16x32_bf16 v[148:151], a[224:227], v[76:79], v[148:151]
  ds_read_b128 a[180:183], v7 offset:50752
  v_fma_f32 v92, v60, s30, v26
  v_mfma_f32_16x16x32_bf16 v[152:155], a[230:233], v[76:79], v[152:155]
  v_exp_f32 v31, v93
  v_mfma_f32_16x16x32_bf16 v[156:159], a[236:239], v[76:79], v[156:159]
  v_cvt_pk_bf16_f32 v83, v30, v31
  v_fma_f32 v93, v61, s30, v26
  s_waitcnt lgkmcnt(1)
  v_mfma_f32_16x16x32_bf16 v[68:71], a[160:163], a[128:131], 0
  v_exp_f32 v28, v92
  v_mfma_f32_16x16x32_bf16 v[68:71], a[164:167], a[132:135], v[68:71]
  ds_read_b128 a[184:187], v7 offset:50816
  v_fma_f32 v92, v62, s30, v26
  v_mfma_f32_16x16x32_bf16 v[68:71], a[168:171], a[136:139], v[68:71]
  v_exp_f32 v29, v93
  v_mfma_f32_16x16x32_bf16 v[68:71], a[172:175], a[140:143], v[68:71]
  v_fma_f32 v93, v63, s30, v26
  v_cvt_pk_bf16_f32 v84, v28, v29
  v_mfma_f32_16x16x32_bf16 v[40:43], a[240:243], v[80:83], v[40:43]
  v_exp_f32 v30, v92
  v_mfma_f32_16x16x32_bf16 v[160:163], a[194:197], v[80:83], v[160:163]
  ds_read_b128 a[188:191], v7 offset:50880
  v_fma_f32 v92, v64, s30, v26
  v_mfma_f32_16x16x32_bf16 v[164:167], a[200:203], v[80:83], v[164:167]
  v_exp_f32 v31, v93
  v_mfma_f32_16x16x32_bf16 v[168:171], a[206:209], v[80:83], v[168:171]
  v_fma_f32 v93, v65, s30, v26
  v_cvt_pk_bf16_f32 v85, v30, v31
  v_mfma_f32_16x16x32_bf16 v[172:175], a[212:215], v[80:83], v[172:175]
  v_exp_f32 v28, v92
  v_mfma_f32_16x16x32_bf16 v[176:179], a[218:221], v[80:83], v[176:179]
  ds_read_b64_tr_b16 a[192:193], v8 offset:49920
  v_fma_f32 v92, v66, s30, v26
  v_mfma_f32_16x16x32_bf16 v[180:183], a[224:227], v[80:83], v[180:183]
  v_exp_f32 v29, v93
  v_mfma_f32_16x16x32_bf16 v[184:187], a[230:233], v[80:83], v[184:187]
  v_fma_f32 v93, v67, s30, v26
  v_cvt_pk_bf16_f32 v86, v28, v29
  v_mfma_f32_16x16x32_bf16 v[188:191], a[236:239], v[80:83], v[188:191]
  v_exp_f32 v30, v92
  v_mfma_f32_16x16x32_bf16 v[52:55], a[160:163], a[0:3], 0
  ds_read_b64_tr_b16 a[198:199], v8 offset:49928
  v_fma_f32 v92, v68, s30, v27
  v_mfma_f32_16x16x32_bf16 v[52:55], a[164:167], a[4:7], v[52:55]
  v_exp_f32 v31, v93
  v_mfma_f32_16x16x32_bf16 v[52:55], a[168:171], a[8:11], v[52:55]
  v_cvt_pk_bf16_f32 v87, v30, v31
  v_fma_f32 v93, v69, s30, v27
  v_mfma_f32_16x16x32_bf16 v[52:55], a[172:175], a[12:15], v[52:55]
  v_exp_f32 v28, v92
  v_mfma_f32_16x16x32_bf16 v[56:59], a[176:179], a[0:3], 0
  ds_read_b64_tr_b16 a[204:205], v8 offset:49984
  v_fma_f32 v92, v70, s30, v27
  s_waitcnt lgkmcnt(2)
  v_mfma_f32_16x16x32_bf16 v[56:59], a[180:183], a[4:7], v[56:59]
  v_exp_f32 v29, v93
  v_mfma_f32_16x16x32_bf16 v[56:59], a[184:187], a[8:11], v[56:59]
  v_fma_f32 v93, v71, s30, v27
  v_cvt_pk_bf16_f32 v88, v28, v29
  v_mfma_f32_16x16x32_bf16 v[56:59], a[188:191], a[12:15], v[56:59]
  v_exp_f32 v30, v92
  v_mfma_f32_16x16x32_bf16 v[44:47], a[240:243], v[84:87], v[44:47]
  ds_read_b64_tr_b16 a[210:211], v8 offset:49992
  v_fma_f32 v92, v52, s30, v23
  v_mfma_f32_16x16x32_bf16 v[192:195], a[194:197], v[84:87], v[192:195]
  v_exp_f32 v31, v93
  v_mfma_f32_16x16x32_bf16 v[196:199], a[200:203], v[84:87], v[196:199]
  v_cvt_pk_bf16_f32 v89, v30, v31
  v_fma_f32 v93, v53, s30, v23
  v_mfma_f32_16x16x32_bf16 v[200:203], a[206:209], v[84:87], v[200:203]
  v_exp_f32 v28, v92
  v_mfma_f32_16x16x32_bf16 v[204:207], a[212:215], v[84:87], v[204:207]
  ds_read_b64_tr_b16 a[216:217], v9 offset:49920
  v_fma_f32 v92, v54, s30, v23
  v_mfma_f32_16x16x32_bf16 v[208:211], a[218:221], v[84:87], v[208:211]
  v_exp_f32 v29, v93
  v_mfma_f32_16x16x32_bf16 v[212:215], a[224:227], v[84:87], v[212:215]
  v_fma_f32 v93, v55, s30, v23
  v_cvt_pk_bf16_f32 v72, v28, v29
  v_mfma_f32_16x16x32_bf16 v[216:219], a[230:233], v[84:87], v[216:219]
  v_exp_f32 v30, v92
  v_mfma_f32_16x16x32_bf16 v[220:223], a[236:239], v[84:87], v[220:223]
  ds_read_b64_tr_b16 a[222:223], v9 offset:49928
  v_fma_f32 v92, v56, s30, v23
  v_mfma_f32_16x16x32_bf16 v[60:63], a[160:163], a[16:19], 0
  v_exp_f32 v31, v93
  v_mfma_f32_16x16x32_bf16 v[60:63], a[164:167], a[20:23], v[60:63]
  v_fma_f32 v93, v57, s30, v23
  v_cvt_pk_bf16_f32 v73, v30, v31
  v_mfma_f32_16x16x32_bf16 v[60:63], a[168:171], a[24:27], v[60:63]
  v_exp_f32 v28, v92
  v_mfma_f32_16x16x32_bf16 v[60:63], a[172:175], a[28:31], v[60:63]
  ds_read_b64_tr_b16 a[228:229], v9 offset:49984
  v_fma_f32 v92, v58, s30, v23
  v_mfma_f32_16x16x32_bf16 v[64:67], a[176:179], a[16:19], 0
  v_exp_f32 v29, v93
  v_mfma_f32_16x16x32_bf16 v[64:67], a[180:183], a[20:23], v[64:67]
  ds_read_b64_tr_b16 a[234:235], v9 offset:49992
  v_fma_f32 v93, v59, s30, v23
  v_mfma_f32_16x16x32_bf16 v[64:67], a[184:187], a[24:27], v[64:67]
  ds_read_b64_tr_b16 a[194:195], v10 offset:49920
  v_cvt_pk_bf16_f32 v74, v28, v29
  v_mfma_f32_16x16x32_bf16 v[64:67], a[188:191], a[28:31], v[64:67]
  v_exp_f32 v30, v92
  v_mfma_f32_16x16x32_bf16 v[52:55], a[160:163], a[32:35], 0
  ds_read_b64_tr_b16 a[200:201], v10 offset:49928
  v_fma_f32 v92, v60, s30, v24
  v_mfma_f32_16x16x32_bf16 v[52:55], a[164:167], a[36:39], v[52:55]
  ds_read_b64_tr_b16 a[206:207], v10 offset:49984
  ds_read_b64_tr_b16 a[212:213], v10 offset:49992
  v_mfma_f32_16x16x32_bf16 v[52:55], a[168:171], a[40:43], v[52:55]
  v_exp_f32 v31, v93
  v_mfma_f32_16x16x32_bf16 v[52:55], a[172:175], a[44:47], v[52:55]
  ds_read_b64_tr_b16 a[218:219], v11 offset:49920
  v_cvt_pk_bf16_f32 v75, v30, v31
  v_mfma_f32_16x16x32_bf16 v[56:59], a[176:179], a[32:35], 0
  ds_read_b64_tr_b16 a[224:225], v11 offset:49928
  ds_read_b64_tr_b16 a[230:231], v11 offset:49984
  v_mfma_f32_16x16x32_bf16 v[56:59], a[180:183], a[36:39], v[56:59]
  ds_read_b64_tr_b16 a[236:237], v11 offset:49992
  v_fma_f32 v93, v61, s30, v24
  v_mfma_f32_16x16x32_bf16 v[56:59], a[184:187], a[40:43], v[56:59]
  v_exp_f32 v28, v92
  v_mfma_f32_16x16x32_bf16 v[56:59], a[188:191], a[44:47], v[56:59]
  s_add_u32 m0, s24, 16896
  v_fma_f32 v92, v62, s30, v24
  v_mfma_f32_16x16x32_bf16 v[32:35], a[240:243], v[72:75], v[32:35]
  v_exp_f32 v29, v93
  s_waitcnt lgkmcnt(4)
  v_mfma_f32_16x16x32_bf16 v[96:99], a[192:195], v[72:75], v[96:99]
  s_xor_b32 s33, s27, 73728
  v_fma_f32 v93, v63, s30, v24
  v_mfma_f32_16x16x32_bf16 v[100:103], a[198:201], v[72:75], v[100:103]
  buffer_load_dwordx4 v2, s[12:15], s33 offen nt lds
  v_cvt_pk_bf16_f32 v76, v28, v29
  v_mfma_f32_16x16x32_bf16 v[104:107], a[204:207], v[72:75], v[104:107]
  buffer_load_dwordx4 v3, s[12:15], s33 offen offset:1024 nt lds
  s_add_u32 m0, s25, 16640
  v_mfma_f32_16x16x32_bf16 v[108:111], a[210:213], v[72:75], v[108:111]
  v_exp_f32 v30, v92
  s_waitcnt lgkmcnt(0)
  v_mfma_f32_16x16x32_bf16 v[112:115], a[216:219], v[72:75], v[112:115]
  buffer_load_dwordx4 v4, s[16:19], s33 offen nt lds
  v_fma_f32 v92, v64, s30, v24
  v_mfma_f32_16x16x32_bf16 v[116:119], a[222:225], v[72:75], v[116:119]
  buffer_load_dwordx4 v5, s[16:19], s33 offen offset:1024 nt lds
  v_exp_f32 v31, v93
  v_mfma_f32_16x16x32_bf16 v[120:123], a[228:231], v[72:75], v[120:123]
  v_fma_f32 v93, v65, s30, v24
  v_cvt_pk_bf16_f32 v77, v30, v31
  v_mfma_f32_16x16x32_bf16 v[124:127], a[234:237], v[72:75], v[124:127]
  v_exp_f32 v28, v92
  s_waitcnt vmcnt(10)
  s_barrier
  v_mfma_f32_16x16x32_bf16 v[60:63], a[160:163], a[48:51], 0
  ds_read_b128 a[160:163], v6 offset:0
  v_fma_f32 v92, v66, s30, v24
  v_mfma_f32_16x16x32_bf16 v[60:63], a[164:167], a[52:55], v[60:63]
  v_exp_f32 v29, v93
  v_mfma_f32_16x16x32_bf16 v[60:63], a[168:171], a[56:59], v[60:63]
  v_fma_f32 v93, v67, s30, v24
  v_cvt_pk_bf16_f32 v78, v28, v29
  v_mfma_f32_16x16x32_bf16 v[60:63], a[172:175], a[60:63], v[60:63]
  v_exp_f32 v30, v92
  v_mfma_f32_16x16x32_bf16 v[64:67], a[176:179], a[48:51], 0
  v_fma_f32 v92, v52, s30, v25
  v_exp_f32 v31, v93
  v_mfma_f32_16x16x32_bf16 v[64:67], a[180:183], a[52:55], v[64:67]
  v_cvt_pk_bf16_f32 v79, v30, v31
  v_fma_f32 v93, v53, s30, v25
  v_mfma_f32_16x16x32_bf16 v[64:67], a[184:187], a[56:59], v[64:67]
  v_exp_f32 v28, v92
  v_mfma_f32_16x16x32_bf16 v[64:67], a[188:191], a[60:63], v[64:67]
  ds_read_b128 a[164:167], v6 offset:64
  v_fma_f32 v92, v54, s30, v25
  v_mfma_f32_16x16x32_bf16 v[36:39], a[240:243], v[76:79], v[36:39]
  v_exp_f32 v29, v93
  v_mfma_f32_16x16x32_bf16 v[128:131], a[192:195], v[76:79], v[128:131]
  v_fma_f32 v93, v55, s30, v25
  v_cvt_pk_bf16_f32 v80, v28, v29
  v_mfma_f32_16x16x32_bf16 v[132:135], a[198:201], v[76:79], v[132:135]
  v_exp_f32 v30, v92
  v_mfma_f32_16x16x32_bf16 v[136:139], a[204:207], v[76:79], v[136:139]
  ds_read_b128 a[168:171], v6 offset:128
  v_fma_f32 v92, v56, s30, v25
  v_mfma_f32_16x16x32_bf16 v[140:143], a[210:213], v[76:79], v[140:143]
  v_exp_f32 v31, v93
  v_fma_f32 v93, v57, s30, v25
  v_mfma_f32_16x16x32_bf16 v[144:147], a[216:219], v[76:79], v[144:147]
  ds_read_b128 a[172:175], v6 offset:192
  v_cvt_pk_bf16_f32 v81, v30, v31
  v_mfma_f32_16x16x32_bf16 v[148:151], a[222:225], v[76:79], v[148:151]
  v_exp_f32 v28, v92
  v_fma_f32 v92, v58, s30, v25
  v_mfma_f32_16x16x32_bf16 v[152:155], a[228:231], v[76:79], v[152:155]
  v_exp_f32 v29, v93
  v_fma_f32 v93, v59, s30, v25
  v_mfma_f32_16x16x32_bf16 v[156:159], a[234:237], v[76:79], v[156:159]
  v_cvt_pk_bf16_f32 v82, v28, v29
  v_exp_f32 v30, v92
  s_waitcnt lgkmcnt(2)
  v_mfma_f32_16x16x32_bf16 v[68:71], a[160:163], a[128:131], 0
  v_fma_f32 v92, v60, s30, v26
  v_exp_f32 v31, v93
  v_mfma_f32_16x16x32_bf16 v[68:71], a[164:167], a[132:135], v[68:71]
  v_cvt_pk_bf16_f32 v83, v30, v31
  v_fma_f32 v93, v61, s30, v26
  s_waitcnt lgkmcnt(1)
  v_mfma_f32_16x16x32_bf16 v[68:71], a[168:171], a[136:139], v[68:71]
  v_exp_f32 v28, v92
  s_waitcnt lgkmcnt(0)
  v_mfma_f32_16x16x32_bf16 v[68:71], a[172:175], a[140:143], v[68:71]
  ds_read_b128 a[176:179], v7 offset:0
  v_fma_f32 v92, v62, s30, v26
  v_mfma_f32_16x16x32_bf16 v[40:43], a[240:243], v[80:83], v[40:43]
  v_exp_f32 v29, v93
  v_mfma_f32_16x16x32_bf16 v[160:163], a[192:195], v[80:83], v[160:163]
  v_fma_f32 v93, v63, s30, v26
  v_cvt_pk_bf16_f32 v84, v28, v29
  v_mfma_f32_16x16x32_bf16 v[164:167], a[198:201], v[80:83], v[164:167]
  v_exp_f32 v30, v92
  v_mfma_f32_16x16x32_bf16 v[168:171], a[204:207], v[80:83], v[168:171]
  ds_read_b128 a[180:183], v7 offset:64
  v_fma_f32 v92, v64, s30, v26
  v_mfma_f32_16x16x32_bf16 v[172:175], a[210:213], v[80:83], v[172:175]
  v_exp_f32 v31, v93
  v_mfma_f32_16x16x32_bf16 v[176:179], a[216:219], v[80:83], v[176:179]
  ds_read_b128 a[184:187], v7 offset:128
  v_fma_f32 v93, v65, s30, v26
  v_mfma_f32_16x16x32_bf16 v[180:183], a[222:225], v[80:83], v[180:183]
  ds_read_b128 a[188:191], v7 offset:192
  v_cvt_pk_bf16_f32 v85, v30, v31
  v_mfma_f32_16x16x32_bf16 v[184:187], a[228:231], v[80:83], v[184:187]
  v_exp_f32 v28, v92
  v_mfma_f32_16x16x32_bf16 v[188:191], a[234:237], v[80:83], v[188:191]
  ds_read_b64_tr_b16 a[196:197], v10 offset:0
  v_fma_f32 v92, v66, s30, v26
  v_mfma_f32_16x16x32_bf16 v[52:55], a[160:163], a[0:3], 0
  v_exp_f32 v29, v93
  v_mfma_f32_16x16x32_bf16 v[52:55], a[164:167], a[4:7], v[52:55]
  v_fma_f32 v93, v67, s30, v26
  v_cvt_pk_bf16_f32 v86, v28, v29
  v_mfma_f32_16x16x32_bf16 v[52:55], a[168:171], a[8:11], v[52:55]
  v_exp_f32 v30, v92
  v_mfma_f32_16x16x32_bf16 v[52:55], a[172:175], a[12:15], v[52:55]
  ds_read_b64_tr_b16 a[202:203], v10 offset:8
  v_fma_f32 v92, v68, s30, v27
  s_waitcnt lgkmcnt(2)
  v_mfma_f32_16x16x32_bf16 v[56:59], a[176:179], a[0:3], 0
  v_exp_f32 v31, v93
  v_mfma_f32_16x16x32_bf16 v[56:59], a[180:183], a[4:7], v[56:59]
  v_cvt_pk_bf16_f32 v87, v30, v31
  v_fma_f32 v93, v69, s30, v27
  v_mfma_f32_16x16x32_bf16 v[56:59], a[184:187], a[8:11], v[56:59]
  ds_read_b64_tr_b16 a[208:209], v10 offset:64
  ds_read_b64_tr_b16 a[214:215], v10 offset:72
  v_mfma_f32_16x16x32_bf16 v[56:59], a[188:191], a[12:15], v[56:59]
  v_exp_f32 v28, v92
  v_mfma_f32_16x16x32_bf16 v[44:47], a[240:243], v[84:87], v[44:47]
  ds_read_b64_tr_b16 a[220:221], v11 offset:0
  v_fma_f32 v92, v70, s30, v27
  v_mfma_f32_16x16x32_bf16 v[192:195], a[192:195], v[84:87], v[192:195]
  ds_read_b64_tr_b16 a[226:227], v11 offset:8
  ds_read_b64_tr_b16 a[232:233], v11 offset:64
  v_mfma_f32_16x16x32_bf16 v[196:199], a[198:201], v[84:87], v[196:199]
  v_exp_f32 v29, v93
  v_mfma_f32_16x16x32_bf16 v[200:203], a[204:207], v[84:87], v[200:203]
  ds_read_b64_tr_b16 a[238:239], v11 offset:72
  v_fma_f32 v93, v71, s30, v27
  v_mfma_f32_16x16x32_bf16 v[204:207], a[210:213], v[84:87], v[204:207]
  ds_read_b64_tr_b16 a[194:195], v8 offset:0
  v_cvt_pk_bf16_f32 v90, v28, v29
  v_mfma_f32_16x16x32_bf16 v[208:211], a[216:219], v[84:87], v[208:211]
  v_exp_f32 v30, v92
  v_mfma_f32_16x16x32_bf16 v[212:215], a[222:225], v[84:87], v[212:215]
  ds_read_b64_tr_b16 a[200:201], v8 offset:8
  v_fma_f32 v92, v52, s30, v23
  v_mfma_f32_16x16x32_bf16 v[216:219], a[228:231], v[84:87], v[216:219]
  ds_read_b64_tr_b16 a[206:207], v8 offset:64
  ds_read_b64_tr_b16 a[212:213], v8 offset:72
  v_mfma_f32_16x16x32_bf16 v[220:223], a[234:237], v[84:87], v[220:223]
  v_exp_f32 v31, v93
  v_mfma_f32_16x16x32_bf16 v[60:63], a[160:163], a[16:19], 0
  ds_read_b64_tr_b16 a[218:219], v9 offset:0
  v_cvt_pk_bf16_f32 v91, v30, v31
  v_mfma_f32_16x16x32_bf16 v[60:63], a[164:167], a[20:23], v[60:63]
  ds_read_b64_tr_b16 a[224:225], v9 offset:8
  ds_read_b64_tr_b16 a[230:231], v9 offset:64
  v_mfma_f32_16x16x32_bf16 v[60:63], a[168:171], a[24:27], v[60:63]
  ds_read_b64_tr_b16 a[236:237], v9 offset:72
  v_fma_f32 v93, v53, s30, v23
  v_mfma_f32_16x16x32_bf16 v[60:63], a[172:175], a[28:31], v[60:63]
  v_exp_f32 v28, v92
  v_mfma_f32_16x16x32_bf16 v[64:67], a[176:179], a[16:19], 0
  s_add_u32 m0, s24, 25344
  v_fma_f32 v92, v54, s30, v23
  v_mfma_f32_16x16x32_bf16 v[64:67], a[180:183], a[20:23], v[64:67]
  v_exp_f32 v29, v93
  v_mfma_f32_16x16x32_bf16 v[64:67], a[184:187], a[24:27], v[64:67]
  v_fma_f32 v93, v55, s30, v23
  v_cvt_pk_bf16_f32 v72, v28, v29
  v_mfma_f32_16x16x32_bf16 v[64:67], a[188:191], a[28:31], v[64:67]
  v_exp_f32 v30, v92
  v_mfma_f32_16x16x32_bf16 v[48:51], a[240:243], v[88:91], v[48:51]
  s_xor_b32 s33, s27, 81920
  v_fma_f32 v92, v56, s30, v23
  s_waitcnt lgkmcnt(0)
  v_mfma_f32_16x16x32_bf16 v[224:227], a[192:195], v[88:91], v[224:227]
  v_exp_f32 v31, v93
  v_mfma_f32_16x16x32_bf16 v[228:231], a[198:201], v[88:91], v[228:231]
  v_fma_f32 v93, v57, s30, v23
  v_cvt_pk_bf16_f32 v73, v30, v31
  v_mfma_f32_16x16x32_bf16 v[232:235], a[204:207], v[88:91], v[232:235]
  v_exp_f32 v28, v92
  v_mfma_f32_16x16x32_bf16 v[236:239], a[210:213], v[88:91], v[236:239]
  buffer_load_dwordx4 v2, s[12:15], s33 offen nt lds
  v_fma_f32 v92, v58, s30, v23
  v_mfma_f32_16x16x32_bf16 v[240:243], a[216:219], v[88:91], v[240:243]
  v_exp_f32 v29, v93
  v_mfma_f32_16x16x32_bf16 v[244:247], a[222:225], v[88:91], v[244:247]
  v_fma_f32 v93, v59, s30, v23
  v_cvt_pk_bf16_f32 v74, v28, v29
  v_mfma_f32_16x16x32_bf16 v[248:251], a[228:231], v[88:91], v[248:251]
  v_exp_f32 v30, v92
  v_mfma_f32_16x16x32_bf16 v[252:255], a[234:237], v[88:91], v[252:255]
  buffer_load_dwordx4 v3, s[12:15], s33 offen offset:1024 nt lds
  v_fma_f32 v92, v60, s30, v24
  v_mfma_f32_16x16x32_bf16 v[52:55], a[160:163], a[32:35], 0
  v_exp_f32 v31, v93
  v_mfma_f32_16x16x32_bf16 v[52:55], a[164:167], a[36:39], v[52:55]
  v_cvt_pk_bf16_f32 v75, v30, v31
  v_fma_f32 v93, v61, s30, v24
  v_mfma_f32_16x16x32_bf16 v[52:55], a[168:171], a[40:43], v[52:55]
  v_exp_f32 v28, v92
  v_mfma_f32_16x16x32_bf16 v[52:55], a[172:175], a[44:47], v[52:55]
  s_add_u32 m0, s25, 24960
  v_fma_f32 v92, v62, s30, v24
  v_mfma_f32_16x16x32_bf16 v[56:59], a[176:179], a[32:35], 0
  v_exp_f32 v29, v93
  v_mfma_f32_16x16x32_bf16 v[56:59], a[180:183], a[36:39], v[56:59]
  v_fma_f32 v93, v63, s30, v24
  v_cvt_pk_bf16_f32 v76, v28, v29
  v_mfma_f32_16x16x32_bf16 v[56:59], a[184:187], a[40:43], v[56:59]
  v_exp_f32 v30, v92
  v_mfma_f32_16x16x32_bf16 v[56:59], a[188:191], a[44:47], v[56:59]
  buffer_load_dwordx4 v4, s[16:19], s33 offen nt lds
  v_fma_f32 v92, v64, s30, v24
  v_mfma_f32_16x16x32_bf16 v[32:35], a[240:243], v[72:75], v[32:35]
  buffer_load_dwordx4 v5, s[16:19], s33 offen offset:1024 nt lds
  v_exp_f32 v31, v93
  v_mfma_f32_16x16x32_bf16 v[96:99], a[194:197], v[72:75], v[96:99]
  v_fma_f32 v93, v65, s30, v24
  v_cvt_pk_bf16_f32 v77, v30, v31
  v_mfma_f32_16x16x32_bf16 v[100:103], a[200:203], v[72:75], v[100:103]
  v_exp_f32 v28, v92
  v_mfma_f32_16x16x32_bf16 v[104:107], a[206:209], v[72:75], v[104:107]
  v_fma_f32 v92, v66, s30, v24
  v_exp_f32 v29, v93
  v_mfma_f32_16x16x32_bf16 v[108:111], a[212:215], v[72:75], v[108:111]
  v_fma_f32 v93, v67, s30, v24
  v_cvt_pk_bf16_f32 v78, v28, v29
  v_mfma_f32_16x16x32_bf16 v[112:115], a[218:221], v[72:75], v[112:115]
  v_exp_f32 v30, v92
  v_mfma_f32_16x16x32_bf16 v[116:119], a[224:227], v[72:75], v[116:119]
  v_fma_f32 v92, v52, s30, v25
  v_exp_f32 v31, v93
  v_mfma_f32_16x16x32_bf16 v[120:123], a[230:233], v[72:75], v[120:123]
  v_cvt_pk_bf16_f32 v79, v30, v31
  v_fma_f32 v93, v53, s30, v25
  v_mfma_f32_16x16x32_bf16 v[124:127], a[236:239], v[72:75], v[124:127]
  v_exp_f32 v28, v92
  s_waitcnt vmcnt(8)
  s_barrier
  v_mfma_f32_16x16x32_bf16 v[60:63], a[160:163], a[48:51], 0
  ds_read_b128 a[160:163], v6 offset:8448
  v_fma_f32 v92, v54, s30, v25
  v_mfma_f32_16x16x32_bf16 v[60:63], a[164:167], a[52:55], v[60:63]
  v_exp_f32 v29, v93
  v_mfma_f32_16x16x32_bf16 v[60:63], a[168:171], a[56:59], v[60:63]
  v_fma_f32 v93, v55, s30, v25
  v_cvt_pk_bf16_f32 v80, v28, v29
  v_mfma_f32_16x16x32_bf16 v[60:63], a[172:175], a[60:63], v[60:63]
  v_exp_f32 v30, v92
  v_mfma_f32_16x16x32_bf16 v[64:67], a[176:179], a[48:51], 0
  ds_read_b128 a[164:167], v6 offset:8512
  v_fma_f32 v92, v56, s30, v25
  v_mfma_f32_16x16x32_bf16 v[64:67], a[180:183], a[52:55], v[64:67]
  v_exp_f32 v31, v93
  v_mfma_f32_16x16x32_bf16 v[64:67], a[184:187], a[56:59], v[64:67]
  ds_read_b128 a[168:171], v6 offset:8576
  v_fma_f32 v93, v57, s30, v25
  v_mfma_f32_16x16x32_bf16 v[64:67], a[188:191], a[60:63], v[64:67]
  ds_read_b128 a[172:175], v6 offset:8640
  v_cvt_pk_bf16_f32 v81, v30, v31
  v_mfma_f32_16x16x32_bf16 v[36:39], a[240:243], v[76:79], v[36:39]
  v_exp_f32 v28, v92
  v_mfma_f32_16x16x32_bf16 v[128:131], a[194:197], v[76:79], v[128:131]
  ds_read_b128 a[176:179], v7 offset:8448
  v_fma_f32 v92, v58, s30, v25
  v_mfma_f32_16x16x32_bf16 v[132:135], a[200:203], v[76:79], v[132:135]
  v_exp_f32 v29, v93
  v_mfma_f32_16x16x32_bf16 v[136:139], a[206:209], v[76:79], v[136:139]
  v_fma_f32 v93, v59, s30, v25
  v_cvt_pk_bf16_f32 v82, v28, v29
  v_mfma_f32_16x16x32_bf16 v[140:143], a[212:215], v[76:79], v[140:143]
  v_exp_f32 v30, v92
  v_mfma_f32_16x16x32_bf16 v[144:147], a[218:221], v[76:79], v[144:147]
  ds_read_b128 a[180:183], v7 offset:8512
  v_fma_f32 v92, v60, s30, v26
  v_mfma_f32_16x16x32_bf16 v[148:151], a[224:227], v[76:79], v[148:151]
  v_exp_f32 v31, v93
  v_mfma_f32_16x16x32_bf16 v[152:155], a[230:233], v[76:79], v[152:155]
  v_cvt_pk_bf16_f32 v83, v30, v31
  v_fma_f32 v93, v61, s30, v26
  v_mfma_f32_16x16x32_bf16 v[156:159], a[236:239], v[76:79], v[156:159]
  v_exp_f32 v28, v92
  s_waitcnt lgkmcnt(1)
  v_mfma_f32_16x16x32_bf16 v[68:71], a[160:163], a[128:131], 0
  ds_read_b128 a[184:187], v7 offset:8576
  v_fma_f32 v92, v62, s30, v26
  v_mfma_f32_16x16x32_bf16 v[68:71], a[164:167], a[132:135], v[68:71]
  v_exp_f32 v29, v93
  v_mfma_f32_16x16x32_bf16 v[68:71], a[168:171], a[136:139], v[68:71]
  v_fma_f32 v93, v63, s30, v26
  v_cvt_pk_bf16_f32 v84, v28, v29
  v_mfma_f32_16x16x32_bf16 v[68:71], a[172:175], a[140:143], v[68:71]
  v_exp_f32 v30, v92
  v_mfma_f32_16x16x32_bf16 v[40:43], a[240:243], v[80:83], v[40:43]
  ds_read_b128 a[188:191], v7 offset:8640
  v_fma_f32 v92, v64, s30, v26
  v_mfma_f32_16x16x32_bf16 v[160:163], a[194:197], v[80:83], v[160:163]
  v_exp_f32 v31, v93
  v_mfma_f32_16x16x32_bf16 v[164:167], a[200:203], v[80:83], v[164:167]
  v_fma_f32 v93, v65, s30, v26
  v_cvt_pk_bf16_f32 v85, v30, v31
  v_mfma_f32_16x16x32_bf16 v[168:171], a[206:209], v[80:83], v[168:171]
  v_exp_f32 v28, v92
  v_mfma_f32_16x16x32_bf16 v[172:175], a[212:215], v[80:83], v[172:175]
  ds_read_b64_tr_b16 a[192:193], v8 offset:8320
  v_fma_f32 v92, v66, s30, v26
  v_mfma_f32_16x16x32_bf16 v[176:179], a[218:221], v[80:83], v[176:179]
  v_exp_f32 v29, v93
  v_mfma_f32_16x16x32_bf16 v[180:183], a[224:227], v[80:83], v[180:183]
  v_fma_f32 v93, v67, s30, v26
  v_cvt_pk_bf16_f32 v86, v28, v29
  v_mfma_f32_16x16x32_bf16 v[184:187], a[230:233], v[80:83], v[184:187]
  v_exp_f32 v30, v92
  v_mfma_f32_16x16x32_bf16 v[188:191], a[236:239], v[80:83], v[188:191]
  ds_read_b64_tr_b16 a[198:199], v8 offset:8328
  v_fma_f32 v92, v68, s30, v27
  v_mfma_f32_16x16x32_bf16 v[52:55], a[160:163], a[0:3], 0
  v_exp_f32 v31, v93
  v_mfma_f32_16x16x32_bf16 v[52:55], a[164:167], a[4:7], v[52:55]
  v_cvt_pk_bf16_f32 v87, v30, v31
  v_fma_f32 v93, v69, s30, v27
  v_mfma_f32_16x16x32_bf16 v[52:55], a[168:171], a[8:11], v[52:55]
  v_exp_f32 v28, v92
  v_mfma_f32_16x16x32_bf16 v[52:55], a[172:175], a[12:15], v[52:55]
  ds_read_b64_tr_b16 a[204:205], v8 offset:8384
  v_fma_f32 v92, v70, s30, v27
  v_mfma_f32_16x16x32_bf16 v[56:59], a[176:179], a[0:3], 0
  v_exp_f32 v29, v93
  s_waitcnt lgkmcnt(2)
  v_mfma_f32_16x16x32_bf16 v[56:59], a[180:183], a[4:7], v[56:59]
  v_fma_f32 v93, v71, s30, v27
  v_cvt_pk_bf16_f32 v88, v28, v29
  v_mfma_f32_16x16x32_bf16 v[56:59], a[184:187], a[8:11], v[56:59]
  v_exp_f32 v30, v92
  v_mfma_f32_16x16x32_bf16 v[56:59], a[188:191], a[12:15], v[56:59]
  ds_read_b64_tr_b16 a[210:211], v8 offset:8392
  v_fma_f32 v92, v52, s30, v23
  v_mfma_f32_16x16x32_bf16 v[44:47], a[240:243], v[84:87], v[44:47]
  v_exp_f32 v31, v93
  v_mfma_f32_16x16x32_bf16 v[192:195], a[194:197], v[84:87], v[192:195]
  v_cvt_pk_bf16_f32 v89, v30, v31
  v_fma_f32 v93, v53, s30, v23
  v_mfma_f32_16x16x32_bf16 v[196:199], a[200:203], v[84:87], v[196:199]
  v_exp_f32 v28, v92
  v_mfma_f32_16x16x32_bf16 v[200:203], a[206:209], v[84:87], v[200:203]
  ds_read_b64_tr_b16 a[216:217], v9 offset:8320
  v_fma_f32 v92, v54, s30, v23
  v_mfma_f32_16x16x32_bf16 v[204:207], a[212:215], v[84:87], v[204:207]
  v_exp_f32 v29, v93
  v_mfma_f32_16x16x32_bf16 v[208:211], a[218:221], v[84:87], v[208:211]
  v_fma_f32 v93, v55, s30, v23
  v_cvt_pk_bf16_f32 v72, v28, v29
  v_mfma_f32_16x16x32_bf16 v[212:215], a[224:227], v[84:87], v[212:215]
  v_exp_f32 v30, v92
  v_mfma_f32_16x16x32_bf16 v[216:219], a[230:233], v[84:87], v[216:219]
  ds_read_b64_tr_b16 a[222:223], v9 offset:8328
  v_fma_f32 v92, v56, s30, v23
  v_mfma_f32_16x16x32_bf16 v[220:223], a[236:239], v[84:87], v[220:223]
  v_exp_f32 v31, v93
  v_mfma_f32_16x16x32_bf16 v[60:63], a[160:163], a[16:19], 0
  v_fma_f32 v93, v57, s30, v23
  v_cvt_pk_bf16_f32 v73, v30, v31
  v_mfma_f32_16x16x32_bf16 v[60:63], a[164:167], a[20:23], v[60:63]
  v_exp_f32 v28, v92
  v_mfma_f32_16x16x32_bf16 v[60:63], a[168:171], a[24:27], v[60:63]
  ds_read_b64_tr_b16 a[228:229], v9 offset:8384
  v_fma_f32 v92, v58, s30, v23
  v_mfma_f32_16x16x32_bf16 v[60:63], a[172:175], a[28:31], v[60:63]
  v_exp_f32 v29, v93
  v_mfma_f32_16x16x32_bf16 v[64:67], a[176:179], a[16:19], 0
  ds_read_b64_tr_b16 a[234:235], v9 offset:8392
  v_fma_f32 v93, v59, s30, v23
  v_mfma_f32_16x16x32_bf16 v[64:67], a[180:183], a[20:23], v[64:67]
  ds_read_b64_tr_b16 a[194:195], v10 offset:8320
  v_cvt_pk_bf16_f32 v74, v28, v29
  v_mfma_f32_16x16x32_bf16 v[64:67], a[184:187], a[24:27], v[64:67]
  v_exp_f32 v30, v92
  v_mfma_f32_16x16x32_bf16 v[64:67], a[188:191], a[28:31], v[64:67]
  ds_read_b64_tr_b16 a[200:201], v10 offset:8328
  v_fma_f32 v92, v60, s30, v24
  v_mfma_f32_16x16x32_bf16 v[52:55], a[160:163], a[32:35], 0
  ds_read_b64_tr_b16 a[206:207], v10 offset:8384
  ds_read_b64_tr_b16 a[212:213], v10 offset:8392
  v_mfma_f32_16x16x32_bf16 v[52:55], a[164:167], a[36:39], v[52:55]
  v_exp_f32 v31, v93
  v_mfma_f32_16x16x32_bf16 v[52:55], a[168:171], a[40:43], v[52:55]
  ds_read_b64_tr_b16 a[218:219], v11 offset:8320
  v_cvt_pk_bf16_f32 v75, v30, v31
  v_mfma_f32_16x16x32_bf16 v[52:55], a[172:175], a[44:47], v[52:55]
  ds_read_b64_tr_b16 a[224:225], v11 offset:8328
  ds_read_b64_tr_b16 a[230:231], v11 offset:8384
  v_mfma_f32_16x16x32_bf16 v[56:59], a[176:179], a[32:35], 0
  ds_read_b64_tr_b16 a[236:237], v11 offset:8392
  v_fma_f32 v93, v61, s30, v24
  v_mfma_f32_16x16x32_bf16 v[56:59], a[180:183], a[36:39], v[56:59]
  v_exp_f32 v28, v92
  v_mfma_f32_16x16x32_bf16 v[56:59], a[184:187], a[40:43], v[56:59]
  s_add_u32 m0, s24, 33792
  v_fma_f32 v92, v62, s30, v24
  v_mfma_f32_16x16x32_bf16 v[56:59], a[188:191], a[44:47], v[56:59]
  v_exp_f32 v29, v93
  v_mfma_f32_16x16x32_bf16 v[32:35], a[240:243], v[72:75], v[32:35]
  s_xor_b32 s33, s27, 90112
  v_fma_f32 v93, v63, s30, v24
  s_waitcnt lgkmcnt(3)
  v_mfma_f32_16x16x32_bf16 v[96:99], a[192:195], v[72:75], v[96:99]
  buffer_load_dwordx4 v2, s[12:15], s33 offen nt lds
  v_cvt_pk_bf16_f32 v76, v28, v29
  v_mfma_f32_16x16x32_bf16 v[100:103], a[198:201], v[72:75], v[100:103]
  buffer_load_dwordx4 v3, s[12:15], s33 offen offset:1024 nt lds
  s_add_u32 m0, s25, 33280
  v_mfma_f32_16x16x32_bf16 v[104:107], a[204:207], v[72:75], v[104:107]
  v_exp_f32 v30, v92
  v_mfma_f32_16x16x32_bf16 v[108:111], a[210:213], v[72:75], v[108:111]
  buffer_load_dwordx4 v4, s[16:19], s33 offen nt lds
  v_fma_f32 v92, v64, s30, v24
  v_mfma_f32_16x16x32_bf16 v[112:115], a[216:219], v[72:75], v[112:115]
  buffer_load_dwordx4 v5, s[16:19], s33 offen offset:1024 nt lds
  v_exp_f32 v31, v93
  s_waitcnt lgkmcnt(0)
  v_mfma_f32_16x16x32_bf16 v[116:119], a[222:225], v[72:75], v[116:119]
  v_fma_f32 v93, v65, s30, v24
  v_cvt_pk_bf16_f32 v77, v30, v31
  v_mfma_f32_16x16x32_bf16 v[120:123], a[228:231], v[72:75], v[120:123]
  v_exp_f32 v28, v92
  v_mfma_f32_16x16x32_bf16 v[124:127], a[234:237], v[72:75], v[124:127]
  v_fma_f32 v92, v66, s30, v24
  v_exp_f32 v29, v93
  s_waitcnt vmcnt(8)
  s_barrier
  v_mfma_f32_16x16x32_bf16 v[60:63], a[160:163], a[48:51], 0
  v_fma_f32 v93, v67, s30, v24
  v_cvt_pk_bf16_f32 v78, v28, v29
  v_mfma_f32_16x16x32_bf16 v[60:63], a[164:167], a[52:55], v[60:63]
  v_exp_f32 v30, v92
  v_mfma_f32_16x16x32_bf16 v[60:63], a[168:171], a[56:59], v[60:63]
  ds_read_b128 a[160:163], v6 offset:16896
  v_fma_f32 v92, v52, s30, v25
  v_mfma_f32_16x16x32_bf16 v[60:63], a[172:175], a[60:63], v[60:63]
  v_exp_f32 v31, v93
  v_mfma_f32_16x16x32_bf16 v[64:67], a[176:179], a[48:51], 0
  v_cvt_pk_bf16_f32 v79, v30, v31
  v_fma_f32 v93, v53, s30, v25
  v_mfma_f32_16x16x32_bf16 v[64:67], a[180:183], a[52:55], v[64:67]
  v_exp_f32 v28, v92
  v_mfma_f32_16x16x32_bf16 v[64:67], a[184:187], a[56:59], v[64:67]
  ds_read_b128 a[164:167], v6 offset:16960
  v_fma_f32 v92, v54, s30, v25
  v_mfma_f32_16x16x32_bf16 v[64:67], a[188:191], a[60:63], v[64:67]
  v_exp_f32 v29, v93
  v_mfma_f32_16x16x32_bf16 v[36:39], a[240:243], v[76:79], v[36:39]
  v_fma_f32 v93, v55, s30, v25
  v_cvt_pk_bf16_f32 v80, v28, v29
  v_mfma_f32_16x16x32_bf16 v[128:131], a[192:195], v[76:79], v[128:131]
  v_exp_f32 v30, v92
  v_mfma_f32_16x16x32_bf16 v[132:135], a[198:201], v[76:79], v[132:135]
  ds_read_b128 a[168:171], v6 offset:17024
  v_fma_f32 v92, v56, s30, v25
  v_mfma_f32_16x16x32_bf16 v[136:139], a[204:207], v[76:79], v[136:139]
  v_exp_f32 v31, v93
  v_mfma_f32_16x16x32_bf16 v[140:143], a[210:213], v[76:79], v[140:143]
  v_fma_f32 v93, v57, s30, v25
  v_cvt_pk_bf16_f32 v81, v30, v31
  v_mfma_f32_16x16x32_bf16 v[144:147], a[216:219], v[76:79], v[144:147]
  ds_read_b128 a[172:175], v6 offset:17088
  ds_read_b128 a[176:179], v7 offset:16896
  v_mfma_f32_16x16x32_bf16 v[148:151], a[222:225], v[76:79], v[148:151]
  v_exp_f32 v28, v92
  v_fma_f32 v92, v58, s30, v25
  v_mfma_f32_16x16x32_bf16 v[152:155], a[228:231], v[76:79], v[152:155]
  v_exp_f32 v29, v93
  v_fma_f32 v93, v59, s30, v25
  v_mfma_f32_16x16x32_bf16 v[156:159], a[234:237], v[76:79], v[156:159]
  v_cvt_pk_bf16_f32 v82, v28, v29
  v_exp_f32 v30, v92
  s_waitcnt lgkmcnt(2)
  v_mfma_f32_16x16x32_bf16 v[68:71], a[160:163], a[128:131], 0
  v_fma_f32 v92, v60, s30, v26
  v_exp_f32 v31, v93
  v_mfma_f32_16x16x32_bf16 v[68:71], a[164:167], a[132:135], v[68:71]
  v_cvt_pk_bf16_f32 v83, v30, v31
  v_fma_f32 v93, v61, s30, v26
  v_mfma_f32_16x16x32_bf16 v[68:71], a[168:171], a[136:139], v[68:71]
  v_exp_f32 v28, v92
  s_waitcnt lgkmcnt(0)
  v_mfma_f32_16x16x32_bf16 v[68:71], a[172:175], a[140:143], v[68:71]
  ds_read_b128 a[180:183], v7 offset:16960
  v_fma_f32 v92, v62, s30, v26
  v_mfma_f32_16x16x32_bf16 v[40:43], a[240:243], v[80:83], v[40:43]
  v_exp_f32 v29, v93
  v_mfma_f32_16x16x32_bf16 v[160:163], a[192:195], v[80:83], v[160:163]
  v_fma_f32 v93, v63, s30, v26
  v_cvt_pk_bf16_f32 v84, v28, v29
  v_mfma_f32_16x16x32_bf16 v[164:167], a[198:201], v[80:83], v[164:167]
  v_exp_f32 v30, v92
  v_mfma_f32_16x16x32_bf16 v[168:171], a[204:207], v[80:83], v[168:171]
  ds_read_b128 a[184:187], v7 offset:17024
  v_fma_f32 v92, v64, s30, v26
  v_mfma_f32_16x16x32_bf16 v[172:175], a[210:213], v[80:83], v[172:175]
  v_exp_f32 v31, v93
  v_mfma_f32_16x16x32_bf16 v[176:179], a[216:219], v[80:83], v[176:179]
  v_fma_f32 v93, v65, s30, v26
  v_cvt_pk_bf16_f32 v85, v30, v31
  v_mfma_f32_16x16x32_bf16 v[180:183], a[222:225], v[80:83], v[180:183]
  ds_read_b128 a[188:191], v7 offset:17088
  ds_read_b64_tr_b16 a[196:197], v10 offset:16640
  v_mfma_f32_16x16x32_bf16 v[184:187], a[228:231], v[80:83], v[184:187]
  v_exp_f32 v28, v92
  v_mfma_f32_16x16x32_bf16 v[188:191], a[234:237], v[80:83], v[188:191]
  ds_read_b64_tr_b16 a[202:203], v10 offset:16648
  v_fma_f32 v92, v66, s30, v26
  v_mfma_f32_16x16x32_bf16 v[52:55], a[160:163], a[0:3], 0
  v_exp_f32 v29, v93
  v_mfma_f32_16x16x32_bf16 v[52:55], a[164:167], a[4:7], v[52:55]
  v_fma_f32 v93, v67, s30, v26
  v_cvt_pk_bf16_f32 v86, v28, v29
  v_mfma_f32_16x16x32_bf16 v[52:55], a[168:171], a[8:11], v[52:55]
  v_exp_f32 v30, v92
  v_mfma_f32_16x16x32_bf16 v[52:55], a[172:175], a[12:15], v[52:55]
  ds_read_b64_tr_b16 a[208:209], v10 offset:16704
  v_fma_f32 v92, v68, s30, v27
  v_mfma_f32_16x16x32_bf16 v[56:59], a[176:179], a[0:3], 0
  v_exp_f32 v31, v93
  s_waitcnt lgkmcnt(2)
  v_mfma_f32_16x16x32_bf16 v[56:59], a[180:183], a[4:7], v[56:59]
  v_cvt_pk_bf16_f32 v87, v30, v31
  v_fma_f32 v93, v69, s30, v27
  v_mfma_f32_16x16x32_bf16 v[56:59], a[184:187], a[8:11], v[56:59]
  ds_read_b64_tr_b16 a[214:215], v10 offset:16712
  ds_read_b64_tr_b16 a[220:221], v11 offset:16640
  v_mfma_f32_16x16x32_bf16 v[56:59], a[188:191], a[12:15], v[56:59]
  v_exp_f32 v28, v92
  v_mfma_f32_16x16x32_bf16 v[44:47], a[240:243], v[84:87], v[44:47]
  ds_read_b64_tr_b16 a[226:227], v11 offset:16648
  v_fma_f32 v92, v70, s30, v27
  v_mfma_f32_16x16x32_bf16 v[192:195], a[192:195], v[84:87], v[192:195]
  ds_read_b64_tr_b16 a[232:233], v11 offset:16704
  ds_read_b64_tr_b16 a[238:239], v11 offset:16712
  v_mfma_f32_16x16x32_bf16 v[196:199], a[198:201], v[84:87], v[196:199]
  v_exp_f32 v29, v93
  v_mfma_f32_16x16x32_bf16 v[200:203], a[204:207], v[84:87], v[200:203]
  ds_read_b64_tr_b16 a[194:195], v8 offset:16640
  v_fma_f32 v93, v71, s30, v27
  v_mfma_f32_16x16x32_bf16 v[204:207], a[210:213], v[84:87], v[204:207]
  ds_read_b64_tr_b16 a[200:201], v8 offset:16648
  v_cvt_pk_bf16_f32 v90, v28, v29
  v_mfma_f32_16x16x32_bf16 v[208:211], a[216:219], v[84:87], v[208:211]
  v_exp_f32 v30, v92
  v_mfma_f32_16x16x32_bf16 v[212:215], a[222:225], v[84:87], v[212:215]
  ds_read_b64_tr_b16 a[206:207], v8 offset:16704
  v_fma_f32 v92, v52, s30, v23
  v_mfma_f32_16x16x32_bf16 v[216:219], a[228:231], v[84:87], v[216:219]
  v_exp_f32 v31, v93
  v_mfma_f32_16x16x32_bf16 v[220:223], a[234:237], v[84:87], v[220:223]
  s_add_u32 s34, s28, 18886656
  ds_read_b64_tr_b16 a[212:213], v8 offset:16712
  v_mfma_f32_16x16x32_bf16 v[60:63], a[160:163], a[16:19], 0
  buffer_load_dwordx4 a[112:115], v12, s[8:11], s34 offen offset:0 nt
  buffer_load_dwordx4 a[116:119], v12, s[8:11], s34 offen offset:64 nt
  v_mfma_f32_16x16x32_bf16 v[60:63], a[164:167], a[20:23], v[60:63]
  ds_read_b64_tr_b16 a[218:219], v9 offset:16640
  v_cvt_pk_bf16_f32 v91, v30, v31
  v_mfma_f32_16x16x32_bf16 v[60:63], a[168:171], a[24:27], v[60:63]
  ds_read_b64_tr_b16 a[224:225], v9 offset:16648
  ds_read_b64_tr_b16 a[230:231], v9 offset:16704
  v_mfma_f32_16x16x32_bf16 v[60:63], a[172:175], a[28:31], v[60:63]
  ds_read_b64_tr_b16 a[236:237], v9 offset:16712
  v_fma_f32 v93, v53, s30, v23
  v_mfma_f32_16x16x32_bf16 v[64:67], a[176:179], a[16:19], 0
  v_exp_f32 v28, v92
  v_mfma_f32_16x16x32_bf16 v[64:67], a[180:183], a[20:23], v[64:67]
  s_add_u32 m0, s24, 42240
  v_fma_f32 v92, v54, s30, v23
  v_mfma_f32_16x16x32_bf16 v[64:67], a[184:187], a[24:27], v[64:67]
  v_exp_f32 v29, v93
  v_mfma_f32_16x16x32_bf16 v[64:67], a[188:191], a[28:31], v[64:67]
  v_fma_f32 v93, v55, s30, v23
  v_cvt_pk_bf16_f32 v72, v28, v29
  v_mfma_f32_16x16x32_bf16 v[48:51], a[240:243], v[88:91], v[48:51]
  v_exp_f32 v30, v92
  s_waitcnt lgkmcnt(1)
  v_mfma_f32_16x16x32_bf16 v[224:227], a[192:195], v[88:91], v[224:227]
  s_xor_b32 s33, s27, 98304
  v_fma_f32 v92, v56, s30, v23
  v_mfma_f32_16x16x32_bf16 v[228:231], a[198:201], v[88:91], v[228:231]
  v_exp_f32 v31, v93
  v_mfma_f32_16x16x32_bf16 v[232:235], a[204:207], v[88:91], v[232:235]
  v_fma_f32 v93, v57, s30, v23
  v_cvt_pk_bf16_f32 v73, v30, v31
  v_mfma_f32_16x16x32_bf16 v[236:239], a[210:213], v[88:91], v[236:239]
  v_exp_f32 v28, v92
  v_mfma_f32_16x16x32_bf16 v[240:243], a[216:219], v[88:91], v[240:243]
  buffer_load_dwordx4 v2, s[12:15], s33 offen nt lds
  v_fma_f32 v92, v58, s30, v23
  v_mfma_f32_16x16x32_bf16 v[244:247], a[222:225], v[88:91], v[244:247]
  v_exp_f32 v29, v93
  v_mfma_f32_16x16x32_bf16 v[248:251], a[228:231], v[88:91], v[248:251]
  v_fma_f32 v93, v59, s30, v23
  v_cvt_pk_bf16_f32 v74, v28, v29
  s_waitcnt lgkmcnt(0)
  v_mfma_f32_16x16x32_bf16 v[252:255], a[234:237], v[88:91], v[252:255]
  v_exp_f32 v30, v92
  v_mfma_f32_16x16x32_bf16 v[52:55], a[160:163], a[32:35], 0
  buffer_load_dwordx4 v3, s[12:15], s33 offen offset:1024 nt lds
  v_fma_f32 v92, v60, s30, v24
  v_mfma_f32_16x16x32_bf16 v[52:55], a[164:167], a[36:39], v[52:55]
  v_exp_f32 v31, v93
  v_mfma_f32_16x16x32_bf16 v[52:55], a[168:171], a[40:43], v[52:55]
  v_cvt_pk_bf16_f32 v75, v30, v31
  v_fma_f32 v93, v61, s30, v24
  v_mfma_f32_16x16x32_bf16 v[52:55], a[172:175], a[44:47], v[52:55]
  v_exp_f32 v28, v92
  v_mfma_f32_16x16x32_bf16 v[56:59], a[176:179], a[32:35], 0
  s_add_u32 m0, s25, 41600
  v_fma_f32 v92, v62, s30, v24
  v_mfma_f32_16x16x32_bf16 v[56:59], a[180:183], a[36:39], v[56:59]
  v_exp_f32 v29, v93
  v_mfma_f32_16x16x32_bf16 v[56:59], a[184:187], a[40:43], v[56:59]
  v_fma_f32 v93, v63, s30, v24
  v_cvt_pk_bf16_f32 v76, v28, v29
  v_mfma_f32_16x16x32_bf16 v[56:59], a[188:191], a[44:47], v[56:59]
  v_exp_f32 v30, v92
  v_mfma_f32_16x16x32_bf16 v[32:35], a[240:243], v[72:75], v[32:35]
  buffer_load_dwordx4 v4, s[16:19], s33 offen nt lds
  v_fma_f32 v92, v64, s30, v24
  v_mfma_f32_16x16x32_bf16 v[96:99], a[194:197], v[72:75], v[96:99]
  buffer_load_dwordx4 v5, s[16:19], s33 offen offset:1024 nt lds
  v_exp_f32 v31, v93
  v_mfma_f32_16x16x32_bf16 v[100:103], a[200:203], v[72:75], v[100:103]
  v_fma_f32 v93, v65, s30, v24
  v_cvt_pk_bf16_f32 v77, v30, v31
  v_mfma_f32_16x16x32_bf16 v[104:107], a[206:209], v[72:75], v[104:107]
  v_exp_f32 v28, v92
  v_mfma_f32_16x16x32_bf16 v[108:111], a[212:215], v[72:75], v[108:111]
  v_fma_f32 v92, v66, s30, v24
  v_exp_f32 v29, v93
  v_mfma_f32_16x16x32_bf16 v[112:115], a[218:221], v[72:75], v[112:115]
  v_fma_f32 v93, v67, s30, v24
  v_cvt_pk_bf16_f32 v78, v28, v29
  v_mfma_f32_16x16x32_bf16 v[116:119], a[224:227], v[72:75], v[116:119]
  v_exp_f32 v30, v92
  v_mfma_f32_16x16x32_bf16 v[120:123], a[230:233], v[72:75], v[120:123]
  v_fma_f32 v92, v52, s30, v25
  v_exp_f32 v31, v93
  v_mfma_f32_16x16x32_bf16 v[124:127], a[236:239], v[72:75], v[124:127]
  v_cvt_pk_bf16_f32 v79, v30, v31
  v_fma_f32 v93, v53, s30, v25
  s_waitcnt vmcnt(10)
  s_barrier
  v_mfma_f32_16x16x32_bf16 v[60:63], a[160:163], a[48:51], 0
  v_exp_f32 v28, v92
  v_mfma_f32_16x16x32_bf16 v[60:63], a[164:167], a[52:55], v[60:63]
  ds_read_b128 a[160:163], v6 offset:25344
  v_fma_f32 v92, v54, s30, v25
  v_mfma_f32_16x16x32_bf16 v[60:63], a[168:171], a[56:59], v[60:63]
  v_exp_f32 v29, v93
  v_mfma_f32_16x16x32_bf16 v[60:63], a[172:175], a[60:63], v[60:63]
  v_fma_f32 v93, v55, s30, v25
  v_cvt_pk_bf16_f32 v80, v28, v29
  v_mfma_f32_16x16x32_bf16 v[64:67], a[176:179], a[48:51], 0
  v_exp_f32 v30, v92
  v_mfma_f32_16x16x32_bf16 v[64:67], a[180:183], a[52:55], v[64:67]
  ds_read_b128 a[164:167], v6 offset:25408
  v_fma_f32 v92, v56, s30, v25
  v_mfma_f32_16x16x32_bf16 v[64:67], a[184:187], a[56:59], v[64:67]
  v_exp_f32 v31, v93
  v_mfma_f32_16x16x32_bf16 v[64:67], a[188:191], a[60:63], v[64:67]
  ds_read_b128 a[168:171], v6 offset:25472
  v_fma_f32 v93, v57, s30, v25
  v_mfma_f32_16x16x32_bf16 v[36:39], a[240:243], v[76:79], v[36:39]
  ds_read_b128 a[172:175], v6 offset:25536
  v_cvt_pk_bf16_f32 v81, v30, v31
  v_mfma_f32_16x16x32_bf16 v[128:131], a[194:197], v[76:79], v[128:131]
  v_exp_f32 v28, v92
  v_mfma_f32_16x16x32_bf16 v[132:135], a[200:203], v[76:79], v[132:135]
  ds_read_b128 a[176:179], v7 offset:25344
  v_fma_f32 v92, v58, s30, v25
  v_mfma_f32_16x16x32_bf16 v[136:139], a[206:209], v[76:79], v[136:139]
  v_exp_f32 v29, v93
  v_mfma_f32_16x16x32_bf16 v[140:143], a[212:215], v[76:79], v[140:143]
  v_fma_f32 v93, v59, s30, v25
  v_cvt_pk_bf16_f32 v82, v28, v29
  v_mfma_f32_16x16x32_bf16 v[144:147], a[218:221], v[76:79], v[144:147]
  v_exp_f32 v30, v92
  v_mfma_f32_16x16x32_bf16 v[148:151], a[224:227], v[76:79], v[148:151]
  ds_read_b128 a[180:183], v7 offset:25408
  v_fma_f32 v92, v60, s30, v26
  v_mfma_f32_16x16x32_bf16 v[152:155], a[230:233], v[76:79], v[152:155]
  v_exp_f32 v31, v93
  v_mfma_f32_16x16x32_bf16 v[156:159], a[236:239], v[76:79], v[156:159]
  v_cvt_pk_bf16_f32 v83, v30, v31
  v_fma_f32 v93, v61, s30, v26
  s_waitcnt lgkmcnt(1)
  v_mfma_f32_16x16x32_bf16 v[68:71], a[160:163], a[128:131], 0
  v_exp_f32 v28, v92
  v_mfma_f32_16x16x32_bf16 v[68:71], a[164:167], a[132:135], v[68:71]
  ds_read_b128 a[184:187], v7 offset:25472
  v_fma_f32 v92, v62, s30, v26
  v_mfma_f32_16x16x32_bf16 v[68:71], a[168:171], a[136:139], v[68:71]
  v_exp_f32 v29, v93
  v_mfma_f32_16x16x32_bf16 v[68:71], a[172:175], a[140:143], v[68:71]
  v_fma_f32 v93, v63, s30, v26
  v_cvt_pk_bf16_f32 v84, v28, v29
  v_mfma_f32_16x16x32_bf16 v[40:43], a[240:243], v[80:83], v[40:43]
  v_exp_f32 v30, v92
  v_mfma_f32_16x16x32_bf16 v[160:163], a[194:197], v[80:83], v[160:163]
  ds_read_b128 a[188:191], v7 offset:25536
  v_fma_f32 v92, v64, s30, v26
  v_mfma_f32_16x16x32_bf16 v[164:167], a[200:203], v[80:83], v[164:167]
  v_exp_f32 v31, v93
  v_mfma_f32_16x16x32_bf16 v[168:171], a[206:209], v[80:83], v[168:171]
  v_fma_f32 v93, v65, s30, v26
  v_cvt_pk_bf16_f32 v85, v30, v31
  v_mfma_f32_16x16x32_bf16 v[172:175], a[212:215], v[80:83], v[172:175]
  v_exp_f32 v28, v92
  v_mfma_f32_16x16x32_bf16 v[176:179], a[218:221], v[80:83], v[176:179]
  ds_read_b64_tr_b16 a[192:193], v8 offset:24960
  v_fma_f32 v92, v66, s30, v26
  v_mfma_f32_16x16x32_bf16 v[180:183], a[224:227], v[80:83], v[180:183]
  v_exp_f32 v29, v93
  v_mfma_f32_16x16x32_bf16 v[184:187], a[230:233], v[80:83], v[184:187]
  v_fma_f32 v93, v67, s30, v26
  v_cvt_pk_bf16_f32 v86, v28, v29
  v_mfma_f32_16x16x32_bf16 v[188:191], a[236:239], v[80:83], v[188:191]
  v_exp_f32 v30, v92
  v_mfma_f32_16x16x32_bf16 v[52:55], a[160:163], a[0:3], 0
  ds_read_b64_tr_b16 a[198:199], v8 offset:24968
  v_fma_f32 v92, v68, s30, v27
  v_mfma_f32_16x16x32_bf16 v[52:55], a[164:167], a[4:7], v[52:55]
  v_exp_f32 v31, v93
  v_mfma_f32_16x16x32_bf16 v[52:55], a[168:171], a[8:11], v[52:55]
  v_cvt_pk_bf16_f32 v87, v30, v31
  v_fma_f32 v93, v69, s30, v27
  v_mfma_f32_16x16x32_bf16 v[52:55], a[172:175], a[12:15], v[52:55]
  v_exp_f32 v28, v92
  v_mfma_f32_16x16x32_bf16 v[56:59], a[176:179], a[0:3], 0
  ds_read_b64_tr_b16 a[204:205], v8 offset:25024
  v_fma_f32 v92, v70, s30, v27
  s_waitcnt lgkmcnt(2)
  v_mfma_f32_16x16x32_bf16 v[56:59], a[180:183], a[4:7], v[56:59]
  v_exp_f32 v29, v93
  v_mfma_f32_16x16x32_bf16 v[56:59], a[184:187], a[8:11], v[56:59]
  v_fma_f32 v93, v71, s30, v27
  v_cvt_pk_bf16_f32 v88, v28, v29
  v_mfma_f32_16x16x32_bf16 v[56:59], a[188:191], a[12:15], v[56:59]
  v_exp_f32 v30, v92
  v_mfma_f32_16x16x32_bf16 v[44:47], a[240:243], v[84:87], v[44:47]
  ds_read_b64_tr_b16 a[210:211], v8 offset:25032
  v_fma_f32 v92, v52, s30, v23
  v_mfma_f32_16x16x32_bf16 v[192:195], a[194:197], v[84:87], v[192:195]
  v_exp_f32 v31, v93
  v_mfma_f32_16x16x32_bf16 v[196:199], a[200:203], v[84:87], v[196:199]
  v_cvt_pk_bf16_f32 v89, v30, v31
  v_fma_f32 v93, v53, s30, v23
  v_mfma_f32_16x16x32_bf16 v[200:203], a[206:209], v[84:87], v[200:203]
  v_exp_f32 v28, v92
  v_mfma_f32_16x16x32_bf16 v[204:207], a[212:215], v[84:87], v[204:207]
  ds_read_b64_tr_b16 a[216:217], v9 offset:24960
  v_fma_f32 v92, v54, s30, v23
  v_mfma_f32_16x16x32_bf16 v[208:211], a[218:221], v[84:87], v[208:211]
  v_exp_f32 v29, v93
  v_mfma_f32_16x16x32_bf16 v[212:215], a[224:227], v[84:87], v[212:215]
  v_fma_f32 v93, v55, s30, v23
  v_cvt_pk_bf16_f32 v72, v28, v29
  v_mfma_f32_16x16x32_bf16 v[216:219], a[230:233], v[84:87], v[216:219]
  v_exp_f32 v30, v92
  v_mfma_f32_16x16x32_bf16 v[220:223], a[236:239], v[84:87], v[220:223]
  ds_read_b64_tr_b16 a[222:223], v9 offset:24968
  v_fma_f32 v92, v56, s30, v23
  v_mfma_f32_16x16x32_bf16 v[60:63], a[160:163], a[16:19], 0
  v_exp_f32 v31, v93
  v_mfma_f32_16x16x32_bf16 v[60:63], a[164:167], a[20:23], v[60:63]
  v_fma_f32 v93, v57, s30, v23
  v_cvt_pk_bf16_f32 v73, v30, v31
  v_mfma_f32_16x16x32_bf16 v[60:63], a[168:171], a[24:27], v[60:63]
  v_exp_f32 v28, v92
  v_mfma_f32_16x16x32_bf16 v[60:63], a[172:175], a[28:31], v[60:63]
  ds_read_b64_tr_b16 a[228:229], v9 offset:25024
  v_fma_f32 v92, v58, s30, v23
  v_mfma_f32_16x16x32_bf16 v[64:67], a[176:179], a[16:19], 0
  v_exp_f32 v29, v93
  v_mfma_f32_16x16x32_bf16 v[64:67], a[180:183], a[20:23], v[64:67]
  ds_read_b64_tr_b16 a[234:235], v9 offset:25032
  v_fma_f32 v93, v59, s30, v23
  v_mfma_f32_16x16x32_bf16 v[64:67], a[184:187], a[24:27], v[64:67]
  ds_read_b64_tr_b16 a[194:195], v10 offset:24960
  v_cvt_pk_bf16_f32 v74, v28, v29
  v_mfma_f32_16x16x32_bf16 v[64:67], a[188:191], a[28:31], v[64:67]
  v_exp_f32 v30, v92
  v_mfma_f32_16x16x32_bf16 v[52:55], a[160:163], a[32:35], 0
  ds_read_b64_tr_b16 a[200:201], v10 offset:24968
  v_fma_f32 v92, v60, s30, v24
  v_mfma_f32_16x16x32_bf16 v[52:55], a[164:167], a[36:39], v[52:55]
  ds_read_b64_tr_b16 a[206:207], v10 offset:25024
  ds_read_b64_tr_b16 a[212:213], v10 offset:25032
  v_mfma_f32_16x16x32_bf16 v[52:55], a[168:171], a[40:43], v[52:55]
  v_exp_f32 v31, v93
  v_mfma_f32_16x16x32_bf16 v[52:55], a[172:175], a[44:47], v[52:55]
  ds_read_b64_tr_b16 a[218:219], v11 offset:24960
  v_cvt_pk_bf16_f32 v75, v30, v31
  v_mfma_f32_16x16x32_bf16 v[56:59], a[176:179], a[32:35], 0
  ds_read_b64_tr_b16 a[224:225], v11 offset:24968
  ds_read_b64_tr_b16 a[230:231], v11 offset:25024
  v_mfma_f32_16x16x32_bf16 v[56:59], a[180:183], a[36:39], v[56:59]
  ds_read_b64_tr_b16 a[236:237], v11 offset:25032
  v_fma_f32 v93, v61, s30, v24
  v_mfma_f32_16x16x32_bf16 v[56:59], a[184:187], a[40:43], v[56:59]
  v_exp_f32 v28, v92
  v_mfma_f32_16x16x32_bf16 v[56:59], a[188:191], a[44:47], v[56:59]
  s_add_u32 m0, s24, 50688
  v_fma_f32 v92, v62, s30, v24
  v_mfma_f32_16x16x32_bf16 v[32:35], a[240:243], v[72:75], v[32:35]
  v_exp_f32 v29, v93
  s_waitcnt lgkmcnt(4)
  v_mfma_f32_16x16x32_bf16 v[96:99], a[192:195], v[72:75], v[96:99]
  s_xor_b32 s33, s27, 106496
  v_fma_f32 v93, v63, s30, v24
  v_mfma_f32_16x16x32_bf16 v[100:103], a[198:201], v[72:75], v[100:103]
  buffer_load_dwordx4 v2, s[12:15], s33 offen nt lds
  v_cvt_pk_bf16_f32 v76, v28, v29
  v_mfma_f32_16x16x32_bf16 v[104:107], a[204:207], v[72:75], v[104:107]
  buffer_load_dwordx4 v3, s[12:15], s33 offen offset:1024 nt lds
  s_add_u32 m0, s25, 49920
  v_mfma_f32_16x16x32_bf16 v[108:111], a[210:213], v[72:75], v[108:111]
  v_exp_f32 v30, v92
  s_waitcnt lgkmcnt(0)
  v_mfma_f32_16x16x32_bf16 v[112:115], a[216:219], v[72:75], v[112:115]
  buffer_load_dwordx4 v4, s[16:19], s33 offen nt lds
  v_fma_f32 v92, v64, s30, v24
  v_mfma_f32_16x16x32_bf16 v[116:119], a[222:225], v[72:75], v[116:119]
  buffer_load_dwordx4 v5, s[16:19], s33 offen offset:1024 nt lds
  v_exp_f32 v31, v93
  v_mfma_f32_16x16x32_bf16 v[120:123], a[228:231], v[72:75], v[120:123]
  v_fma_f32 v93, v65, s30, v24
  v_cvt_pk_bf16_f32 v77, v30, v31
  v_mfma_f32_16x16x32_bf16 v[124:127], a[234:237], v[72:75], v[124:127]
  v_exp_f32 v28, v92
  s_waitcnt vmcnt(10)
  s_barrier
  v_mfma_f32_16x16x32_bf16 v[60:63], a[160:163], a[48:51], 0
  ds_read_b128 a[160:163], v6 offset:33792
  v_fma_f32 v92, v66, s30, v24
  v_mfma_f32_16x16x32_bf16 v[60:63], a[164:167], a[52:55], v[60:63]
  v_exp_f32 v29, v93
  v_mfma_f32_16x16x32_bf16 v[60:63], a[168:171], a[56:59], v[60:63]
  v_fma_f32 v93, v67, s30, v24
  v_cvt_pk_bf16_f32 v78, v28, v29
  v_mfma_f32_16x16x32_bf16 v[60:63], a[172:175], a[60:63], v[60:63]
  v_exp_f32 v30, v92
  v_mfma_f32_16x16x32_bf16 v[64:67], a[176:179], a[48:51], 0
  v_fma_f32 v92, v52, s30, v25
  v_exp_f32 v31, v93
  v_mfma_f32_16x16x32_bf16 v[64:67], a[180:183], a[52:55], v[64:67]
  v_cvt_pk_bf16_f32 v79, v30, v31
  v_fma_f32 v93, v53, s30, v25
  v_mfma_f32_16x16x32_bf16 v[64:67], a[184:187], a[56:59], v[64:67]
  v_exp_f32 v28, v92
  v_mfma_f32_16x16x32_bf16 v[64:67], a[188:191], a[60:63], v[64:67]
  ds_read_b128 a[164:167], v6 offset:33856
  v_fma_f32 v92, v54, s30, v25
  v_mfma_f32_16x16x32_bf16 v[36:39], a[240:243], v[76:79], v[36:39]
  v_exp_f32 v29, v93
  v_mfma_f32_16x16x32_bf16 v[128:131], a[192:195], v[76:79], v[128:131]
  v_fma_f32 v93, v55, s30, v25
  v_cvt_pk_bf16_f32 v80, v28, v29
  v_mfma_f32_16x16x32_bf16 v[132:135], a[198:201], v[76:79], v[132:135]
  v_exp_f32 v30, v92
  v_mfma_f32_16x16x32_bf16 v[136:139], a[204:207], v[76:79], v[136:139]
  ds_read_b128 a[168:171], v6 offset:33920
  v_fma_f32 v92, v56, s30, v25
  v_mfma_f32_16x16x32_bf16 v[140:143], a[210:213], v[76:79], v[140:143]
  v_exp_f32 v31, v93
  v_fma_f32 v93, v57, s30, v25
  v_mfma_f32_16x16x32_bf16 v[144:147], a[216:219], v[76:79], v[144:147]
  ds_read_b128 a[172:175], v6 offset:33984
  v_cvt_pk_bf16_f32 v81, v30, v31
  v_mfma_f32_16x16x32_bf16 v[148:151], a[222:225], v[76:79], v[148:151]
  v_exp_f32 v28, v92
  v_fma_f32 v92, v58, s30, v25
  v_mfma_f32_16x16x32_bf16 v[152:155], a[228:231], v[76:79], v[152:155]
  v_exp_f32 v29, v93
  v_fma_f32 v93, v59, s30, v25
  v_mfma_f32_16x16x32_bf16 v[156:159], a[234:237], v[76:79], v[156:159]
  v_cvt_pk_bf16_f32 v82, v28, v29
  v_exp_f32 v30, v92
  s_waitcnt lgkmcnt(2)
  v_mfma_f32_16x16x32_bf16 v[68:71], a[160:163], a[128:131], 0
  v_fma_f32 v92, v60, s30, v26
  v_exp_f32 v31, v93
  v_mfma_f32_16x16x32_bf16 v[68:71], a[164:167], a[132:135], v[68:71]
  v_cvt_pk_bf16_f32 v83, v30, v31
  v_fma_f32 v93, v61, s30, v26
  s_waitcnt lgkmcnt(1)
  v_mfma_f32_16x16x32_bf16 v[68:71], a[168:171], a[136:139], v[68:71]
  v_exp_f32 v28, v92
  s_waitcnt lgkmcnt(0)
  v_mfma_f32_16x16x32_bf16 v[68:71], a[172:175], a[140:143], v[68:71]
  ds_read_b128 a[176:179], v7 offset:33792
  v_fma_f32 v92, v62, s30, v26
  v_mfma_f32_16x16x32_bf16 v[40:43], a[240:243], v[80:83], v[40:43]
  v_exp_f32 v29, v93
  v_mfma_f32_16x16x32_bf16 v[160:163], a[192:195], v[80:83], v[160:163]
  v_fma_f32 v93, v63, s30, v26
  v_cvt_pk_bf16_f32 v84, v28, v29
  v_mfma_f32_16x16x32_bf16 v[164:167], a[198:201], v[80:83], v[164:167]
  v_exp_f32 v30, v92
  v_mfma_f32_16x16x32_bf16 v[168:171], a[204:207], v[80:83], v[168:171]
  ds_read_b128 a[180:183], v7 offset:33856
  v_fma_f32 v92, v64, s30, v26
  v_mfma_f32_16x16x32_bf16 v[172:175], a[210:213], v[80:83], v[172:175]
  v_exp_f32 v31, v93
  v_mfma_f32_16x16x32_bf16 v[176:179], a[216:219], v[80:83], v[176:179]
  ds_read_b128 a[184:187], v7 offset:33920
  v_fma_f32 v93, v65, s30, v26
  v_mfma_f32_16x16x32_bf16 v[180:183], a[222:225], v[80:83], v[180:183]
  ds_read_b128 a[188:191], v7 offset:33984
  v_cvt_pk_bf16_f32 v85, v30, v31
  v_mfma_f32_16x16x32_bf16 v[184:187], a[228:231], v[80:83], v[184:187]
  v_exp_f32 v28, v92
  v_mfma_f32_16x16x32_bf16 v[188:191], a[234:237], v[80:83], v[188:191]
  ds_read_b64_tr_b16 a[196:197], v10 offset:33280
  v_fma_f32 v92, v66, s30, v26
  v_mfma_f32_16x16x32_bf16 v[52:55], a[160:163], a[0:3], 0
  v_exp_f32 v29, v93
  v_mfma_f32_16x16x32_bf16 v[52:55], a[164:167], a[4:7], v[52:55]
  v_fma_f32 v93, v67, s30, v26
  v_cvt_pk_bf16_f32 v86, v28, v29
  v_mfma_f32_16x16x32_bf16 v[52:55], a[168:171], a[8:11], v[52:55]
  v_exp_f32 v30, v92
  v_mfma_f32_16x16x32_bf16 v[52:55], a[172:175], a[12:15], v[52:55]
  ds_read_b64_tr_b16 a[202:203], v10 offset:33288
  v_fma_f32 v92, v68, s30, v27
  s_waitcnt lgkmcnt(2)
  v_mfma_f32_16x16x32_bf16 v[56:59], a[176:179], a[0:3], 0
  v_exp_f32 v31, v93
  v_mfma_f32_16x16x32_bf16 v[56:59], a[180:183], a[4:7], v[56:59]
  v_cvt_pk_bf16_f32 v87, v30, v31
  v_fma_f32 v93, v69, s30, v27
  v_mfma_f32_16x16x32_bf16 v[56:59], a[184:187], a[8:11], v[56:59]
  ds_read_b64_tr_b16 a[208:209], v10 offset:33344
  ds_read_b64_tr_b16 a[214:215], v10 offset:33352
  v_mfma_f32_16x16x32_bf16 v[56:59], a[188:191], a[12:15], v[56:59]
  v_exp_f32 v28, v92
  v_mfma_f32_16x16x32_bf16 v[44:47], a[240:243], v[84:87], v[44:47]
  ds_read_b64_tr_b16 a[220:221], v11 offset:33280
  v_fma_f32 v92, v70, s30, v27
  v_mfma_f32_16x16x32_bf16 v[192:195], a[192:195], v[84:87], v[192:195]
  ds_read_b64_tr_b16 a[226:227], v11 offset:33288
  ds_read_b64_tr_b16 a[232:233], v11 offset:33344
  v_mfma_f32_16x16x32_bf16 v[196:199], a[198:201], v[84:87], v[196:199]
  v_exp_f32 v29, v93
  v_mfma_f32_16x16x32_bf16 v[200:203], a[204:207], v[84:87], v[200:203]
  ds_read_b64_tr_b16 a[238:239], v11 offset:33352
  v_fma_f32 v93, v71, s30, v27
  v_mfma_f32_16x16x32_bf16 v[204:207], a[210:213], v[84:87], v[204:207]
  ds_read_b64_tr_b16 a[194:195], v8 offset:33280
  v_cvt_pk_bf16_f32 v90, v28, v29
  v_mfma_f32_16x16x32_bf16 v[208:211], a[216:219], v[84:87], v[208:211]
  v_exp_f32 v30, v92
  v_mfma_f32_16x16x32_bf16 v[212:215], a[222:225], v[84:87], v[212:215]
  ds_read_b64_tr_b16 a[200:201], v8 offset:33288
  v_fma_f32 v92, v52, s30, v23
  v_mfma_f32_16x16x32_bf16 v[216:219], a[228:231], v[84:87], v[216:219]
  ds_read_b64_tr_b16 a[206:207], v8 offset:33344
  ds_read_b64_tr_b16 a[212:213], v8 offset:33352
  v_mfma_f32_16x16x32_bf16 v[220:223], a[234:237], v[84:87], v[220:223]
  v_exp_f32 v31, v93
  v_mfma_f32_16x16x32_bf16 v[60:63], a[160:163], a[16:19], 0
  ds_read_b64_tr_b16 a[218:219], v9 offset:33280
  v_cvt_pk_bf16_f32 v91, v30, v31
  v_mfma_f32_16x16x32_bf16 v[60:63], a[164:167], a[20:23], v[60:63]
  ds_read_b64_tr_b16 a[224:225], v9 offset:33288
  ds_read_b64_tr_b16 a[230:231], v9 offset:33344
  v_mfma_f32_16x16x32_bf16 v[60:63], a[168:171], a[24:27], v[60:63]
  ds_read_b64_tr_b16 a[236:237], v9 offset:33352
  v_fma_f32 v93, v53, s30, v23
  v_mfma_f32_16x16x32_bf16 v[60:63], a[172:175], a[28:31], v[60:63]
  v_exp_f32 v28, v92
  v_mfma_f32_16x16x32_bf16 v[64:67], a[176:179], a[16:19], 0
  s_add_u32 m0, s24, 0
  v_fma_f32 v92, v54, s30, v23
  v_mfma_f32_16x16x32_bf16 v[64:67], a[180:183], a[20:23], v[64:67]
  v_exp_f32 v29, v93
  v_mfma_f32_16x16x32_bf16 v[64:67], a[184:187], a[24:27], v[64:67]
  v_fma_f32 v93, v55, s30, v23
  v_cvt_pk_bf16_f32 v72, v28, v29
  v_mfma_f32_16x16x32_bf16 v[64:67], a[188:191], a[28:31], v[64:67]
  v_exp_f32 v30, v92
  v_mfma_f32_16x16x32_bf16 v[48:51], a[240:243], v[88:91], v[48:51]
  s_xor_b32 s33, s27, 114688
  v_fma_f32 v92, v56, s30, v23
  s_waitcnt lgkmcnt(0)
  v_mfma_f32_16x16x32_bf16 v[224:227], a[192:195], v[88:91], v[224:227]
  v_exp_f32 v31, v93
  v_mfma_f32_16x16x32_bf16 v[228:231], a[198:201], v[88:91], v[228:231]
  v_fma_f32 v93, v57, s30, v23
  v_cvt_pk_bf16_f32 v73, v30, v31
  v_mfma_f32_16x16x32_bf16 v[232:235], a[204:207], v[88:91], v[232:235]
  v_exp_f32 v28, v92
  v_mfma_f32_16x16x32_bf16 v[236:239], a[210:213], v[88:91], v[236:239]
  buffer_load_dwordx4 v2, s[12:15], s33 offen nt lds
  v_fma_f32 v92, v58, s30, v23
  v_mfma_f32_16x16x32_bf16 v[240:243], a[216:219], v[88:91], v[240:243]
  v_exp_f32 v29, v93
  v_mfma_f32_16x16x32_bf16 v[244:247], a[222:225], v[88:91], v[244:247]
  v_fma_f32 v93, v59, s30, v23
  v_cvt_pk_bf16_f32 v74, v28, v29
  v_mfma_f32_16x16x32_bf16 v[248:251], a[228:231], v[88:91], v[248:251]
  v_exp_f32 v30, v92
  v_mfma_f32_16x16x32_bf16 v[252:255], a[234:237], v[88:91], v[252:255]
  buffer_load_dwordx4 v3, s[12:15], s33 offen offset:1024 nt lds
  v_fma_f32 v92, v60, s30, v24
  v_mfma_f32_16x16x32_bf16 v[52:55], a[160:163], a[32:35], 0
  v_exp_f32 v31, v93
  v_mfma_f32_16x16x32_bf16 v[52:55], a[164:167], a[36:39], v[52:55]
  v_cvt_pk_bf16_f32 v75, v30, v31
  v_fma_f32 v93, v61, s30, v24
  v_mfma_f32_16x16x32_bf16 v[52:55], a[168:171], a[40:43], v[52:55]
  v_exp_f32 v28, v92
  v_mfma_f32_16x16x32_bf16 v[52:55], a[172:175], a[44:47], v[52:55]
  s_add_u32 m0, s25, 0
  v_fma_f32 v92, v62, s30, v24
  v_mfma_f32_16x16x32_bf16 v[56:59], a[176:179], a[32:35], 0
  v_exp_f32 v29, v93
  v_mfma_f32_16x16x32_bf16 v[56:59], a[180:183], a[36:39], v[56:59]
  v_fma_f32 v93, v63, s30, v24
  v_cvt_pk_bf16_f32 v76, v28, v29
  v_mfma_f32_16x16x32_bf16 v[56:59], a[184:187], a[40:43], v[56:59]
  v_exp_f32 v30, v92
  v_mfma_f32_16x16x32_bf16 v[56:59], a[188:191], a[44:47], v[56:59]
  buffer_load_dwordx4 v4, s[16:19], s33 offen nt lds
  v_fma_f32 v92, v64, s30, v24
  v_mfma_f32_16x16x32_bf16 v[32:35], a[240:243], v[72:75], v[32:35]
  buffer_load_dwordx4 v5, s[16:19], s33 offen offset:1024 nt lds
  v_exp_f32 v31, v93
  v_mfma_f32_16x16x32_bf16 v[96:99], a[194:197], v[72:75], v[96:99]
  v_fma_f32 v93, v65, s30, v24
  v_cvt_pk_bf16_f32 v77, v30, v31
  v_mfma_f32_16x16x32_bf16 v[100:103], a[200:203], v[72:75], v[100:103]
  v_exp_f32 v28, v92
  v_mfma_f32_16x16x32_bf16 v[104:107], a[206:209], v[72:75], v[104:107]
  v_fma_f32 v92, v66, s30, v24
  v_exp_f32 v29, v93
  v_mfma_f32_16x16x32_bf16 v[108:111], a[212:215], v[72:75], v[108:111]
  v_fma_f32 v93, v67, s30, v24
  v_cvt_pk_bf16_f32 v78, v28, v29
  v_mfma_f32_16x16x32_bf16 v[112:115], a[218:221], v[72:75], v[112:115]
  v_exp_f32 v30, v92
  v_mfma_f32_16x16x32_bf16 v[116:119], a[224:227], v[72:75], v[116:119]
  v_fma_f32 v92, v52, s30, v25
  v_exp_f32 v31, v93
  v_mfma_f32_16x16x32_bf16 v[120:123], a[230:233], v[72:75], v[120:123]
  v_cvt_pk_bf16_f32 v79, v30, v31
  v_fma_f32 v93, v53, s30, v25
  v_mfma_f32_16x16x32_bf16 v[124:127], a[236:239], v[72:75], v[124:127]
  v_exp_f32 v28, v92
  s_waitcnt vmcnt(8)
  s_barrier
  v_mfma_f32_16x16x32_bf16 v[60:63], a[160:163], a[48:51], 0
  ds_read_b128 a[160:163], v6 offset:42240
  v_fma_f32 v92, v54, s30, v25
  v_mfma_f32_16x16x32_bf16 v[60:63], a[164:167], a[52:55], v[60:63]
  v_exp_f32 v29, v93
  v_mfma_f32_16x16x32_bf16 v[60:63], a[168:171], a[56:59], v[60:63]
  v_fma_f32 v93, v55, s30, v25
  v_cvt_pk_bf16_f32 v80, v28, v29
  v_mfma_f32_16x16x32_bf16 v[60:63], a[172:175], a[60:63], v[60:63]
  v_exp_f32 v30, v92
  v_mfma_f32_16x16x32_bf16 v[64:67], a[176:179], a[48:51], 0
  ds_read_b128 a[164:167], v6 offset:42304
  v_fma_f32 v92, v56, s30, v25
  v_mfma_f32_16x16x32_bf16 v[64:67], a[180:183], a[52:55], v[64:67]
  v_exp_f32 v31, v93
  v_mfma_f32_16x16x32_bf16 v[64:67], a[184:187], a[56:59], v[64:67]
  ds_read_b128 a[168:171], v6 offset:42368
  v_fma_f32 v93, v57, s30, v25
  v_mfma_f32_16x16x32_bf16 v[64:67], a[188:191], a[60:63], v[64:67]
  ds_read_b128 a[172:175], v6 offset:42432
  v_cvt_pk_bf16_f32 v81, v30, v31
  v_mfma_f32_16x16x32_bf16 v[36:39], a[240:243], v[76:79], v[36:39]
  v_exp_f32 v28, v92
  v_mfma_f32_16x16x32_bf16 v[128:131], a[194:197], v[76:79], v[128:131]
  ds_read_b128 a[176:179], v7 offset:42240
  v_fma_f32 v92, v58, s30, v25
  v_mfma_f32_16x16x32_bf16 v[132:135], a[200:203], v[76:79], v[132:135]
  v_exp_f32 v29, v93
  v_mfma_f32_16x16x32_bf16 v[136:139], a[206:209], v[76:79], v[136:139]
  v_fma_f32 v93, v59, s30, v25
  v_cvt_pk_bf16_f32 v82, v28, v29
  v_mfma_f32_16x16x32_bf16 v[140:143], a[212:215], v[76:79], v[140:143]
  v_exp_f32 v30, v92
  v_mfma_f32_16x16x32_bf16 v[144:147], a[218:221], v[76:79], v[144:147]
  ds_read_b128 a[180:183], v7 offset:42304
  v_fma_f32 v92, v60, s30, v26
  v_mfma_f32_16x16x32_bf16 v[148:151], a[224:227], v[76:79], v[148:151]
  v_exp_f32 v31, v93
  v_mfma_f32_16x16x32_bf16 v[152:155], a[230:233], v[76:79], v[152:155]
  v_cvt_pk_bf16_f32 v83, v30, v31
  v_fma_f32 v93, v61, s30, v26
  v_mfma_f32_16x16x32_bf16 v[156:159], a[236:239], v[76:79], v[156:159]
  v_exp_f32 v28, v92
  s_waitcnt lgkmcnt(1)
  v_mfma_f32_16x16x32_bf16 v[68:71], a[160:163], a[128:131], 0
  ds_read_b128 a[184:187], v7 offset:42368
  v_fma_f32 v92, v62, s30, v26
  v_mfma_f32_16x16x32_bf16 v[68:71], a[164:167], a[132:135], v[68:71]
  v_exp_f32 v29, v93
  v_mfma_f32_16x16x32_bf16 v[68:71], a[168:171], a[136:139], v[68:71]
  v_fma_f32 v93, v63, s30, v26
  v_cvt_pk_bf16_f32 v84, v28, v29
  v_mfma_f32_16x16x32_bf16 v[68:71], a[172:175], a[140:143], v[68:71]
  v_exp_f32 v30, v92
  v_mfma_f32_16x16x32_bf16 v[40:43], a[240:243], v[80:83], v[40:43]
  ds_read_b128 a[188:191], v7 offset:42432
  v_fma_f32 v92, v64, s30, v26
  v_mfma_f32_16x16x32_bf16 v[160:163], a[194:197], v[80:83], v[160:163]
  v_exp_f32 v31, v93
  v_mfma_f32_16x16x32_bf16 v[164:167], a[200:203], v[80:83], v[164:167]
  v_fma_f32 v93, v65, s30, v26
  v_cvt_pk_bf16_f32 v85, v30, v31
  v_mfma_f32_16x16x32_bf16 v[168:171], a[206:209], v[80:83], v[168:171]
  v_exp_f32 v28, v92
  v_mfma_f32_16x16x32_bf16 v[172:175], a[212:215], v[80:83], v[172:175]
  ds_read_b64_tr_b16 a[192:193], v8 offset:41600
  v_fma_f32 v92, v66, s30, v26
  v_mfma_f32_16x16x32_bf16 v[176:179], a[218:221], v[80:83], v[176:179]
  v_exp_f32 v29, v93
  v_mfma_f32_16x16x32_bf16 v[180:183], a[224:227], v[80:83], v[180:183]
  v_fma_f32 v93, v67, s30, v26
  v_cvt_pk_bf16_f32 v86, v28, v29
  v_mfma_f32_16x16x32_bf16 v[184:187], a[230:233], v[80:83], v[184:187]
  v_exp_f32 v30, v92
  v_mfma_f32_16x16x32_bf16 v[188:191], a[236:239], v[80:83], v[188:191]
  ds_read_b64_tr_b16 a[198:199], v8 offset:41608
  v_fma_f32 v92, v68, s30, v27
  v_mfma_f32_16x16x32_bf16 v[52:55], a[160:163], a[0:3], 0
  v_exp_f32 v31, v93
  v_mfma_f32_16x16x32_bf16 v[52:55], a[164:167], a[4:7], v[52:55]
  v_cvt_pk_bf16_f32 v87, v30, v31
  v_fma_f32 v93, v69, s30, v27
  v_mfma_f32_16x16x32_bf16 v[52:55], a[168:171], a[8:11], v[52:55]
  v_exp_f32 v28, v92
  v_mfma_f32_16x16x32_bf16 v[52:55], a[172:175], a[12:15], v[52:55]
  ds_read_b64_tr_b16 a[204:205], v8 offset:41664
  v_fma_f32 v92, v70, s30, v27
  v_mfma_f32_16x16x32_bf16 v[56:59], a[176:179], a[0:3], 0
  v_exp_f32 v29, v93
  s_waitcnt lgkmcnt(2)
  v_mfma_f32_16x16x32_bf16 v[56:59], a[180:183], a[4:7], v[56:59]
  v_fma_f32 v93, v71, s30, v27
  v_cvt_pk_bf16_f32 v88, v28, v29
  v_mfma_f32_16x16x32_bf16 v[56:59], a[184:187], a[8:11], v[56:59]
  v_exp_f32 v30, v92
  v_mfma_f32_16x16x32_bf16 v[56:59], a[188:191], a[12:15], v[56:59]
  ds_read_b64_tr_b16 a[210:211], v8 offset:41672
  v_fma_f32 v92, v52, s30, v23
  v_mfma_f32_16x16x32_bf16 v[44:47], a[240:243], v[84:87], v[44:47]
  v_exp_f32 v31, v93
  v_mfma_f32_16x16x32_bf16 v[192:195], a[194:197], v[84:87], v[192:195]
  buffer_load_dwordx4 a[120:123], v12, s[8:11], s34 offen offset:128 nt
  buffer_load_dwordx4 a[124:127], v12, s[8:11], s34 offen offset:192 nt
  v_mfma_f32_16x16x32_bf16 v[196:199], a[200:203], v[84:87], v[196:199]
  v_cvt_pk_bf16_f32 v89, v30, v31
  v_fma_f32 v93, v53, s30, v23
  v_mfma_f32_16x16x32_bf16 v[200:203], a[206:209], v[84:87], v[200:203]
  v_exp_f32 v28, v92
  v_mfma_f32_16x16x32_bf16 v[204:207], a[212:215], v[84:87], v[204:207]
  ds_read_b64_tr_b16 a[216:217], v9 offset:41600
  v_fma_f32 v92, v54, s30, v23
  v_mfma_f32_16x16x32_bf16 v[208:211], a[218:221], v[84:87], v[208:211]
  v_exp_f32 v29, v93
  v_mfma_f32_16x16x32_bf16 v[212:215], a[224:227], v[84:87], v[212:215]
  v_fma_f32 v93, v55, s30, v23
  v_cvt_pk_bf16_f32 v72, v28, v29
  v_mfma_f32_16x16x32_bf16 v[216:219], a[230:233], v[84:87], v[216:219]
  v_exp_f32 v30, v92
  v_mfma_f32_16x16x32_bf16 v[220:223], a[236:239], v[84:87], v[220:223]
  ds_read_b64_tr_b16 a[222:223], v9 offset:41608
  v_fma_f32 v92, v56, s30, v23
  v_mfma_f32_16x16x32_bf16 v[60:63], a[160:163], a[16:19], 0
  v_exp_f32 v31, v93
  v_mfma_f32_16x16x32_bf16 v[60:63], a[164:167], a[20:23], v[60:63]
  v_fma_f32 v93, v57, s30, v23
  v_cvt_pk_bf16_f32 v73, v30, v31
  v_mfma_f32_16x16x32_bf16 v[60:63], a[168:171], a[24:27], v[60:63]
  v_exp_f32 v28, v92
  v_mfma_f32_16x16x32_bf16 v[60:63], a[172:175], a[28:31], v[60:63]
  ds_read_b64_tr_b16 a[228:229], v9 offset:41664
  v_fma_f32 v92, v58, s30, v23
  v_mfma_f32_16x16x32_bf16 v[64:67], a[176:179], a[16:19], 0
  v_exp_f32 v29, v93
  v_mfma_f32_16x16x32_bf16 v[64:67], a[180:183], a[20:23], v[64:67]
  ds_read_b64_tr_b16 a[234:235], v9 offset:41672
  v_fma_f32 v93, v59, s30, v23
  v_mfma_f32_16x16x32_bf16 v[64:67], a[184:187], a[24:27], v[64:67]
  ds_read_b64_tr_b16 a[194:195], v10 offset:41600
  v_cvt_pk_bf16_f32 v74, v28, v29
  v_mfma_f32_16x16x32_bf16 v[64:67], a[188:191], a[28:31], v[64:67]
  v_exp_f32 v30, v92
  v_mfma_f32_16x16x32_bf16 v[52:55], a[160:163], a[32:35], 0
  ds_read_b64_tr_b16 a[200:201], v10 offset:41608
  v_fma_f32 v92, v60, s30, v24
  v_mfma_f32_16x16x32_bf16 v[52:55], a[164:167], a[36:39], v[52:55]
  ds_read_b64_tr_b16 a[206:207], v10 offset:41664
  ds_read_b64_tr_b16 a[212:213], v10 offset:41672
  v_mfma_f32_16x16x32_bf16 v[52:55], a[168:171], a[40:43], v[52:55]
  v_exp_f32 v31, v93
  v_mfma_f32_16x16x32_bf16 v[52:55], a[172:175], a[44:47], v[52:55]
  ds_read_b64_tr_b16 a[218:219], v11 offset:41600
  v_cvt_pk_bf16_f32 v75, v30, v31
  v_mfma_f32_16x16x32_bf16 v[56:59], a[176:179], a[32:35], 0
  ds_read_b64_tr_b16 a[224:225], v11 offset:41608
  ds_read_b64_tr_b16 a[230:231], v11 offset:41664
  v_mfma_f32_16x16x32_bf16 v[56:59], a[180:183], a[36:39], v[56:59]
  ds_read_b64_tr_b16 a[236:237], v11 offset:41672
  v_fma_f32 v93, v61, s30, v24
  v_mfma_f32_16x16x32_bf16 v[56:59], a[184:187], a[40:43], v[56:59]
  v_exp_f32 v28, v92
  v_mfma_f32_16x16x32_bf16 v[56:59], a[188:191], a[44:47], v[56:59]
  s_add_u32 m0, s24, 8448
  v_fma_f32 v92, v62, s30, v24
  v_mfma_f32_16x16x32_bf16 v[32:35], a[240:243], v[72:75], v[32:35]
  v_exp_f32 v29, v93
  s_waitcnt lgkmcnt(4)
  v_mfma_f32_16x16x32_bf16 v[96:99], a[192:195], v[72:75], v[96:99]
  s_xor_b32 s33, s27, 122880
  v_fma_f32 v93, v63, s30, v24
  v_mfma_f32_16x16x32_bf16 v[100:103], a[198:201], v[72:75], v[100:103]
  buffer_load_dwordx4 v2, s[12:15], s33 offen nt lds
  v_cvt_pk_bf16_f32 v76, v28, v29
  v_mfma_f32_16x16x32_bf16 v[104:107], a[204:207], v[72:75], v[104:107]
  buffer_load_dwordx4 v3, s[12:15], s33 offen offset:1024 nt lds
  s_add_u32 m0, s25, 8320
  v_mfma_f32_16x16x32_bf16 v[108:111], a[210:213], v[72:75], v[108:111]
  v_exp_f32 v30, v92
  s_waitcnt lgkmcnt(0)
  v_mfma_f32_16x16x32_bf16 v[112:115], a[216:219], v[72:75], v[112:115]
  buffer_load_dwordx4 v4, s[16:19], s33 offen nt lds
  v_fma_f32 v92, v64, s30, v24
  v_mfma_f32_16x16x32_bf16 v[116:119], a[222:225], v[72:75], v[116:119]
  buffer_load_dwordx4 v5, s[16:19], s33 offen offset:1024 nt lds
  v_exp_f32 v31, v93
  v_mfma_f32_16x16x32_bf16 v[120:123], a[228:231], v[72:75], v[120:123]
  v_fma_f32 v93, v65, s30, v24
  v_cvt_pk_bf16_f32 v77, v30, v31
  v_mfma_f32_16x16x32_bf16 v[124:127], a[234:237], v[72:75], v[124:127]
  v_exp_f32 v28, v92
  s_waitcnt vmcnt(10)
  s_barrier
  v_mfma_f32_16x16x32_bf16 v[60:63], a[160:163], a[48:51], 0
  ds_read_b128 a[160:163], v6 offset:50688
  v_fma_f32 v92, v66, s30, v24
  v_mfma_f32_16x16x32_bf16 v[60:63], a[164:167], a[52:55], v[60:63]
  v_exp_f32 v29, v93
  v_mfma_f32_16x16x32_bf16 v[60:63], a[168:171], a[56:59], v[60:63]
  v_fma_f32 v93, v67, s30, v24
  v_cvt_pk_bf16_f32 v78, v28, v29
  v_mfma_f32_16x16x32_bf16 v[60:63], a[172:175], a[60:63], v[60:63]
  v_exp_f32 v30, v92
  v_mfma_f32_16x16x32_bf16 v[64:67], a[176:179], a[48:51], 0
  v_fma_f32 v92, v52, s30, v25
  v_exp_f32 v31, v93
  v_mfma_f32_16x16x32_bf16 v[64:67], a[180:183], a[52:55], v[64:67]
  v_cvt_pk_bf16_f32 v79, v30, v31
  v_fma_f32 v93, v53, s30, v25
  v_mfma_f32_16x16x32_bf16 v[64:67], a[184:187], a[56:59], v[64:67]
  v_exp_f32 v28, v92
  v_mfma_f32_16x16x32_bf16 v[64:67], a[188:191], a[60:63], v[64:67]
  ds_read_b128 a[164:167], v6 offset:50752
  v_fma_f32 v92, v54, s30, v25
  v_mfma_f32_16x16x32_bf16 v[36:39], a[240:243], v[76:79], v[36:39]
  v_exp_f32 v29, v93
  v_mfma_f32_16x16x32_bf16 v[128:131], a[192:195], v[76:79], v[128:131]
  v_fma_f32 v93, v55, s30, v25
  v_cvt_pk_bf16_f32 v80, v28, v29
  v_mfma_f32_16x16x32_bf16 v[132:135], a[198:201], v[76:79], v[132:135]
  v_exp_f32 v30, v92
  v_mfma_f32_16x16x32_bf16 v[136:139], a[204:207], v[76:79], v[136:139]
  ds_read_b128 a[168:171], v6 offset:50816
  v_fma_f32 v92, v56, s30, v25
  v_mfma_f32_16x16x32_bf16 v[140:143], a[210:213], v[76:79], v[140:143]
  v_exp_f32 v31, v93
  v_fma_f32 v93, v57, s30, v25
  v_mfma_f32_16x16x32_bf16 v[144:147], a[216:219], v[76:79], v[144:147]
  ds_read_b128 a[172:175], v6 offset:50880
  v_cvt_pk_bf16_f32 v81, v30, v31
  v_mfma_f32_16x16x32_bf16 v[148:151], a[222:225], v[76:79], v[148:151]
  v_exp_f32 v28, v92
  v_fma_f32 v92, v58, s30, v25
  v_mfma_f32_16x16x32_bf16 v[152:155], a[228:231], v[76:79], v[152:155]
  v_exp_f32 v29, v93
  v_fma_f32 v93, v59, s30, v25
  v_mfma_f32_16x16x32_bf16 v[156:159], a[234:237], v[76:79], v[156:159]
  v_cvt_pk_bf16_f32 v82, v28, v29
  v_exp_f32 v30, v92
  s_waitcnt lgkmcnt(2)
  v_mfma_f32_16x16x32_bf16 v[68:71], a[160:163], a[128:131], 0
  v_fma_f32 v92, v60, s30, v26
  v_exp_f32 v31, v93
  v_mfma_f32_16x16x32_bf16 v[68:71], a[164:167], a[132:135], v[68:71]
  v_cvt_pk_bf16_f32 v83, v30, v31
  v_fma_f32 v93, v61, s30, v26
  s_waitcnt lgkmcnt(1)
  v_mfma_f32_16x16x32_bf16 v[68:71], a[168:171], a[136:139], v[68:71]
  v_exp_f32 v28, v92
  s_waitcnt lgkmcnt(0)
  v_mfma_f32_16x16x32_bf16 v[68:71], a[172:175], a[140:143], v[68:71]
  ds_read_b128 a[176:179], v7 offset:50688
  v_fma_f32 v92, v62, s30, v26
  v_mfma_f32_16x16x32_bf16 v[40:43], a[240:243], v[80:83], v[40:43]
  v_exp_f32 v29, v93
  v_mfma_f32_16x16x32_bf16 v[160:163], a[192:195], v[80:83], v[160:163]
  v_fma_f32 v93, v63, s30, v26
  v_cvt_pk_bf16_f32 v84, v28, v29
  v_mfma_f32_16x16x32_bf16 v[164:167], a[198:201], v[80:83], v[164:167]
  v_exp_f32 v30, v92
  v_mfma_f32_16x16x32_bf16 v[168:171], a[204:207], v[80:83], v[168:171]
  ds_read_b128 a[180:183], v7 offset:50752
  v_fma_f32 v92, v64, s30, v26
  v_mfma_f32_16x16x32_bf16 v[172:175], a[210:213], v[80:83], v[172:175]
  v_exp_f32 v31, v93
  v_mfma_f32_16x16x32_bf16 v[176:179], a[216:219], v[80:83], v[176:179]
  ds_read_b128 a[184:187], v7 offset:50816
  v_fma_f32 v93, v65, s30, v26
  v_mfma_f32_16x16x32_bf16 v[180:183], a[222:225], v[80:83], v[180:183]
  ds_read_b128 a[188:191], v7 offset:50880
  v_cvt_pk_bf16_f32 v85, v30, v31
  v_mfma_f32_16x16x32_bf16 v[184:187], a[228:231], v[80:83], v[184:187]
  v_exp_f32 v28, v92
  v_mfma_f32_16x16x32_bf16 v[188:191], a[234:237], v[80:83], v[188:191]
  ds_read_b64_tr_b16 a[196:197], v10 offset:49920
  v_fma_f32 v92, v66, s30, v26
  v_mfma_f32_16x16x32_bf16 v[52:55], a[160:163], a[0:3], 0
  v_exp_f32 v29, v93
  v_mfma_f32_16x16x32_bf16 v[52:55], a[164:167], a[4:7], v[52:55]
  v_fma_f32 v93, v67, s30, v26
  v_cvt_pk_bf16_f32 v86, v28, v29
  v_mfma_f32_16x16x32_bf16 v[52:55], a[168:171], a[8:11], v[52:55]
  v_exp_f32 v30, v92
  v_mfma_f32_16x16x32_bf16 v[52:55], a[172:175], a[12:15], v[52:55]
  ds_read_b64_tr_b16 a[202:203], v10 offset:49928
  v_fma_f32 v92, v68, s30, v27
  s_waitcnt lgkmcnt(2)
  v_mfma_f32_16x16x32_bf16 v[56:59], a[176:179], a[0:3], 0
  v_exp_f32 v31, v93
  v_mfma_f32_16x16x32_bf16 v[56:59], a[180:183], a[4:7], v[56:59]
  v_cvt_pk_bf16_f32 v87, v30, v31
  v_fma_f32 v93, v69, s30, v27
  v_mfma_f32_16x16x32_bf16 v[56:59], a[184:187], a[8:11], v[56:59]
  ds_read_b64_tr_b16 a[208:209], v10 offset:49984
  ds_read_b64_tr_b16 a[214:215], v10 offset:49992
  v_mfma_f32_16x16x32_bf16 v[56:59], a[188:191], a[12:15], v[56:59]
  v_exp_f32 v28, v92
  v_mfma_f32_16x16x32_bf16 v[44:47], a[240:243], v[84:87], v[44:47]
  ds_read_b64_tr_b16 a[220:221], v11 offset:49920
  v_fma_f32 v92, v70, s30, v27
  v_mfma_f32_16x16x32_bf16 v[192:195], a[192:195], v[84:87], v[192:195]
  ds_read_b64_tr_b16 a[226:227], v11 offset:49928
  ds_read_b64_tr_b16 a[232:233], v11 offset:49984
  v_mfma_f32_16x16x32_bf16 v[196:199], a[198:201], v[84:87], v[196:199]
  v_exp_f32 v29, v93
  v_mfma_f32_16x16x32_bf16 v[200:203], a[204:207], v[84:87], v[200:203]
  ds_read_b64_tr_b16 a[238:239], v11 offset:49992
  v_fma_f32 v93, v71, s30, v27
  v_mfma_f32_16x16x32_bf16 v[204:207], a[210:213], v[84:87], v[204:207]
  ds_read_b64_tr_b16 a[194:195], v8 offset:49920
  v_cvt_pk_bf16_f32 v90, v28, v29
  v_mfma_f32_16x16x32_bf16 v[208:211], a[216:219], v[84:87], v[208:211]
  v_exp_f32 v30, v92
  v_mfma_f32_16x16x32_bf16 v[212:215], a[222:225], v[84:87], v[212:215]
  ds_read_b64_tr_b16 a[200:201], v8 offset:49928
  v_fma_f32 v92, v52, s30, v23
  v_mfma_f32_16x16x32_bf16 v[216:219], a[228:231], v[84:87], v[216:219]
  ds_read_b64_tr_b16 a[206:207], v8 offset:49984
  ds_read_b64_tr_b16 a[212:213], v8 offset:49992
  v_mfma_f32_16x16x32_bf16 v[220:223], a[234:237], v[84:87], v[220:223]
  v_exp_f32 v31, v93
  v_mfma_f32_16x16x32_bf16 v[60:63], a[160:163], a[16:19], 0
  ds_read_b64_tr_b16 a[218:219], v9 offset:49920
  v_cvt_pk_bf16_f32 v91, v30, v31
  v_mfma_f32_16x16x32_bf16 v[60:63], a[164:167], a[20:23], v[60:63]
  ds_read_b64_tr_b16 a[224:225], v9 offset:49928
  ds_read_b64_tr_b16 a[230:231], v9 offset:49984
  v_mfma_f32_16x16x32_bf16 v[60:63], a[168:171], a[24:27], v[60:63]
  ds_read_b64_tr_b16 a[236:237], v9 offset:49992
  v_fma_f32 v93, v53, s30, v23
  v_mfma_f32_16x16x32_bf16 v[60:63], a[172:175], a[28:31], v[60:63]
  v_exp_f32 v28, v92
  v_mfma_f32_16x16x32_bf16 v[64:67], a[176:179], a[16:19], 0
  s_add_u32 m0, s24, 16896
  v_fma_f32 v92, v54, s30, v23
  v_mfma_f32_16x16x32_bf16 v[64:67], a[180:183], a[20:23], v[64:67]
  v_exp_f32 v29, v93
  v_mfma_f32_16x16x32_bf16 v[64:67], a[184:187], a[24:27], v[64:67]
  v_fma_f32 v93, v55, s30, v23
  v_cvt_pk_bf16_f32 v72, v28, v29
  v_mfma_f32_16x16x32_bf16 v[64:67], a[188:191], a[28:31], v[64:67]
  v_exp_f32 v30, v92
  v_mfma_f32_16x16x32_bf16 v[48:51], a[240:243], v[88:91], v[48:51]
  s_xor_b32 s33, s27, 33554432
  v_fma_f32 v92, v56, s30, v23
  s_waitcnt lgkmcnt(0)
  v_mfma_f32_16x16x32_bf16 v[224:227], a[192:195], v[88:91], v[224:227]
  v_exp_f32 v31, v93
  v_mfma_f32_16x16x32_bf16 v[228:231], a[198:201], v[88:91], v[228:231]
  v_fma_f32 v93, v57, s30, v23
  v_cvt_pk_bf16_f32 v73, v30, v31
  v_mfma_f32_16x16x32_bf16 v[232:235], a[204:207], v[88:91], v[232:235]
  v_exp_f32 v28, v92
  v_mfma_f32_16x16x32_bf16 v[236:239], a[210:213], v[88:91], v[236:239]
  buffer_load_dwordx4 v2, s[12:15], s33 offen nt lds
  v_fma_f32 v92, v58, s30, v23
  v_mfma_f32_16x16x32_bf16 v[240:243], a[216:219], v[88:91], v[240:243]
  v_exp_f32 v29, v93
  v_mfma_f32_16x16x32_bf16 v[244:247], a[222:225], v[88:91], v[244:247]
  v_fma_f32 v93, v59, s30, v23
  v_cvt_pk_bf16_f32 v74, v28, v29
  v_mfma_f32_16x16x32_bf16 v[248:251], a[228:231], v[88:91], v[248:251]
  v_exp_f32 v30, v92
  v_mfma_f32_16x16x32_bf16 v[252:255], a[234:237], v[88:91], v[252:255]
  buffer_load_dwordx4 v3, s[12:15], s33 offen offset:1024 nt lds
  v_fma_f32 v92, v60, s30, v24
  v_mfma_f32_16x16x32_bf16 v[52:55], a[160:163], a[32:35], 0
  v_exp_f32 v31, v93
  v_mfma_f32_16x16x32_bf16 v[52:55], a[164:167], a[36:39], v[52:55]
  v_cvt_pk_bf16_f32 v75, v30, v31
  v_fma_f32 v93, v61, s30, v24
  v_mfma_f32_16x16x32_bf16 v[52:55], a[168:171], a[40:43], v[52:55]
  v_exp_f32 v28, v92
  v_mfma_f32_16x16x32_bf16 v[52:55], a[172:175], a[44:47], v[52:55]
  s_add_u32 m0, s25, 16640
  v_fma_f32 v92, v62, s30, v24
  v_mfma_f32_16x16x32_bf16 v[56:59], a[176:179], a[32:35], 0
  v_exp_f32 v29, v93
  v_mfma_f32_16x16x32_bf16 v[56:59], a[180:183], a[36:39], v[56:59]
  v_fma_f32 v93, v63, s30, v24
  v_cvt_pk_bf16_f32 v76, v28, v29
  v_mfma_f32_16x16x32_bf16 v[56:59], a[184:187], a[40:43], v[56:59]
  v_exp_f32 v30, v92
  v_mfma_f32_16x16x32_bf16 v[56:59], a[188:191], a[44:47], v[56:59]
  buffer_load_dwordx4 v4, s[16:19], s33 offen nt lds
  v_fma_f32 v92, v64, s30, v24
  v_mfma_f32_16x16x32_bf16 v[32:35], a[240:243], v[72:75], v[32:35]
  buffer_load_dwordx4 v5, s[16:19], s33 offen offset:1024 nt lds
  v_exp_f32 v31, v93
  v_mfma_f32_16x16x32_bf16 v[96:99], a[194:197], v[72:75], v[96:99]
  v_fma_f32 v93, v65, s30, v24
  v_cvt_pk_bf16_f32 v77, v30, v31
  v_mfma_f32_16x16x32_bf16 v[100:103], a[200:203], v[72:75], v[100:103]
  v_exp_f32 v28, v92
  v_mfma_f32_16x16x32_bf16 v[104:107], a[206:209], v[72:75], v[104:107]
  v_fma_f32 v92, v66, s30, v24
  v_exp_f32 v29, v93
  v_mfma_f32_16x16x32_bf16 v[108:111], a[212:215], v[72:75], v[108:111]
  v_fma_f32 v93, v67, s30, v24
  v_cvt_pk_bf16_f32 v78, v28, v29
  v_mfma_f32_16x16x32_bf16 v[112:115], a[218:221], v[72:75], v[112:115]
  v_exp_f32 v30, v92
  v_mfma_f32_16x16x32_bf16 v[116:119], a[224:227], v[72:75], v[116:119]
  v_fma_f32 v92, v52, s30, v25
  v_exp_f32 v31, v93
  v_mfma_f32_16x16x32_bf16 v[120:123], a[230:233], v[72:75], v[120:123]
  v_cvt_pk_bf16_f32 v79, v30, v31
  v_fma_f32 v93, v53, s30, v25
  v_mfma_f32_16x16x32_bf16 v[124:127], a[236:239], v[72:75], v[124:127]
  v_exp_f32 v28, v92
  s_waitcnt vmcnt(10)
  s_barrier
  v_mfma_f32_16x16x32_bf16 v[60:63], a[160:163], a[48:51], 0
  ds_read_b128 a[160:163], v6 offset:0
  v_fma_f32 v92, v54, s30, v25
  v_mfma_f32_16x16x32_bf16 v[60:63], a[164:167], a[52:55], v[60:63]
  v_exp_f32 v29, v93
  v_mfma_f32_16x16x32_bf16 v[60:63], a[168:171], a[56:59], v[60:63]
  v_fma_f32 v93, v55, s30, v25
  v_cvt_pk_bf16_f32 v80, v28, v29
  v_mfma_f32_16x16x32_bf16 v[60:63], a[172:175], a[60:63], v[60:63]
  v_exp_f32 v30, v92
  v_mfma_f32_16x16x32_bf16 v[64:67], a[176:179], a[48:51], 0
  ds_read_b128 a[164:167], v6 offset:64
  v_fma_f32 v92, v56, s30, v25
  v_mfma_f32_16x16x32_bf16 v[64:67], a[180:183], a[52:55], v[64:67]
  v_exp_f32 v31, v93
  v_mfma_f32_16x16x32_bf16 v[64:67], a[184:187], a[56:59], v[64:67]
  ds_read_b128 a[168:171], v6 offset:128
  v_fma_f32 v93, v57, s30, v25
  v_mfma_f32_16x16x32_bf16 v[64:67], a[188:191], a[60:63], v[64:67]
  ds_read_b128 a[172:175], v6 offset:192
  v_cvt_pk_bf16_f32 v81, v30, v31
  v_mfma_f32_16x16x32_bf16 v[36:39], a[240:243], v[76:79], v[36:39]
  v_exp_f32 v28, v92
  v_mfma_f32_16x16x32_bf16 v[128:131], a[194:197], v[76:79], v[128:131]
  ds_read_b128 a[176:179], v7 offset:0
  v_fma_f32 v92, v58, s30, v25
  v_mfma_f32_16x16x32_bf16 v[132:135], a[200:203], v[76:79], v[132:135]
  v_exp_f32 v29, v93
  v_mfma_f32_16x16x32_bf16 v[136:139], a[206:209], v[76:79], v[136:139]
  v_fma_f32 v93, v59, s30, v25
  v_cvt_pk_bf16_f32 v82, v28, v29
  v_mfma_f32_16x16x32_bf16 v[140:143], a[212:215], v[76:79], v[140:143]
  v_exp_f32 v30, v92
  v_mfma_f32_16x16x32_bf16 v[144:147], a[218:221], v[76:79], v[144:147]
  ds_read_b128 a[180:183], v7 offset:64
  v_fma_f32 v92, v60, s30, v26
  v_mfma_f32_16x16x32_bf16 v[148:151], a[224:227], v[76:79], v[148:151]
  v_exp_f32 v31, v93
  v_mfma_f32_16x16x32_bf16 v[152:155], a[230:233], v[76:79], v[152:155]
  v_cvt_pk_bf16_f32 v83, v30, v31
  v_fma_f32 v93, v61, s30, v26
  v_mfma_f32_16x16x32_bf16 v[156:159], a[236:239], v[76:79], v[156:159]
  v_exp_f32 v28, v92
  s_waitcnt lgkmcnt(1)
  v_mfma_f32_16x16x32_bf16 v[68:71], a[160:163], a[128:131], 0
  ds_read_b128 a[184:187], v7 offset:128
  v_fma_f32 v92, v62, s30, v26
  v_mfma_f32_16x16x32_bf16 v[68:71], a[164:167], a[132:135], v[68:71]
  v_exp_f32 v29, v93
  v_mfma_f32_16x16x32_bf16 v[68:71], a[168:171], a[136:139], v[68:71]
  v_fma_f32 v93, v63, s30, v26
  v_cvt_pk_bf16_f32 v84, v28, v29
  v_mfma_f32_16x16x32_bf16 v[68:71], a[172:175], a[140:143], v[68:71]
  v_exp_f32 v30, v92
  v_mfma_f32_16x16x32_bf16 v[40:43], a[240:243], v[80:83], v[40:43]
  ds_read_b128 a[188:191], v7 offset:192
  v_fma_f32 v92, v64, s30, v26
  v_mfma_f32_16x16x32_bf16 v[160:163], a[194:197], v[80:83], v[160:163]
  v_exp_f32 v31, v93
  v_mfma_f32_16x16x32_bf16 v[164:167], a[200:203], v[80:83], v[164:167]
  v_fma_f32 v93, v65, s30, v26
  v_cvt_pk_bf16_f32 v85, v30, v31
  v_mfma_f32_16x16x32_bf16 v[168:171], a[206:209], v[80:83], v[168:171]
  v_exp_f32 v28, v92
  v_mfma_f32_16x16x32_bf16 v[172:175], a[212:215], v[80:83], v[172:175]
  ds_read_b64_tr_b16 a[192:193], v8 offset:0
  v_fma_f32 v92, v66, s30, v26
  v_mfma_f32_16x16x32_bf16 v[176:179], a[218:221], v[80:83], v[176:179]
  v_exp_f32 v29, v93
  v_mfma_f32_16x16x32_bf16 v[180:183], a[224:227], v[80:83], v[180:183]
  v_fma_f32 v93, v67, s30, v26
  v_cvt_pk_bf16_f32 v86, v28, v29
  v_mfma_f32_16x16x32_bf16 v[184:187], a[230:233], v[80:83], v[184:187]
  v_exp_f32 v30, v92
  v_mfma_f32_16x16x32_bf16 v[188:191], a[236:239], v[80:83], v[188:191]
  ds_read_b64_tr_b16 a[198:199], v8 offset:8
  v_fma_f32 v92, v68, s30, v27
  v_mfma_f32_16x16x32_bf16 v[52:55], a[160:163], a[0:3], 0
  v_exp_f32 v31, v93
  v_mfma_f32_16x16x32_bf16 v[52:55], a[164:167], a[4:7], v[52:55]
  v_cvt_pk_bf16_f32 v87, v30, v31
  v_fma_f32 v93, v69, s30, v27
  v_mfma_f32_16x16x32_bf16 v[52:55], a[168:171], a[8:11], v[52:55]
  v_exp_f32 v28, v92
  v_mfma_f32_16x16x32_bf16 v[52:55], a[172:175], a[12:15], v[52:55]
  ds_read_b64_tr_b16 a[204:205], v8 offset:64
  v_fma_f32 v92, v70, s30, v27
  v_mfma_f32_16x16x32_bf16 v[56:59], a[176:179], a[0:3], 0
  v_exp_f32 v29, v93
  s_waitcnt lgkmcnt(2)
  v_mfma_f32_16x16x32_bf16 v[56:59], a[180:183], a[4:7], v[56:59]
  v_fma_f32 v93, v71, s30, v27
  v_cvt_pk_bf16_f32 v88, v28, v29
  v_mfma_f32_16x16x32_bf16 v[56:59], a[184:187], a[8:11], v[56:59]
  v_exp_f32 v30, v92
  v_mfma_f32_16x16x32_bf16 v[56:59], a[188:191], a[12:15], v[56:59]
  ds_read_b64_tr_b16 a[210:211], v8 offset:72
  v_fma_f32 v92, v52, s30, v23
  v_mfma_f32_16x16x32_bf16 v[44:47], a[240:243], v[84:87], v[44:47]
  v_exp_f32 v31, v93
  v_mfma_f32_16x16x32_bf16 v[192:195], a[194:197], v[84:87], v[192:195]
  v_cvt_pk_bf16_f32 v89, v30, v31
  v_fma_f32 v93, v53, s30, v23
  v_mfma_f32_16x16x32_bf16 v[196:199], a[200:203], v[84:87], v[196:199]
  v_exp_f32 v28, v92
  v_mfma_f32_16x16x32_bf16 v[200:203], a[206:209], v[84:87], v[200:203]
  ds_read_b64_tr_b16 a[216:217], v9 offset:0
  v_fma_f32 v92, v54, s30, v23
  v_mfma_f32_16x16x32_bf16 v[204:207], a[212:215], v[84:87], v[204:207]
  v_exp_f32 v29, v93
  v_mfma_f32_16x16x32_bf16 v[208:211], a[218:221], v[84:87], v[208:211]
  v_fma_f32 v93, v55, s30, v23
  v_cvt_pk_bf16_f32 v72, v28, v29
  v_mfma_f32_16x16x32_bf16 v[212:215], a[224:227], v[84:87], v[212:215]
  v_exp_f32 v30, v92
  v_mfma_f32_16x16x32_bf16 v[216:219], a[230:233], v[84:87], v[216:219]
  ds_read_b64_tr_b16 a[222:223], v9 offset:8
  v_fma_f32 v92, v56, s30, v23
  v_mfma_f32_16x16x32_bf16 v[220:223], a[236:239], v[84:87], v[220:223]
  v_exp_f32 v31, v93
  v_mfma_f32_16x16x32_bf16 v[60:63], a[160:163], a[16:19], 0
  v_fma_f32 v93, v57, s30, v23
  v_cvt_pk_bf16_f32 v73, v30, v31
  v_mfma_f32_16x16x32_bf16 v[60:63], a[164:167], a[20:23], v[60:63]
  v_exp_f32 v28, v92
  v_mfma_f32_16x16x32_bf16 v[60:63], a[168:171], a[24:27], v[60:63]
  ds_read_b64_tr_b16 a[228:229], v9 offset:64
  v_fma_f32 v92, v58, s30, v23
  v_mfma_f32_16x16x32_bf16 v[60:63], a[172:175], a[28:31], v[60:63]
  v_exp_f32 v29, v93
  v_mfma_f32_16x16x32_bf16 v[64:67], a[176:179], a[16:19], 0
  ds_read_b64_tr_b16 a[234:235], v9 offset:72
  v_fma_f32 v93, v59, s30, v23
  v_mfma_f32_16x16x32_bf16 v[64:67], a[180:183], a[20:23], v[64:67]
  ds_read_b64_tr_b16 a[194:195], v10 offset:0
  v_cvt_pk_bf16_f32 v74, v28, v29
  v_mfma_f32_16x16x32_bf16 v[64:67], a[184:187], a[24:27], v[64:67]
  v_exp_f32 v30, v92
  v_mfma_f32_16x16x32_bf16 v[64:67], a[188:191], a[28:31], v[64:67]
  ds_read_b64_tr_b16 a[200:201], v10 offset:8
  v_fma_f32 v92, v60, s30, v24
  v_mfma_f32_16x16x32_bf16 v[52:55], a[160:163], a[32:35], 0
  ds_read_b64_tr_b16 a[206:207], v10 offset:64
  ds_read_b64_tr_b16 a[212:213], v10 offset:72
  v_mfma_f32_16x16x32_bf16 v[52:55], a[164:167], a[36:39], v[52:55]
  v_exp_f32 v31, v93
  v_mfma_f32_16x16x32_bf16 v[52:55], a[168:171], a[40:43], v[52:55]
  ds_read_b64_tr_b16 a[218:219], v11 offset:0
  v_cvt_pk_bf16_f32 v75, v30, v31
  v_mfma_f32_16x16x32_bf16 v[52:55], a[172:175], a[44:47], v[52:55]
  ds_read_b64_tr_b16 a[224:225], v11 offset:8
  ds_read_b64_tr_b16 a[230:231], v11 offset:64
  v_mfma_f32_16x16x32_bf16 v[56:59], a[176:179], a[32:35], 0
  ds_read_b64_tr_b16 a[236:237], v11 offset:72
  s_add_u32 m0, s24, 25344
  v_mfma_f32_16x16x32_bf16 v[56:59], a[180:183], a[36:39], v[56:59]
  s_xor_b32 s33, s27, 33562624
  buffer_load_dwordx4 v2, s[12:15], s33 offen nt lds
  v_mfma_f32_16x16x32_bf16 v[56:59], a[184:187], a[40:43], v[56:59]
  buffer_load_dwordx4 v3, s[12:15], s33 offen offset:1024 nt lds
  v_fma_f32 v93, v61, s30, v24
  v_mfma_f32_16x16x32_bf16 v[56:59], a[188:191], a[44:47], v[56:59]
  s_add_u32 m0, s25, 24960
  s_nop 0
  buffer_load_dwordx4 v4, s[16:19], s33 offen nt lds
  v_mfma_f32_16x16x32_bf16 v[32:35], a[240:243], v[72:75], v[32:35]
  v_exp_f32 v28, v92
  s_waitcnt lgkmcnt(3)
  v_mfma_f32_16x16x32_bf16 v[96:99], a[192:195], v[72:75], v[96:99]
  buffer_load_dwordx4 v5, s[16:19], s33 offen offset:1024 nt lds
  v_fma_f32 v92, v62, s30, v24
  v_mfma_f32_16x16x32_bf16 v[100:103], a[198:201], v[72:75], v[100:103]
  s_add_u32 m0, s24, 33792
  s_xor_b32 s33, s27, 33570816
  v_mfma_f32_16x16x32_bf16 v[104:107], a[204:207], v[72:75], v[104:107]
  v_exp_f32 v29, v93
  v_mfma_f32_16x16x32_bf16 v[108:111], a[210:213], v[72:75], v[108:111]
  buffer_load_dwordx4 v2, s[12:15], s33 offen nt lds
  v_fma_f32 v93, v63, s30, v24
  v_mfma_f32_16x16x32_bf16 v[112:115], a[216:219], v[72:75], v[112:115]
  buffer_load_dwordx4 v3, s[12:15], s33 offen offset:1024 nt lds
  v_cvt_pk_bf16_f32 v76, v28, v29
  s_waitcnt lgkmcnt(0)
  v_mfma_f32_16x16x32_bf16 v[116:119], a[222:225], v[72:75], v[116:119]
  v_exp_f32 v30, v92
  v_mfma_f32_16x16x32_bf16 v[120:123], a[228:231], v[72:75], v[120:123]
  s_add_u32 m0, s25, 33280
  s_nop 0
  buffer_load_dwordx4 v4, s[16:19], s33 offen nt lds
  buffer_load_dwordx4 v5, s[16:19], s33 offen offset:1024 nt lds
  v_fma_f32 v92, v64, s30, v24
  v_mfma_f32_16x16x32_bf16 v[124:127], a[234:237], v[72:75], v[124:127]
  v_exp_f32 v31, v93
  v_fma_f32 v93, v65, s30, v24
  s_waitcnt vmcnt(12)
  s_barrier
  v_mfma_f32_16x16x32_bf16 v[60:63], a[160:163], a[48:51], 0
  v_cvt_pk_bf16_f32 v77, v30, v31
  v_exp_f32 v28, v92
  v_mfma_f32_16x16x32_bf16 v[60:63], a[164:167], a[52:55], v[60:63]
  ds_read_b128 a[160:163], v6 offset:8448
  v_fma_f32 v92, v66, s30, v24
  v_mfma_f32_16x16x32_bf16 v[60:63], a[168:171], a[56:59], v[60:63]
  v_exp_f32 v29, v93
  v_fma_f32 v93, v67, s30, v24
  v_cvt_pk_bf16_f32 v78, v28, v29
  v_mfma_f32_16x16x32_bf16 v[60:63], a[172:175], a[60:63], v[60:63]
  v_exp_f32 v30, v92
  v_mfma_f32_16x16x32_bf16 v[64:67], a[176:179], a[48:51], 0
  v_fma_f32 v92, v52, s30, v25
  v_exp_f32 v31, v93
  v_mfma_f32_16x16x32_bf16 v[64:67], a[180:183], a[52:55], v[64:67]
  v_cvt_pk_bf16_f32 v79, v30, v31
  v_fma_f32 v93, v53, s30, v25
  v_mfma_f32_16x16x32_bf16 v[64:67], a[184:187], a[56:59], v[64:67]
  v_exp_f32 v28, v92
  v_mfma_f32_16x16x32_bf16 v[64:67], a[188:191], a[60:63], v[64:67]
  ds_read_b128 a[164:167], v6 offset:8512
  v_fma_f32 v92, v54, s30, v25
  v_mfma_f32_16x16x32_bf16 v[36:39], a[240:243], v[76:79], v[36:39]
  v_exp_f32 v29, v93
  v_mfma_f32_16x16x32_bf16 v[128:131], a[192:195], v[76:79], v[128:131]
  v_fma_f32 v93, v55, s30, v25
  v_cvt_pk_bf16_f32 v80, v28, v29
  v_mfma_f32_16x16x32_bf16 v[132:135], a[198:201], v[76:79], v[132:135]
  v_exp_f32 v30, v92
  v_mfma_f32_16x16x32_bf16 v[136:139], a[204:207], v[76:79], v[136:139]
  ds_read_b128 a[168:171], v6 offset:8576
  v_fma_f32 v92, v56, s30, v25
  v_mfma_f32_16x16x32_bf16 v[140:143], a[210:213], v[76:79], v[140:143]
  v_exp_f32 v31, v93
  v_fma_f32 v93, v57, s30, v25
  v_mfma_f32_16x16x32_bf16 v[144:147], a[216:219], v[76:79], v[144:147]
  ds_read_b128 a[172:175], v6 offset:8640
  v_cvt_pk_bf16_f32 v81, v30, v31
  v_exp_f32 v28, v92
  v_mfma_f32_16x16x32_bf16 v[148:151], a[222:225], v[76:79], v[148:151]
  ds_read_b128 a[176:179], v7 offset:8448
  v_fma_f32 v92, v58, s30, v25
  v_mfma_f32_16x16x32_bf16 v[152:155], a[228:231], v[76:79], v[152:155]
  v_exp_f32 v29, v93
  v_fma_f32 v93, v59, s30, v25
  v_cvt_pk_bf16_f32 v82, v28, v29
  v_mfma_f32_16x16x32_bf16 v[156:159], a[234:237], v[76:79], v[156:159]
  v_exp_f32 v30, v92
  s_waitcnt lgkmcnt(3)
  v_mfma_f32_16x16x32_bf16 v[68:71], a[160:163], a[128:131], 0
  v_fma_f32 v92, v60, s30, v26
  v_exp_f32 v31, v93
  v_mfma_f32_16x16x32_bf16 v[68:71], a[164:167], a[132:135], v[68:71]
  v_cvt_pk_bf16_f32 v83, v30, v31
  v_fma_f32 v93, v61, s30, v26
  s_waitcnt lgkmcnt(2)
  v_mfma_f32_16x16x32_bf16 v[68:71], a[168:171], a[136:139], v[68:71]
  v_exp_f32 v28, v92
  s_waitcnt lgkmcnt(1)
  v_mfma_f32_16x16x32_bf16 v[68:71], a[172:175], a[140:143], v[68:71]
  ds_read_b128 a[180:183], v7 offset:8512
  v_fma_f32 v92, v62, s30, v26
  v_mfma_f32_16x16x32_bf16 v[40:43], a[240:243], v[80:83], v[40:43]
  v_exp_f32 v29, v93
  v_mfma_f32_16x16x32_bf16 v[160:163], a[192:195], v[80:83], v[160:163]
  v_fma_f32 v93, v63, s30, v26
  v_cvt_pk_bf16_f32 v84, v28, v29
  v_mfma_f32_16x16x32_bf16 v[164:167], a[198:201], v[80:83], v[164:167]
  v_exp_f32 v30, v92
  v_mfma_f32_16x16x32_bf16 v[168:171], a[204:207], v[80:83], v[168:171]
  ds_read_b128 a[184:187], v7 offset:8576
  v_fma_f32 v92, v64, s30, v26
  v_mfma_f32_16x16x32_bf16 v[172:175], a[210:213], v[80:83], v[172:175]
  v_exp_f32 v31, v93
  v_mfma_f32_16x16x32_bf16 v[176:179], a[216:219], v[80:83], v[176:179]
  v_fma_f32 v93, v65, s30, v26
  v_cvt_pk_bf16_f32 v85, v30, v31
  v_mfma_f32_16x16x32_bf16 v[180:183], a[222:225], v[80:83], v[180:183]
  v_exp_f32 v28, v92
  v_mfma_f32_16x16x32_bf16 v[184:187], a[228:231], v[80:83], v[184:187]
  ds_read_b128 a[188:191], v7 offset:8640
  v_fma_f32 v92, v66, s30, v26
  v_mfma_f32_16x16x32_bf16 v[188:191], a[234:237], v[80:83], v[188:191]
  v_exp_f32 v29, v93
  v_mfma_f32_16x16x32_bf16 v[52:55], a[160:163], a[0:3], 0
  v_fma_f32 v93, v67, s30, v26
  v_cvt_pk_bf16_f32 v86, v28, v29
  v_mfma_f32_16x16x32_bf16 v[52:55], a[164:167], a[4:7], v[52:55]
  v_exp_f32 v30, v92
  v_mfma_f32_16x16x32_bf16 v[52:55], a[168:171], a[8:11], v[52:55]
  ds_read_b64_tr_b16 a[196:197], v10 offset:8320
  v_fma_f32 v92, v68, s30, v27
  v_mfma_f32_16x16x32_bf16 v[52:55], a[172:175], a[12:15], v[52:55]
  v_exp_f32 v31, v93
  s_waitcnt lgkmcnt(2)
  v_mfma_f32_16x16x32_bf16 v[56:59], a[176:179], a[0:3], 0
  ds_read_b64_tr_b16 a[202:203], v10 offset:8328
  v_cvt_pk_bf16_f32 v87, v30, v31
  v_mfma_f32_16x16x32_bf16 v[56:59], a[180:183], a[4:7], v[56:59]
  ds_read_b64_tr_b16 a[208:209], v10 offset:8384
  v_fma_f32 v93, v69, s30, v27
  v_mfma_f32_16x16x32_bf16 v[56:59], a[184:187], a[8:11], v[56:59]
  ds_read_b64_tr_b16 a[214:215], v10 offset:8392
  ds_read_b64_tr_b16 a[220:221], v11 offset:8320
  s_waitcnt lgkmcnt(5)
  v_mfma_f32_16x16x32_bf16 v[56:59], a[188:191], a[12:15], v[56:59]
  v_exp_f32 v28, v92
  v_mfma_f32_16x16x32_bf16 v[44:47], a[240:243], v[84:87], v[44:47]
  ds_read_b64_tr_b16 a[226:227], v11 offset:8328
  v_fma_f32 v92, v70, s30, v27
  v_mfma_f32_16x16x32_bf16 v[192:195], a[192:195], v[84:87], v[192:195]
  ds_read_b64_tr_b16 a[232:233], v11 offset:8384
  ds_read_b64_tr_b16 a[238:239], v11 offset:8392
  v_mfma_f32_16x16x32_bf16 v[196:199], a[198:201], v[84:87], v[196:199]
  v_exp_f32 v29, v93
  v_mfma_f32_16x16x32_bf16 v[200:203], a[204:207], v[84:87], v[200:203]
  ds_read_b64_tr_b16 a[194:195], v8 offset:8320
  v_fma_f32 v93, v71, s30, v27
  v_mfma_f32_16x16x32_bf16 v[204:207], a[210:213], v[84:87], v[204:207]
  ds_read_b64_tr_b16 a[200:201], v8 offset:8328
  v_cvt_pk_bf16_f32 v90, v28, v29
  v_mfma_f32_16x16x32_bf16 v[208:211], a[216:219], v[84:87], v[208:211]
  v_exp_f32 v30, v92
  v_mfma_f32_16x16x32_bf16 v[212:215], a[222:225], v[84:87], v[212:215]
  ds_read_b64_tr_b16 a[206:207], v8 offset:8384
  v_fma_f32 v92, v52, s30, v23
  v_mfma_f32_16x16x32_bf16 v[216:219], a[228:231], v[84:87], v[216:219]
  v_exp_f32 v31, v93
  v_mfma_f32_16x16x32_bf16 v[220:223], a[234:237], v[84:87], v[220:223]
  ds_read_b64_tr_b16 a[212:213], v8 offset:8392
  v_cvt_pk_bf16_f32 v91, v30, v31
  v_mfma_f32_16x16x32_bf16 v[60:63], a[160:163], a[16:19], 0
  ds_read_b64_tr_b16 a[218:219], v9 offset:8320
  ds_read_b64_tr_b16 a[224:225], v9 offset:8328
  v_mfma_f32_16x16x32_bf16 v[60:63], a[164:167], a[20:23], v[60:63]
  ds_read_b64_tr_b16 a[230:231], v9 offset:8384
  ds_read_b64_tr_b16 a[236:237], v9 offset:8392
  v_mfma_f32_16x16x32_bf16 v[60:63], a[168:171], a[24:27], v[60:63]
  s_add_u32 m0, s24, 42240
  v_fma_f32 v93, v53, s30, v23
  v_mfma_f32_16x16x32_bf16 v[60:63], a[172:175], a[28:31], v[60:63]
  v_exp_f32 v28, v92
  v_mfma_f32_16x16x32_bf16 v[64:67], a[176:179], a[16:19], 0
  s_xor_b32 s33, s27, 33579008
  v_fma_f32 v92, v54, s30, v23
  v_mfma_f32_16x16x32_bf16 v[64:67], a[180:183], a[20:23], v[64:67]
  v_exp_f32 v29, v93
  v_mfma_f32_16x16x32_bf16 v[64:67], a[184:187], a[24:27], v[64:67]
  v_fma_f32 v93, v55, s30, v23
  v_cvt_pk_bf16_f32 v72, v28, v29
  v_mfma_f32_16x16x32_bf16 v[64:67], a[188:191], a[28:31], v[64:67]
  v_exp_f32 v30, v92
  v_mfma_f32_16x16x32_bf16 v[48:51], a[240:243], v[88:91], v[48:51]
  buffer_load_dwordx4 v2, s[12:15], s33 offen nt lds
  v_fma_f32 v92, v56, s30, v23
  s_waitcnt lgkmcnt(0)
  v_mfma_f32_16x16x32_bf16 v[224:227], a[192:195], v[88:91], v[224:227]
  v_exp_f32 v31, v93
  v_mfma_f32_16x16x32_bf16 v[228:231], a[198:201], v[88:91], v[228:231]
  v_fma_f32 v93, v57, s30, v23
  v_cvt_pk_bf16_f32 v73, v30, v31
  v_mfma_f32_16x16x32_bf16 v[232:235], a[204:207], v[88:91], v[232:235]
  v_exp_f32 v28, v92
  v_mfma_f32_16x16x32_bf16 v[236:239], a[210:213], v[88:91], v[236:239]
  buffer_load_dwordx4 v3, s[12:15], s33 offen offset:1024 nt lds
  v_fma_f32 v92, v58, s30, v23
  v_mfma_f32_16x16x32_bf16 v[240:243], a[216:219], v[88:91], v[240:243]
  v_exp_f32 v29, v93
  v_mfma_f32_16x16x32_bf16 v[244:247], a[222:225], v[88:91], v[244:247]
  v_fma_f32 v93, v59, s30, v23
  v_cvt_pk_bf16_f32 v74, v28, v29
  v_mfma_f32_16x16x32_bf16 v[248:251], a[228:231], v[88:91], v[248:251]
  v_exp_f32 v30, v92
  v_mfma_f32_16x16x32_bf16 v[252:255], a[234:237], v[88:91], v[252:255]
  s_add_u32 m0, s25, 41600
  v_fma_f32 v92, v60, s30, v24
  v_mfma_f32_16x16x32_bf16 v[52:55], a[160:163], a[32:35], 0
  v_exp_f32 v31, v93
  v_mfma_f32_16x16x32_bf16 v[52:55], a[164:167], a[36:39], v[52:55]
  v_cvt_pk_bf16_f32 v75, v30, v31
  v_fma_f32 v93, v61, s30, v24
  v_mfma_f32_16x16x32_bf16 v[52:55], a[168:171], a[40:43], v[52:55]
  s_add_u32 s36, s26, 4352
  v_add_u32 v0, s36, v17
  v_mfma_f32_16x16x32_bf16 v[52:55], a[172:175], a[44:47], v[52:55]
  v_bfe_u32 v1, v17, 1, 7
  v_mov_b32 v18, v27
  v_mfma_f32_16x16x32_bf16 v[56:59], a[176:179], a[32:35], 0
  v_mov_b32 v19, v48
  ds_write_b128 v0, v[240:243] offset:0
  v_mfma_f32_16x16x32_bf16 v[56:59], a[180:183], a[36:39], v[56:59]
  ds_write_b128 v0, v[244:247] offset:1024
  ds_write_b128 v0, v[248:251] offset:2048
  v_mfma_f32_16x16x32_bf16 v[56:59], a[184:187], a[40:43], v[56:59]
  ds_write_b128 v0, v[252:255] offset:3072
  v_add_u32 v0, s36, v1
  v_mfma_f32_16x16x32_bf16 v[56:59], a[188:191], a[44:47], v[56:59]
  buffer_load_dwordx4 v4, s[16:19], s33 offen nt lds
  ds_write_b64 v0, v[18:19] offset:4096
  v_mfma_f32_16x16x32_bf16 v[32:35], a[240:243], v[72:75], v[32:35]
  v_exp_f32 v28, v92
  v_mfma_f32_16x16x32_bf16 v[96:99], a[194:197], v[72:75], v[96:99]
  buffer_load_dwordx4 v5, s[16:19], s33 offen offset:1024 nt lds
  v_fma_f32 v92, v62, s30, v24
  v_mfma_f32_16x16x32_bf16 v[100:103], a[200:203], v[72:75], v[100:103]
  s_add_u32 m0, s24, 50688
  s_xor_b32 s33, s27, 33587200
  v_mfma_f32_16x16x32_bf16 v[104:107], a[206:209], v[72:75], v[104:107]
  v_exp_f32 v29, v93
  v_mfma_f32_16x16x32_bf16 v[108:111], a[212:215], v[72:75], v[108:111]
  buffer_load_dwordx4 v2, s[12:15], s33 offen nt lds
  v_fma_f32 v93, v63, s30, v24
  v_mfma_f32_16x16x32_bf16 v[112:115], a[218:221], v[72:75], v[112:115]
  buffer_load_dwordx4 v3, s[12:15], s33 offen offset:1024 nt lds
  v_cvt_pk_bf16_f32 v76, v28, v29
  v_mfma_f32_16x16x32_bf16 v[116:119], a[224:227], v[72:75], v[116:119]
  v_exp_f32 v30, v92
  v_mfma_f32_16x16x32_bf16 v[120:123], a[230:233], v[72:75], v[120:123]
  s_add_u32 m0, s25, 49920
  s_nop 0
  buffer_load_dwordx4 v4, s[16:19], s33 offen nt lds
  buffer_load_dwordx4 v5, s[16:19], s33 offen offset:1024 nt lds
  v_fma_f32 v92, v64, s30, v24
  v_mfma_f32_16x16x32_bf16 v[124:127], a[236:239], v[72:75], v[124:127]
  v_exp_f32 v31, v93
  v_fma_f32 v93, v65, s30, v24
  s_waitcnt vmcnt(16)
  s_waitcnt lgkmcnt(0)
  s_barrier
  v_mfma_f32_16x16x32_bf16 v[60:63], a[160:163], a[48:51], 0
  v_cvt_pk_bf16_f32 v77, v30, v31
  v_exp_f32 v28, v92
  v_mfma_f32_16x16x32_bf16 v[60:63], a[164:167], a[52:55], v[60:63]
  v_fma_f32 v92, v66, s30, v24
  v_add_u32 v0, s40, v1
  v_mfma_f32_16x16x32_bf16 v[60:63], a[168:171], a[56:59], v[60:63]
  v_exp_f32 v29, v93
  v_fma_f32 v93, v67, s30, v24
  v_cvt_pk_bf16_f32 v78, v28, v29
  v_mfma_f32_16x16x32_bf16 v[60:63], a[172:175], a[60:63], v[60:63]
  ds_read_b64 v[20:21], v0 offset:4096
  v_add_u32 v0, s40, v17
  v_exp_f32 v30, v92
  v_mfma_f32_16x16x32_bf16 v[64:67], a[176:179], a[48:51], 0
  ds_read_b128 v[240:243], v0 offset:0
  v_fma_f32 v92, v52, s30, v25
  ds_read_b128 v[244:247], v0 offset:1024
  ds_read_b128 v[248:251], v0 offset:2048
  v_exp_f32 v31, v93
  v_mfma_f32_16x16x32_bf16 v[64:67], a[180:183], a[52:55], v[64:67]
  ds_read_b128 v[252:255], v0 offset:3072
  v_cvt_pk_bf16_f32 v79, v30, v31
  v_mfma_f32_16x16x32_bf16 v[64:67], a[184:187], a[56:59], v[64:67]
  v_rcp_f32 v22, v32
  v_fma_f32 v93, v53, s30, v25
  v_cmp_nge_f32 vcc, s32, v32
  s_nop 0
  s_or_b64 s[42:43], s[42:43], vcc
  v_mfma_f32_16x16x32_bf16 v[64:67], a[188:191], a[60:63], v[64:67]
  v_mul_f32 v96, v22, v96
  v_exp_f32 v28, v92
  v_mul_f32 v97, v22, v97
  v_fma_f32 v92, v54, s30, v25
  v_mfma_f32_16x16x32_bf16 v[36:39], a[240:243], v[76:79], v[36:39]
  v_mul_f32 v98, v22, v98
  v_mul_f32 v99, v22, v99
  v_exp_f32 v29, v93
  v_mul_f32 v100, v22, v100
  v_fma_f32 v93, v55, s30, v25
  v_mfma_f32_16x16x32_bf16 v[128:131], a[194:197], v[76:79], v[128:131]
  v_mul_f32 v101, v22, v101
  v_cvt_pk_bf16_f32 v80, v28, v29
  v_mul_f32 v102, v22, v102
  v_mfma_f32_16x16x32_bf16 v[132:135], a[200:203], v[76:79], v[132:135]
  ds_read_b128 a[160:163], v6 offset:16896
  v_mul_f32 v103, v22, v103
  v_exp_f32 v30, v92
  v_cvt_pk_bf16_f32 v96, v96, v97
  v_fma_f32 v92, v56, s30, v25
  v_cvt_pk_bf16_f32 v97, v98, v99
  v_mfma_f32_16x16x32_bf16 v[136:139], a[206:209], v[76:79], v[136:139]
  ds_read_b128 a[164:167], v6 offset:16960
  v_cvt_pk_bf16_f32 v98, v100, v101
  v_exp_f32 v31, v93
  v_cvt_pk_bf16_f32 v99, v102, v103
  v_fma_f32 v93, v57, s30, v25
  v_mfma_f32_16x16x32_bf16 v[140:143], a[212:215], v[76:79], v[140:143]
  ds_read_b128 a[168:171], v6 offset:17024
  ds_write_b128 v14, v[96:99] offset:0
  v_cvt_pk_bf16_f32 v81, v30, v31
  v_mul_f32 v104, v22, v104
  v_mul_f32 v105, v22, v105
  v_exp_f32 v28, v92
  v_mfma_f32_16x16x32_bf16 v[144:147], a[218:221], v[76:79], v[144:147]
  ds_read_b128 a[172:175], v6 offset:17088
  v_mul_f32 v106, v22, v106
  v_fma_f32 v92, v58, s30, v25
  v_mul_f32 v107, v22, v107
  v_mfma_f32_16x16x32_bf16 v[148:151], a[224:227], v[76:79], v[148:151]
  v_mul_f32 v108, v22, v108
  v_exp_f32 v29, v93
  v_mul_f32 v109, v22, v109
  v_fma_f32 v93, v59, s30, v25
  v_mul_f32 v110, v22, v110
  v_cvt_pk_bf16_f32 v82, v28, v29
  v_mfma_f32_16x16x32_bf16 v[152:155], a[230:233], v[76:79], v[152:155]
  v_mul_f32 v111, v22, v111
  v_cvt_pk_bf16_f32 v104, v104, v105
  v_exp_f32 v30, v92
  v_mfma_f32_16x16x32_bf16 v[156:159], a[236:239], v[76:79], v[156:159]
  v_cvt_pk_bf16_f32 v105, v106, v107
  v_fma_f32 v92, v60, s30, v26
  v_cvt_pk_bf16_f32 v106, v108, v109
  v_cvt_pk_bf16_f32 v107, v110, v111
  v_exp_f32 v31, v93
  s_waitcnt lgkmcnt(4)
  v_mfma_f32_16x16x32_bf16 v[68:71], a[160:163], a[144:147], 0
  ds_write_b128 v14, v[104:107] offset:64
  v_cvt_pk_bf16_f32 v83, v30, v31
  v_mul_f32 v112, v22, v112
  v_fma_f32 v93, v61, s30, v26
  s_waitcnt lgkmcnt(4)
  v_mfma_f32_16x16x32_bf16 v[68:71], a[164:167], a[148:151], v[68:71]
  v_mul_f32 v113, v22, v113
  v_mul_f32 v114, v22, v114
  v_exp_f32 v28, v92
  v_mul_f32 v115, v22, v115
  v_fma_f32 v92, v62, s30, v26
  s_waitcnt lgkmcnt(2)
  v_mfma_f32_16x16x32_bf16 v[68:71], a[168:171], a[152:155], v[68:71]
  v_mul_f32 v116, v22, v116
  v_mul_f32 v117, v22, v117
  v_exp_f32 v29, v93
  s_waitcnt lgkmcnt(1)
  v_mfma_f32_16x16x32_bf16 v[68:71], a[172:175], a[156:159], v[68:71]
  v_mul_f32 v118, v22, v118
  v_fma_f32 v93, v63, s30, v26
  v_mul_f32 v119, v22, v119
  v_cvt_pk_bf16_f32 v84, v28, v29
  v_cvt_pk_bf16_f32 v112, v112, v113
  v_mfma_f32_16x16x32_bf16 v[40:43], a[240:243], v[80:83], v[40:43]
  v_cvt_pk_bf16_f32 v113, v114, v115
  v_exp_f32 v30, v92
  v_cvt_pk_bf16_f32 v114, v116, v117
  v_fma_f32 v92, v64, s30, v26
  v_mfma_f32_16x16x32_bf16 v[160:163], a[194:197], v[80:83], v[160:163]
  v_cvt_pk_bf16_f32 v115, v118, v119
  ds_write_b128 v15, v[112:115] offset:0
  v_exp_f32 v31, v93
  v_mul_f32 v120, v22, v120
  v_fma_f32 v93, v65, s30, v26
  v_mfma_f32_16x16x32_bf16 v[164:167], a[200:203], v[80:83], v[164:167]
  v_mul_f32 v121, v22, v121
  v_cvt_pk_bf16_f32 v85, v30, v31
  v_mul_f32 v122, v22, v122
  v_mfma_f32_16x16x32_bf16 v[168:171], a[206:209], v[80:83], v[168:171]
  v_mul_f32 v123, v22, v123
  v_exp_f32 v28, v92
  v_mul_f32 v124, v22, v124
  v_fma_f32 v92, v66, s30, v26
  v_mul_f32 v125, v22, v125
  v_mfma_f32_16x16x32_bf16 v[172:175], a[212:215], v[80:83], v[172:175]
  v_mul_f32 v126, v22, v126
  v_exp_f32 v29, v93
  v_mul_f32 v127, v22, v127
  v_fma_f32 v93, v67, s30, v26
  v_mfma_f32_16x16x32_bf16 v[176:179], a[218:221], v[80:83], v[176:179]
  v_cvt_pk_bf16_f32 v120, v120, v121
  v_cvt_pk_bf16_f32 v86, v28, v29
  v_cvt_pk_bf16_f32 v121, v122, v123
  v_cvt_pk_bf16_f32 v122, v124, v125
  v_exp_f32 v30, v92
  v_mfma_f32_16x16x32_bf16 v[180:183], a[224:227], v[80:83], v[180:183]
  ds_read_b128 a[176:179], v7 offset:16896
  v_cvt_pk_bf16_f32 v123, v126, v127
  v_max3_f32 v94, v68, v69, v70
  ds_write_b128 v15, v[120:123] offset:64
  v_max_f32 v94, v94, v71
  v_mfma_f32_16x16x32_bf16 v[184:187], a[230:233], v[80:83], v[184:187]
  ds_read_b128 a[180:183], v7 offset:16960
  ds_read_b128 a[0:3], v16 offset:0
  v_mov_b32 v95, v94
  ds_read_b128 a[4:7], v16 offset:1088
  ds_read_b128 a[8:11], v16 offset:2176
  v_exp_f32 v31, v93
  v_mfma_f32_16x16x32_bf16 v[188:191], a[236:239], v[80:83], v[188:191]
  ds_read_b128 a[184:187], v7 offset:17024
  ds_read_b128 a[12:15], v16 offset:3264
  v_permlane32_swap_b32 v94, v95
  v_max_f32 v94, v94, v95
  v_mfma_f32_16x16x32_bf16 v[52:55], a[160:163], a[64:67], 0
  ds_read_b128 a[188:191], v7 offset:17088
  v_rcp_f32 v22, v36
  v_mov_b32 v95, v94
  v_accvgpr_read_b32 v27, a253
  v_cmp_nge_f32 vcc, s32, v36
  s_nop 0
  s_or_b64 s[42:43], s[42:43], vcc
  v_cvt_pk_bf16_f32 v87, v30, v31
  v_mfma_f32_16x16x32_bf16 v[52:55], a[164:167], a[68:71], v[52:55]
  v_mul_f32 v128, v22, v128
  v_permlane16_swap_b32 v94, v95
  v_mul_f32 v129, v22, v129
  v_max_f32 v94, v94, v95
  v_mfma_f32_16x16x32_bf16 v[52:55], a[168:171], a[72:75], v[52:55]
  v_mul_f32 v130, v22, v130
  v_mul_f32 v94, s31, v94
  v_mul_f32 v131, v22, v131
  v_min_f32 v27, v27, v94
  v_mul_f32 v132, v22, v132
  v_fma_f32 v92, v68, s30, v27
  v_mfma_f32_16x16x32_bf16 v[52:55], a[172:175], a[76:79], v[52:55]
  v_mul_f32 v133, v22, v133
  v_fma_f32 v93, v69, s30, v27
  v_mul_f32 v134, v22, v134
  s_waitcnt lgkmcnt(7)
  v_mfma_f32_16x16x32_bf16 v[56:59], a[176:179], a[64:67], 0
  v_mul_f32 v135, v22, v135
  v_exp_f32 v28, v92
  v_cvt_pk_bf16_f32 v128, v128, v129
  v_fma_f32 v92, v70, s30, v27
  v_cvt_pk_bf16_f32 v129, v130, v131
  s_waitcnt lgkmcnt(3)
  v_mfma_f32_16x16x32_bf16 v[56:59], a[180:183], a[68:71], v[56:59]
  v_cvt_pk_bf16_f32 v130, v132, v133
  v_exp_f32 v29, v93
  v_cvt_pk_bf16_f32 v131, v134, v135
  v_fma_f32 v93, v71, s30, v27
  s_waitcnt lgkmcnt(1)
  v_mfma_f32_16x16x32_bf16 v[56:59], a[184:187], a[72:75], v[56:59]
  ds_write_b128 v14, v[128:131] offset:0
  v_cvt_pk_bf16_f32 v88, v28, v29
  v_mul_f32 v136, v22, v136
  v_mul_f32 v137, v22, v137
  v_exp_f32 v30, v92
  s_waitcnt lgkmcnt(1)
  v_mfma_f32_16x16x32_bf16 v[56:59], a[188:191], a[76:79], v[56:59]
  v_mul_f32 v138, v22, v138
  v_mul_f32 v139, v22, v139
  v_mfma_f32_16x16x32_bf16 v[44:47], a[240:243], v[84:87], v[44:47]
  v_mul_f32 v140, v22, v140
  v_mul_f32 v141, v22, v141
  v_mul_f32 v142, v22, v142
  v_mfma_f32_16x16x32_bf16 v[192:195], a[194:197], v[84:87], v[192:195]
  v_mul_f32 v143, v22, v143
  v_cvt_pk_bf16_f32 v136, v136, v137
  v_mfma_f32_16x16x32_bf16 v[196:199], a[200:203], v[84:87], v[196:199]
  v_max3_f32 v94, v52, v53, v54
  v_max3_f32 v95, v55, v56, v57
  v_max3_f32 v94, v94, v58, v59
  v_max_f32 v94, v94, v95
  v_mov_b32 v95, v94
  v_exp_f32 v31, v93
  v_cvt_pk_bf16_f32 v137, v138, v139
  v_permlane32_swap_b32 v94, v95
  v_cvt_pk_bf16_f32 v138, v140, v141
  v_max_f32 v94, v94, v95
  v_cvt_pk_bf16_f32 v139, v142, v143
  v_mov_b32 v95, v94
  v_mfma_f32_16x16x32_bf16 v[200:203], a[206:209], v[84:87], v[200:203]
  ds_write_b128 v14, v[136:139] offset:64
  v_accvgpr_read_b32 v23, a249
  v_mul_f32 v144, v22, v144
  v_cvt_pk_bf16_f32 v89, v30, v31
  v_mfma_f32_16x16x32_bf16 v[204:207], a[212:215], v[84:87], v[204:207]
  v_mul_f32 v145, v22, v145
  v_permlane16_swap_b32 v94, v95
  v_mul_f32 v146, v22, v146
  v_max_f32 v94, v94, v95
  v_mul_f32 v147, v22, v147
  v_mul_f32 v94, s31, v94
  v_mfma_f32_16x16x32_bf16 v[208:211], a[218:221], v[84:87], v[208:211]
  v_mul_f32 v148, v22, v148
  v_min_f32 v23, v23, v94
  v_mul_f32 v149, v22, v149
  v_fma_f32 v92, v52, s30, v23
  v_mfma_f32_16x16x32_bf16 v[212:215], a[224:227], v[84:87], v[212:215]
  v_mul_f32 v150, v22, v150
  v_fma_f32 v93, v53, s30, v23
  v_mul_f32 v151, v22, v151
  v_cvt_pk_bf16_f32 v144, v144, v145
  v_exp_f32 v28, v92
  v_mfma_f32_16x16x32_bf16 v[216:219], a[230:233], v[84:87], v[216:219]
  v_cvt_pk_bf16_f32 v145, v146, v147
  v_fma_f32 v92, v54, s30, v23
  v_cvt_pk_bf16_f32 v146, v148, v149
  v_mfma_f32_16x16x32_bf16 v[220:223], a[236:239], v[84:87], v[220:223]
  v_cvt_pk_bf16_f32 v147, v150, v151
  v_exp_f32 v29, v93
  ds_write_b128 v15, v[144:147] offset:0
  v_fma_f32 v93, v55, s30, v23
  v_mul_f32 v152, v22, v152
  v_cvt_pk_bf16_f32 v72, v28, v29
  v_mfma_f32_16x16x32_bf16 v[60:63], a[160:163], a[80:83], 0
  v_mul_f32 v153, v22, v153
  v_mul_f32 v154, v22, v154
  v_exp_f32 v30, v92
  v_mfma_f32_16x16x32_bf16 v[60:63], a[164:167], a[84:87], v[60:63]
  v_mul_f32 v155, v22, v155
  v_fma_f32 v92, v56, s30, v23
  v_mul_f32 v156, v22, v156
  v_mul_f32 v157, v22, v157
  v_exp_f32 v31, v93
  v_mfma_f32_16x16x32_bf16 v[60:63], a[168:171], a[88:91], v[60:63]
  v_mul_f32 v158, v22, v158
  v_fma_f32 v93, v57, s30, v23
  v_mul_f32 v159, v22, v159
  v_cvt_pk_bf16_f32 v73, v30, v31
  v_mfma_f32_16x16x32_bf16 v[60:63], a[172:175], a[92:95], v[60:63]
  v_cvt_pk_bf16_f32 v152, v152, v153
  v_cvt_pk_bf16_f32 v153, v154, v155
  v_exp_f32 v28, v92
  v_cvt_pk_bf16_f32 v154, v156, v157
  v_fma_f32 v92, v58, s30, v23
  v_mfma_f32_16x16x32_bf16 v[64:67], a[176:179], a[80:83], 0
  v_cvt_pk_bf16_f32 v155, v158, v159
  ds_write_b128 v15, v[152:155] offset:64
  v_exp_f32 v29, v93
  v_mfma_f32_16x16x32_bf16 v[64:67], a[180:183], a[84:87], v[64:67]
  ds_read_b128 a[16:19], v16 offset:0
  v_fma_f32 v93, v59, s30, v23
  ds_read_b128 a[20:23], v16 offset:1088
  v_cvt_pk_bf16_f32 v74, v28, v29
  ds_read_b128 a[24:27], v16 offset:2176
  v_mfma_f32_16x16x32_bf16 v[64:67], a[184:187], a[88:91], v[64:67]
  ds_read_b128 a[28:31], v16 offset:3264
  v_exp_f32 v30, v92
  v_mfma_f32_16x16x32_bf16 v[64:67], a[188:191], a[92:95], v[64:67]
  ds_read_b64_tr_b16 a[192:193], v8 offset:16640
  v_rcp_f32 v22, v40
  v_cmp_nge_f32 vcc, s32, v40
  s_nop 0
  s_or_b64 s[42:43], s[42:43], vcc
  v_mfma_f32_16x16x32_bf16 v[52:55], a[160:163], a[96:99], 0
  ds_read_b64_tr_b16 a[198:199], v8 offset:16648
  ds_read_b64_tr_b16 a[204:205], v8 offset:16704
  ds_read_b64_tr_b16 a[210:211], v8 offset:16712
  v_mul_f32 v160, v22, v160
  v_mul_f32 v161, v22, v161
  v_mfma_f32_16x16x32_bf16 v[52:55], a[164:167], a[100:103], v[52:55]
  ds_read_b64_tr_b16 a[216:217], v9 offset:16640
  ds_read_b64_tr_b16 a[222:223], v9 offset:16648
  v_mul_f32 v162, v22, v162
  v_mul_f32 v163, v22, v163
  v_mul_f32 v164, v22, v164
  v_mfma_f32_16x16x32_bf16 v[52:55], a[168:171], a[104:107], v[52:55]
  ds_read_b64_tr_b16 a[228:229], v9 offset:16704
  ds_read_b64_tr_b16 a[234:235], v9 offset:16712
  ds_read_b64_tr_b16 a[194:195], v10 offset:16640
  v_max3_f32 v94, v60, v61, v62
  v_max3_f32 v95, v63, v64, v65
  v_max3_f32 v94, v94, v66, v67
  v_max_f32 v94, v94, v95
  v_mov_b32 v95, v94
  v_exp_f32 v31, v93
  s_nop 0
  v_permlane32_swap_b32 v94, v95
  v_max_f32 v94, v94, v95
  v_mul_f32 v165, v22, v165
  v_mov_b32 v95, v94
  v_mul_f32 v166, v22, v166
  v_accvgpr_read_b32 v24, a250
  v_mfma_f32_16x16x32_bf16 v[52:55], a[172:175], a[108:111], v[52:55]
  ds_read_b64_tr_b16 a[200:201], v10 offset:16648
  v_mul_f32 v167, v22, v167
  v_cvt_pk_bf16_f32 v75, v30, v31
  v_cvt_pk_bf16_f32 v160, v160, v161
  v_permlane16_swap_b32 v94, v95
  v_cvt_pk_bf16_f32 v161, v162, v163
  v_max_f32 v94, v94, v95
  v_mfma_f32_16x16x32_bf16 v[56:59], a[176:179], a[96:99], 0
  ds_read_b64_tr_b16 a[206:207], v10 offset:16704
  v_cvt_pk_bf16_f32 v162, v164, v165
  v_mul_f32 v94, s31, v94
  v_cvt_pk_bf16_f32 v163, v166, v167
  v_min_f32 v24, v24, v94
  v_mfma_f32_16x16x32_bf16 v[56:59], a[180:183], a[100:103], v[56:59]
  ds_read_b64_tr_b16 a[212:213], v10 offset:16712
  ds_write_b128 v14, v[160:163] offset:0
  v_fma_f32 v92, v60, s30, v24
  v_mul_f32 v168, v22, v168
  v_fma_f32 v93, v61, s30, v24
  v_mul_f32 v169, v22, v169
  v_mfma_f32_16x16x32_bf16 v[56:59], a[184:187], a[104:107], v[56:59]
  ds_read_b64_tr_b16 a[218:219], v11 offset:16640
  v_mul_f32 v170, v22, v170
  v_exp_f32 v28, v92
  v_mul_f32 v171, v22, v171
  v_fma_f32 v92, v62, s30, v24
  v_mfma_f32_16x16x32_bf16 v[56:59], a[188:191], a[108:111], v[56:59]
  ds_read_b64_tr_b16 a[224:225], v11 offset:16648
  v_mul_f32 v172, v22, v172
  v_mul_f32 v173, v22, v173
  v_exp_f32 v29, v93
  v_mul_f32 v174, v22, v174
  v_fma_f32 v93, v63, s30, v24
  v_mfma_f32_16x16x32_bf16 v[32:35], a[240:243], v[72:75], 0
  ds_read_b64_tr_b16 a[230:231], v11 offset:16704
  v_mul_f32 v175, v22, v175
  v_cvt_pk_bf16_f32 v76, v28, v29
  v_cvt_pk_bf16_f32 v168, v168, v169
  s_waitcnt lgkmcnt(7)
  v_mfma_f32_16x16x32_bf16 v[96:99], a[192:195], v[72:75], 0
  ds_read_b64_tr_b16 a[236:237], v11 offset:16712
  v_cvt_pk_bf16_f32 v169, v170, v171
  v_exp_f32 v30, v92
  v_cvt_pk_bf16_f32 v170, v172, v173
  v_fma_f32 v92, v64, s30, v24
  v_cvt_pk_bf16_f32 v171, v174, v175
  s_waitcnt lgkmcnt(7)
  v_mfma_f32_16x16x32_bf16 v[100:103], a[198:201], v[72:75], 0
  s_add_u32 m0, s24, 0
  ds_write_b128 v14, v[168:171] offset:64
  v_exp_f32 v31, v93
  v_mul_f32 v176, v22, v176
  v_fma_f32 v93, v65, s30, v24
  s_waitcnt lgkmcnt(7)
  v_mfma_f32_16x16x32_bf16 v[104:107], a[204:207], v[72:75], 0
  s_xor_b32 s33, s27, 33595392
  buffer_load_dwordx4 v2, s[12:15], s33 offen nt lds
  buffer_load_dwordx4 v3, s[12:15], s33 offen offset:1024 nt lds
  v_mul_f32 v177, v22, v177
  v_cvt_pk_bf16_f32 v77, v30, v31
  v_mul_f32 v178, v22, v178
  v_mul_f32 v179, v22, v179
  v_exp_f32 v28, v92
  s_waitcnt lgkmcnt(5)
  v_mfma_f32_16x16x32_bf16 v[108:111], a[210:213], v[72:75], 0
  s_add_u32 m0, s25, 0
  s_nop 0
  buffer_load_dwordx4 v4, s[16:19], s33 offen nt lds
  v_mul_f32 v180, v22, v180
  v_fma_f32 v92, v66, s30, v24
  v_mul_f32 v181, v22, v181
  s_waitcnt lgkmcnt(4)
  v_mfma_f32_16x16x32_bf16 v[112:115], a[216:219], v[72:75], 0
  buffer_load_dwordx4 v5, s[16:19], s33 offen offset:1024 nt lds
  s_add_u32 m0, s24, 8448
  s_xor_b32 s33, s27, 33603584
  v_mul_f32 v182, v22, v182
  v_exp_f32 v29, v93
  v_mul_f32 v183, v22, v183
  v_fma_f32 v93, v67, s30, v24
  v_cvt_pk_bf16_f32 v176, v176, v177
  v_cvt_pk_bf16_f32 v78, v28, v29
  s_waitcnt lgkmcnt(3)
  v_mfma_f32_16x16x32_bf16 v[116:119], a[222:225], v[72:75], 0
  buffer_load_dwordx4 v2, s[12:15], s33 offen nt lds
  buffer_load_dwordx4 v3, s[12:15], s33 offen offset:1024 nt lds
  v_cvt_pk_bf16_f32 v177, v178, v179
  v_cvt_pk_bf16_f32 v178, v180, v181
  v_exp_f32 v30, v92
  s_waitcnt lgkmcnt(2)
  v_mfma_f32_16x16x32_bf16 v[120:123], a[228:231], v[72:75], 0
  s_add_u32 m0, s25, 8320
  s_nop 0
  buffer_load_dwordx4 v4, s[16:19], s33 offen nt lds
  buffer_load_dwordx4 v5, s[16:19], s33 offen offset:1024 nt lds
  v_cvt_pk_bf16_f32 v179, v182, v183
  v_max3_f32 v94, v52, v53, v54
  ds_write_b128 v15, v[176:179] offset:0
  v_max3_f32 v95, v55, v56, v57
  v_mul_f32 v184, v22, v184
  v_max3_f32 v94, v94, v58, v59
  s_waitcnt lgkmcnt(2)
  v_mfma_f32_16x16x32_bf16 v[124:127], a[234:237], v[72:75], 0
  v_mul_f32 v185, v22, v185
  v_max_f32 v94, v94, v95
  v_mul_f32 v186, v22, v186
  v_mov_b32 v95, v94
  s_waitcnt vmcnt(20)
  s_barrier
  v_mfma_f32_16x16x32_bf16 v[60:63], a[160:163], a[112:115], 0
  v_mul_f32 v187, v22, v187
  v_mul_f32 v188, v22, v188
  v_exp_f32 v31, v93
  v_mul_f32 v189, v22, v189
  v_permlane32_swap_b32 v94, v95
  v_mfma_f32_16x16x32_bf16 v[60:63], a[164:167], a[116:119], v[60:63]
  v_mul_f32 v190, v22, v190
  v_max_f32 v94, v94, v95
  v_mul_f32 v191, v22, v191
  v_mov_b32 v95, v94
  v_mfma_f32_16x16x32_bf16 v[60:63], a[168:171], a[120:123], v[60:63]
  v_cvt_pk_bf16_f32 v184, v184, v185
  v_accvgpr_read_b32 v25, a251
  v_cvt_pk_bf16_f32 v185, v186, v187
  v_cvt_pk_bf16_f32 v79, v30, v31
  v_cvt_pk_bf16_f32 v186, v188, v189
  v_permlane16_swap_b32 v94, v95
  v_mfma_f32_16x16x32_bf16 v[60:63], a[172:175], a[124:127], v[60:63]
  v_cvt_pk_bf16_f32 v187, v190, v191
  v_max_f32 v94, v94, v95
  ds_write_b128 v15, v[184:187] offset:64
  v_mul_f32 v94, s31, v94
  v_mfma_f32_16x16x32_bf16 v[64:67], a[176:179], a[112:115], 0
  ds_read_b128 a[32:35], v16 offset:0
  v_min_f32 v25, v25, v94
  ds_read_b128 a[36:39], v16 offset:1088
  v_fma_f32 v92, v52, s30, v25
  ds_read_b128 a[40:43], v16 offset:2176
  v_fma_f32 v93, v53, s30, v25
  v_mfma_f32_16x16x32_bf16 v[64:67], a[180:183], a[116:119], v[64:67]
  ds_read_b128 a[44:47], v16 offset:3264
  v_exp_f32 v28, v92
  v_mfma_f32_16x16x32_bf16 v[64:67], a[184:187], a[120:123], v[64:67]
  v_rcp_f32 v22, v44
  v_fma_f32 v92, v54, s30, v25
  v_cmp_nge_f32 vcc, s32, v44
  s_nop 0
  s_or_b64 s[42:43], s[42:43], vcc
  v_exp_f32 v29, v93
  v_mfma_f32_16x16x32_bf16 v[64:67], a[188:191], a[124:127], v[64:67]
  v_mul_f32 v192, v22, v192
  v_fma_f32 v93, v55, s30, v25
  v_mul_f32 v193, v22, v193
  v_cvt_pk_bf16_f32 v80, v28, v29
  v_mfma_f32_16x16x32_bf16 v[36:39], a[240:243], v[76:79], 0
  v_mul_f32 v194, v22, v194
  v_mul_f32 v195, v22, v195
  v_exp_f32 v30, v92
  v_mul_f32 v196, v22, v196
  v_fma_f32 v92, v56, s30, v25
  v_mfma_f32_16x16x32_bf16 v[128:131], a[192:195], v[76:79], 0
  v_mul_f32 v197, v22, v197
  v_mul_f32 v198, v22, v198
  v_exp_f32 v31, v93
  v_mfma_f32_16x16x32_bf16 v[132:135], a[198:201], v[76:79], 0
  ds_read_b128 a[160:163], v6 offset:25344
  v_mul_f32 v199, v22, v199
  v_fma_f32 v93, v57, s30, v25
  v_cvt_pk_bf16_f32 v192, v192, v193
  v_cvt_pk_bf16_f32 v81, v30, v31
  v_cvt_pk_bf16_f32 v193, v194, v195
  v_mfma_f32_16x16x32_bf16 v[136:139], a[204:207], v[76:79], 0
  ds_read_b128 a[164:167], v6 offset:25408
  v_cvt_pk_bf16_f32 v194, v196, v197
  v_exp_f32 v28, v92
  v_cvt_pk_bf16_f32 v195, v198, v199
  v_fma_f32 v92, v58, s30, v25
  v_mfma_f32_16x16x32_bf16 v[140:143], a[210:213], v[76:79], 0
  ds_read_b128 a[168:171], v6 offset:25472
  ds_write_b128 v14, v[192:195] offset:0
  v_mul_f32 v200, v22, v200
  v_exp_f32 v29, v93
  v_mul_f32 v201, v22, v201
  v_fma_f32 v93, v59, s30, v25
  v_mfma_f32_16x16x32_bf16 v[144:147], a[216:219], v[76:79], 0
  ds_read_b128 a[172:175], v6 offset:25536
  v_mul_f32 v202, v22, v202
  v_cvt_pk_bf16_f32 v82, v28, v29
  v_mul_f32 v203, v22, v203
  v_mfma_f32_16x16x32_bf16 v[148:151], a[222:225], v[76:79], 0
  v_mul_f32 v204, v22, v204
  v_exp_f32 v30, v92
  v_mul_f32 v205, v22, v205
  v_max3_f32 v94, v60, v61, v62
  v_mul_f32 v206, v22, v206
  v_max3_f32 v95, v63, v64, v65
  v_mfma_f32_16x16x32_bf16 v[152:155], a[228:231], v[76:79], 0
  v_mul_f32 v207, v22, v207
  v_max3_f32 v94, v94, v66, v67
  v_cvt_pk_bf16_f32 v200, v200, v201
  v_max_f32 v94, v94, v95
  v_mfma_f32_16x16x32_bf16 v[156:159], a[234:237], v[76:79], 0
  v_cvt_pk_bf16_f32 v201, v202, v203
  v_mov_b32 v95, v94
  v_cvt_pk_bf16_f32 v202, v204, v205
  v_cvt_pk_bf16_f32 v203, v206, v207
  v_exp_f32 v31, v93
  s_waitcnt lgkmcnt(4)
  v_mfma_f32_16x16x32_bf16 v[68:71], a[160:163], a[144:147], 0
  ds_write_b128 v14, v[200:203] offset:64
  v_permlane32_swap_b32 v94, v95
  v_mul_f32 v208, v22, v208
  v_max_f32 v94, v94, v95
  s_waitcnt lgkmcnt(4)
  v_mfma_f32_16x16x32_bf16 v[68:71], a[164:167], a[148:151], v[68:71]
  v_mul_f32 v209, v22, v209
  v_mov_b32 v95, v94
  v_mul_f32 v210, v22, v210
  v_accvgpr_read_b32 v26, a252
  v_mul_f32 v211, v22, v211
  v_cvt_pk_bf16_f32 v83, v30, v31
  s_waitcnt lgkmcnt(2)
  v_mfma_f32_16x16x32_bf16 v[68:71], a[168:171], a[152:155], v[68:71]
  v_mul_f32 v212, v22, v212
  v_mul_f32 v213, v22, v213
  s_waitcnt lgkmcnt(1)
  v_mfma_f32_16x16x32_bf16 v[68:71], a[172:175], a[156:159], v[68:71]
  v_mul_f32 v214, v22, v214
  v_mul_f32 v215, v22, v215
  v_cvt_pk_bf16_f32 v208, v208, v209
  v_mfma_f32_16x16x32_bf16 v[40:43], a[240:243], v[80:83], 0
  v_cvt_pk_bf16_f32 v209, v210, v211
  v_cvt_pk_bf16_f32 v210, v212, v213
  v_mfma_f32_16x16x32_bf16 v[160:163], a[192:195], v[80:83], 0
  v_cvt_pk_bf16_f32 v211, v214, v215
  ds_write_b128 v15, v[208:211] offset:0
  v_permlane16_swap_b32 v94, v95
  v_mul_f32 v216, v22, v216
  v_max_f32 v94, v94, v95
  v_mfma_f32_16x16x32_bf16 v[164:167], a[198:201], v[80:83], 0
  v_mul_f32 v217, v22, v217
  v_mul_f32 v94, s31, v94
  v_mul_f32 v218, v22, v218
  v_min_f32 v26, v26, v94
  v_mfma_f32_16x16x32_bf16 v[168:171], a[204:207], v[80:83], 0
  v_mul_f32 v219, v22, v219
  v_fma_f32 v92, v60, s30, v26
  v_mul_f32 v220, v22, v220
  v_fma_f32 v93, v61, s30, v26
  v_mul_f32 v221, v22, v221
  v_mfma_f32_16x16x32_bf16 v[172:175], a[210:213], v[80:83], 0
  v_mul_f32 v222, v22, v222
  v_exp_f32 v28, v92
  v_mul_f32 v223, v22, v223
  v_fma_f32 v92, v62, s30, v26
  v_mfma_f32_16x16x32_bf16 v[176:179], a[216:219], v[80:83], 0
  v_cvt_pk_bf16_f32 v216, v216, v217
  v_cvt_pk_bf16_f32 v217, v218, v219
  v_exp_f32 v29, v93
  v_cvt_pk_bf16_f32 v218, v220, v221
  v_fma_f32 v93, v63, s30, v26
  v_mfma_f32_16x16x32_bf16 v[180:183], a[222:225], v[80:83], 0
  ds_read_b128 a[176:179], v7 offset:25344
  v_cvt_pk_bf16_f32 v219, v222, v223
  v_cvt_pk_bf16_f32 v84, v28, v29
  ds_write_b128 v15, v[216:219] offset:64
  v_mfma_f32_16x16x32_bf16 v[184:187], a[228:231], v[80:83], 0
  ds_read_b128 a[180:183], v7 offset:25408
  ds_read_b128 a[48:51], v16 offset:0
  v_exp_f32 v30, v92
  ds_read_b128 a[52:55], v16 offset:1088
  v_fma_f32 v92, v64, s30, v26
  ds_read_b128 a[56:59], v16 offset:2176
  v_mfma_f32_16x16x32_bf16 v[188:191], a[234:237], v[80:83], 0
  ds_read_b128 a[184:187], v7 offset:25472
  ds_read_b128 a[60:63], v16 offset:3264
  v_exp_f32 v31, v93
  v_fma_f32 v93, v65, s30, v26
  v_mfma_f32_16x16x32_bf16 v[52:55], a[160:163], a[64:67], 0
  ds_read_b128 a[188:191], v7 offset:25536
  v_cmp_nge_f32 vcc, s32, v19
  s_nop 0
  s_or_b64 s[42:43], s[42:43], vcc
  v_cvt_pk_bf16_f32 v85, v30, v31
  v_min_f32 v0, v18, v20
  v_sub_f32 v18, v0, v18
  v_exp_f32 v28, v92
  v_mfma_f32_16x16x32_bf16 v[52:55], a[164:167], a[68:71], v[52:55]
  v_sub_f32 v20, v0, v20
  v_fma_f32 v92, v66, s30, v26
  v_mfma_f32_16x16x32_bf16 v[52:55], a[168:171], a[72:75], v[52:55]
  v_exp_f32 v18, v18
  v_exp_f32 v29, v93
  v_fma_f32 v93, v67, s30, v26
  v_exp_f32 v20, v20
  v_cvt_pk_bf16_f32 v86, v28, v29
  v_mfma_f32_16x16x32_bf16 v[52:55], a[172:175], a[76:79], v[52:55]
  v_lshrrev_b32 v0, 7, v17
  v_mul_f32 v19, v18, v19
  v_exp_f32 v30, v92
  s_waitcnt lgkmcnt(7)
  v_mfma_f32_16x16x32_bf16 v[56:59], a[176:179], a[64:67], 0
  v_fmac_f32 v19, v20, v21
  v_fma_f32 v92, v68, s30, v27
  v_rcp_f32 v22, v19
  v_exp_f32 v31, v93
  s_waitcnt lgkmcnt(3)
  v_mfma_f32_16x16x32_bf16 v[56:59], a[180:183], a[68:71], v[56:59]
  v_and_b32 v1, 0x70, v17
  v_mul_f32 v18, v18, v22
  v_cvt_pk_bf16_f32 v87, v30, v31
  s_waitcnt lgkmcnt(1)
  v_mfma_f32_16x16x32_bf16 v[56:59], a[184:187], a[72:75], v[56:59]
  v_mul_f32 v20, v20, v22
  v_mul_f32 v224, v18, v224
  v_mul_f32 v225, v18, v225
  s_waitcnt lgkmcnt(0)
  v_mfma_f32_16x16x32_bf16 v[56:59], a[188:191], a[76:79], v[56:59]
  v_mul_f32 v226, v18, v226
  v_mul_f32 v227, v18, v227
  v_mfma_f32_16x16x32_bf16 v[44:47], a[240:243], v[84:87], 0
  v_mul_f32 v228, v18, v228
  v_mul_f32 v229, v18, v229
  v_mul_f32 v230, v18, v230
  v_mfma_f32_16x16x32_bf16 v[192:195], a[192:195], v[84:87], 0
  v_mul_f32 v231, v18, v231
  v_fmac_f32 v224, v20, v240
  v_mfma_f32_16x16x32_bf16 v[196:199], a[198:201], v[84:87], 0
  v_fmac_f32 v225, v20, v241
  v_fmac_f32 v226, v20, v242
  v_fmac_f32 v227, v20, v243
  v_mfma_f32_16x16x32_bf16 v[200:203], a[204:207], v[84:87], 0
  v_fmac_f32 v228, v20, v244
  v_fmac_f32 v229, v20, v245
  v_mfma_f32_16x16x32_bf16 v[204:207], a[210:213], v[84:87], 0
  v_fmac_f32 v230, v20, v246
  v_fmac_f32 v231, v20, v247
  v_cvt_pk_bf16_f32 v224, v224, v225
  v_mfma_f32_16x16x32_bf16 v[208:211], a[216:219], v[84:87], 0
  v_cvt_pk_bf16_f32 v225, v226, v227
  v_cvt_pk_bf16_f32 v226, v228, v229
  v_mfma_f32_16x16x32_bf16 v[212:215], a[222:225], v[84:87], 0
  v_cvt_pk_bf16_f32 v227, v230, v231
  ds_write_b128 v14, v[224:227] offset:0
  v_mul_f32 v232, v18, v232
  v_mfma_f32_16x16x32_bf16 v[216:219], a[228:231], v[84:87], 0
  v_mul_f32 v233, v18, v233
  v_mul_f32 v234, v18, v234
  v_mfma_f32_16x16x32_bf16 v[220:223], a[234:237], v[84:87], 0
  ds_read_b64_tr_b16 a[196:197], v10 offset:24960
  v_mul_f32 v235, v18, v235
  v_mul_f32 v236, v18, v236
  v_mul_f32 v237, v18, v237
  v_mfma_f32_16x16x32_bf16 v[60:63], a[160:163], a[80:83], 0
  ds_read_b64_tr_b16 a[202:203], v10 offset:24968
  ds_read_b64_tr_b16 a[208:209], v10 offset:25024
  ds_read_b64_tr_b16 a[214:215], v10 offset:25032
  v_fma_f32 v93, v69, s30, v27
  v_mul_f32 v238, v18, v238
  v_mul_f32 v239, v18, v239
  v_exp_f32 v28, v92
  v_mfma_f32_16x16x32_bf16 v[60:63], a[164:167], a[84:87], v[60:63]
  ds_read_b64_tr_b16 a[220:221], v11 offset:24960
  ds_read_b64_tr_b16 a[226:227], v11 offset:24968
  v_fmac_f32 v232, v20, v248
  v_fma_f32 v92, v70, s30, v27
  v_fmac_f32 v233, v20, v249
  v_fmac_f32 v234, v20, v250
  v_mfma_f32_16x16x32_bf16 v[60:63], a[168:171], a[88:91], v[60:63]
  ds_read_b64_tr_b16 a[232:233], v11 offset:25024
  ds_read_b64_tr_b16 a[238:239], v11 offset:25032
  ds_read_b64_tr_b16 a[194:195], v8 offset:24960
  v_exp_f32 v29, v93
  v_fmac_f32 v235, v20, v251
  v_fma_f32 v93, v71, s30, v27
  v_fmac_f32 v236, v20, v252
  v_cvt_pk_bf16_f32 v90, v28, v29
  v_mfma_f32_16x16x32_bf16 v[60:63], a[172:175], a[92:95], v[60:63]
  ds_read_b64_tr_b16 a[200:201], v8 offset:24968
  v_fmac_f32 v237, v20, v253
  v_fmac_f32 v238, v20, v254
  v_exp_f32 v30, v92
  v_fmac_f32 v239, v20, v255
  v_mfma_f32_16x16x32_bf16 v[64:67], a[176:179], a[80:83], 0
  ds_read_b64_tr_b16 a[206:207], v8 offset:25024
  v_fma_f32 v92, v52, s30, v23
  v_cvt_pk_bf16_f32 v232, v232, v233
  v_cvt_pk_bf16_f32 v233, v234, v235
  v_exp_f32 v31, v93
  v_mfma_f32_16x16x32_bf16 v[64:67], a[180:183], a[84:87], v[64:67]
  ds_read_b64_tr_b16 a[212:213], v8 offset:25032
  v_cvt_pk_bf16_f32 v234, v236, v237
  v_cvt_pk_bf16_f32 v235, v238, v239
  v_cvt_pk_bf16_f32 v91, v30, v31
  ds_write_b128 v14, v[232:235] offset:64
  v_mfma_f32_16x16x32_bf16 v[64:67], a[184:187], a[88:91], v[64:67]
  ds_read_b64_tr_b16 a[218:219], v9 offset:24960
  ds_read_b64_tr_b16 a[224:225], v9 offset:24968
  v_mfma_f32_16x16x32_bf16 v[64:67], a[188:191], a[92:95], v[64:67]
  ds_read_b64_tr_b16 a[230:231], v9 offset:25024
  ds_read_b64_tr_b16 a[236:237], v9 offset:25032
  v_mfma_f32_16x16x32_bf16 v[48:51], a[240:243], v[88:91], 0
  s_add_u32 m0, s24, 16896
  v_fma_f32 v93, v53, s30, v23
  s_waitcnt lgkmcnt(8)
  v_mfma_f32_16x16x32_bf16 v[224:227], a[192:195], v[88:91], 0
  v_exp_f32 v28, v92
  s_waitcnt lgkmcnt(7)
  v_mfma_f32_16x16x32_bf16 v[228:231], a[198:201], v[88:91], 0
  s_xor_b32 s33, s27, 33611776
  v_fma_f32 v92, v54, s30, v23
  s_waitcnt lgkmcnt(6)
  v_mfma_f32_16x16x32_bf16 v[232:235], a[204:207], v[88:91], 0
  v_exp_f32 v29, v93
  s_waitcnt lgkmcnt(4)
  v_mfma_f32_16x16x32_bf16 v[236:239], a[210:213], v[88:91], 0
  v_fma_f32 v93, v55, s30, v23
  v_cvt_pk_bf16_f32 v72, v28, v29
  s_waitcnt lgkmcnt(2)
  v_mfma_f32_16x16x32_bf16 v[240:243], a[216:219], v[88:91], 0
  v_exp_f32 v30, v92
  v_mfma_f32_16x16x32_bf16 v[244:247], a[222:225], v[88:91], 0
  buffer_load_dwordx4 v2, s[12:15], s33 offen nt lds
  v_fma_f32 v92, v56, s30, v23
  s_waitcnt lgkmcnt(0)
  v_mfma_f32_16x16x32_bf16 v[248:251], a[228:231], v[88:91], 0
  v_exp_f32 v31, v93
  v_mfma_f32_16x16x32_bf16 v[252:255], a[234:237], v[88:91], 0
  v_fma_f32 v93, v57, s30, v23
  v_cvt_pk_bf16_f32 v73, v30, v31
  v_mfma_f32_16x16x32_bf16 v[52:55], a[160:163], a[96:99], 0
  v_exp_f32 v28, v92
  v_mfma_f32_16x16x32_bf16 v[52:55], a[164:167], a[100:103], v[52:55]
  buffer_load_dwordx4 v3, s[12:15], s33 offen offset:1024 nt lds
  v_fma_f32 v92, v58, s30, v23
  v_mfma_f32_16x16x32_bf16 v[52:55], a[168:171], a[104:107], v[52:55]
  v_exp_f32 v29, v93
  v_fma_f32 v93, v59, s30, v23
  v_cvt_pk_bf16_f32 v74, v28, v29
  v_mfma_f32_16x16x32_bf16 v[52:55], a[172:175], a[108:111], v[52:55]
  v_exp_f32 v30, v92
  v_mfma_f32_16x16x32_bf16 v[56:59], a[176:179], a[96:99], 0
  v_fma_f32 v92, v60, s30, v24
  v_exp_f32 v31, v93
  v_mfma_f32_16x16x32_bf16 v[56:59], a[180:183], a[100:103], v[56:59]
  v_cvt_pk_bf16_f32 v75, v30, v31
  v_fma_f32 v93, v61, s30, v24
  v_mfma_f32_16x16x32_bf16 v[56:59], a[184:187], a[104:107], v[56:59]
  v_exp_f32 v28, v92
  v_mfma_f32_16x16x32_bf16 v[56:59], a[188:191], a[108:111], v[56:59]
  s_add_u32 m0, s25, 16640
  v_fma_f32 v92, v62, s30, v24
  v_mfma_f32_16x16x32_bf16 v[32:35], a[240:243], v[72:75], v[32:35]
  v_exp_f32 v29, v93
  v_mfma_f32_16x16x32_bf16 v[96:99], a[194:197], v[72:75], v[96:99]
  v_fma_f32 v93, v63, s30, v24
  v_cvt_pk_bf16_f32 v76, v28, v29
  v_mfma_f32_16x16x32_bf16 v[100:103], a[200:203], v[72:75], v[100:103]
  v_exp_f32 v30, v92
  v_mfma_f32_16x16x32_bf16 v[104:107], a[206:209], v[72:75], v[104:107]
  buffer_load_dwordx4 v4, s[16:19], s33 offen nt lds
  v_fma_f32 v92, v64, s30, v24
  v_mfma_f32_16x16x32_bf16 v[108:111], a[212:215], v[72:75], v[108:111]
  buffer_load_dwordx4 v5, s[16:19], s33 offen offset:1024 nt lds
  s_lshl_b32 s36, s39, 7
  v_mfma_f32_16x16x32_bf16 v[112:115], a[218:221], v[72:75], v[112:115]
  v_exp_f32 v31, v93
  v_mfma_f32_16x16x32_bf16 v[116:119], a[224:227], v[72:75], v[116:119]
  v_fma_f32 v93, v65, s30, v24
  v_cvt_pk_bf16_f32 v77, v30, v31
  v_mfma_f32_16x16x32_bf16 v[120:123], a[230:233], v[72:75], v[120:123]
  v_exp_f32 v28, v92
  v_mfma_f32_16x16x32_bf16 v[124:127], a[236:239], v[72:75], v[124:127]
  v_fma_f32 v92, v66, s30, v24
  v_add_u32 v1, s36, v1
  s_waitcnt vmcnt(20)
  s_barrier
  v_mfma_f32_16x16x32_bf16 v[60:63], a[160:163], a[112:115], 0
  v_exp_f32 v29, v93
  v_mfma_f32_16x16x32_bf16 v[60:63], a[164:167], a[116:119], v[60:63]
  v_fma_f32 v93, v67, s30, v24
  v_cvt_pk_bf16_f32 v78, v28, v29
  v_mfma_f32_16x16x32_bf16 v[60:63], a[168:171], a[120:123], v[60:63]
  v_exp_f32 v30, v92
  v_mfma_f32_16x16x32_bf16 v[60:63], a[172:175], a[124:127], v[60:63]
  ds_read_b128 a[160:163], v6 offset:33792
  v_fma_f32 v92, v52, s30, v25
  v_mfma_f32_16x16x32_bf16 v[64:67], a[176:179], a[112:115], 0
  v_exp_f32 v31, v93
  v_mfma_f32_16x16x32_bf16 v[64:67], a[180:183], a[116:119], v[64:67]
  v_cvt_pk_bf16_f32 v79, v30, v31
  v_fma_f32 v93, v53, s30, v25
  v_mfma_f32_16x16x32_bf16 v[64:67], a[184:187], a[120:123], v[64:67]
  v_exp_f32 v28, v92
  v_mfma_f32_16x16x32_bf16 v[64:67], a[188:191], a[124:127], v[64:67]
  ds_read_b128 a[164:167], v6 offset:33856
  v_fma_f32 v92, v54, s30, v25
  v_mfma_f32_16x16x32_bf16 v[36:39], a[240:243], v[76:79], v[36:39]
  v_exp_f32 v29, v93
  v_mfma_f32_16x16x32_bf16 v[128:131], a[194:197], v[76:79], v[128:131]
  v_fma_f32 v93, v55, s30, v25
  v_cvt_pk_bf16_f32 v80, v28, v29
  v_mfma_f32_16x16x32_bf16 v[132:135], a[200:203], v[76:79], v[132:135]
  v_exp_f32 v30, v92
  v_mfma_f32_16x16x32_bf16 v[136:139], a[206:209], v[76:79], v[136:139]
  ds_read_b128 a[168:171], v6 offset:33920
  v_fma_f32 v92, v56, s30, v25
  v_mfma_f32_16x16x32_bf16 v[140:143], a[212:215], v[76:79], v[140:143]
  v_exp_f32 v31, v93
  v_fma_f32 v93, v57, s30, v25
  v_mfma_f32_16x16x32_bf16 v[144:147], a[218:221], v[76:79], v[144:147]
  ds_read_b128 a[172:175], v6 offset:33984
  v_cvt_pk_bf16_f32 v81, v30, v31
  v_exp_f32 v28, v92
  v_mfma_f32_16x16x32_bf16 v[148:151], a[224:227], v[76:79], v[148:151]
  ds_read_b128 a[176:179], v7 offset:33792
  v_fma_f32 v92, v58, s30, v25
  v_mfma_f32_16x16x32_bf16 v[152:155], a[230:233], v[76:79], v[152:155]
  v_exp_f32 v29, v93
  v_fma_f32 v93, v59, s30, v25
  v_cvt_pk_bf16_f32 v82, v28, v29
  v_mfma_f32_16x16x32_bf16 v[156:159], a[236:239], v[76:79], v[156:159]
  v_exp_f32 v30, v92
  s_waitcnt lgkmcnt(3)
  v_mfma_f32_16x16x32_bf16 v[68:71], a[160:163], a[144:147], 0
  v_fma_f32 v92, v60, s30, v26
  v_exp_f32 v31, v93
  v_mfma_f32_16x16x32_bf16 v[68:71], a[164:167], a[148:151], v[68:71]
  v_cvt_pk_bf16_f32 v83, v30, v31
  v_fma_f32 v93, v61, s30, v26
  s_waitcnt lgkmcnt(2)
  v_mfma_f32_16x16x32_bf16 v[68:71], a[168:171], a[152:155], v[68:71]
  v_exp_f32 v28, v92
  s_waitcnt lgkmcnt(1)
  v_mfma_f32_16x16x32_bf16 v[68:71], a[172:175], a[156:159], v[68:71]
  ds_read_b128 a[180:183], v7 offset:33856
  v_fma_f32 v92, v62, s30, v26
  v_mfma_f32_16x16x32_bf16 v[40:43], a[240:243], v[80:83], v[40:43]
  v_exp_f32 v29, v93
  v_mfma_f32_16x16x32_bf16 v[160:163], a[194:197], v[80:83], v[160:163]
  v_fma_f32 v93, v63, s30, v26
  v_cvt_pk_bf16_f32 v84, v28, v29
  v_mfma_f32_16x16x32_bf16 v[164:167], a[200:203], v[80:83], v[164:167]
  v_exp_f32 v30, v92
  v_mfma_f32_16x16x32_bf16 v[168:171], a[206:209], v[80:83], v[168:171]
  ds_read_b128 a[184:187], v7 offset:33920
  v_fma_f32 v92, v64, s30, v26
  v_mfma_f32_16x16x32_bf16 v[172:175], a[212:215], v[80:83], v[172:175]
  v_exp_f32 v31, v93
  v_mfma_f32_16x16x32_bf16 v[176:179], a[218:221], v[80:83], v[176:179]
  v_fma_f32 v93, v65, s30, v26
  v_cvt_pk_bf16_f32 v85, v30, v31
  v_mfma_f32_16x16x32_bf16 v[180:183], a[224:227], v[80:83], v[180:183]
  v_exp_f32 v28, v92
  v_mfma_f32_16x16x32_bf16 v[184:187], a[230:233], v[80:83], v[184:187]
  ds_read_b128 a[188:191], v7 offset:33984
  v_fma_f32 v92, v66, s30, v26
  v_mfma_f32_16x16x32_bf16 v[188:191], a[236:239], v[80:83], v[188:191]
  v_exp_f32 v29, v93
  v_mfma_f32_16x16x32_bf16 v[52:55], a[160:163], a[64:67], 0
  v_fma_f32 v93, v67, s30, v26
  v_cvt_pk_bf16_f32 v86, v28, v29
  v_mfma_f32_16x16x32_bf16 v[52:55], a[164:167], a[68:71], v[52:55]
  v_exp_f32 v30, v92
  v_mfma_f32_16x16x32_bf16 v[52:55], a[168:171], a[72:75], v[52:55]
  ds_read_b64_tr_b16 a[192:193], v8 offset:33280
  v_fma_f32 v92, v68, s30, v27
  v_mfma_f32_16x16x32_bf16 v[52:55], a[172:175], a[76:79], v[52:55]
  v_exp_f32 v31, v93
  s_waitcnt lgkmcnt(2)
  v_mfma_f32_16x16x32_bf16 v[56:59], a[176:179], a[64:67], 0
  v_cvt_pk_bf16_f32 v87, v30, v31
  v_fma_f32 v93, v69, s30, v27
  v_mfma_f32_16x16x32_bf16 v[56:59], a[180:183], a[68:71], v[56:59]
  v_exp_f32 v28, v92
  v_mfma_f32_16x16x32_bf16 v[56:59], a[184:187], a[72:75], v[56:59]
  ds_read_b64_tr_b16 a[198:199], v8 offset:33288
  v_fma_f32 v92, v70, s30, v27
  s_waitcnt lgkmcnt(2)
  v_mfma_f32_16x16x32_bf16 v[56:59], a[188:191], a[76:79], v[56:59]
  v_exp_f32 v29, v93
  v_mfma_f32_16x16x32_bf16 v[44:47], a[240:243], v[84:87], v[44:47]
  v_fma_f32 v93, v71, s30, v27
  v_cvt_pk_bf16_f32 v88, v28, v29
  v_mfma_f32_16x16x32_bf16 v[192:195], a[194:197], v[84:87], v[192:195]
  v_exp_f32 v30, v92
  v_mfma_f32_16x16x32_bf16 v[196:199], a[200:203], v[84:87], v[196:199]
  ds_read_b64_tr_b16 a[204:205], v8 offset:33344
  v_fma_f32 v92, v52, s30, v23
  v_mfma_f32_16x16x32_bf16 v[200:203], a[206:209], v[84:87], v[200:203]
  v_exp_f32 v31, v93
  v_mfma_f32_16x16x32_bf16 v[204:207], a[212:215], v[84:87], v[204:207]
  v_cvt_pk_bf16_f32 v89, v30, v31
  v_fma_f32 v93, v53, s30, v23
  v_mfma_f32_16x16x32_bf16 v[208:211], a[218:221], v[84:87], v[208:211]
  v_exp_f32 v28, v92
  v_mfma_f32_16x16x32_bf16 v[212:215], a[224:227], v[84:87], v[212:215]
  ds_read_b64_tr_b16 a[210:211], v8 offset:33352
  v_fma_f32 v92, v54, s30, v23
  v_mfma_f32_16x16x32_bf16 v[216:219], a[230:233], v[84:87], v[216:219]
  v_exp_f32 v29, v93
  v_mfma_f32_16x16x32_bf16 v[220:223], a[236:239], v[84:87], v[220:223]
  v_fma_f32 v93, v55, s30, v23
  v_cvt_pk_bf16_f32 v72, v28, v29
  v_mfma_f32_16x16x32_bf16 v[60:63], a[160:163], a[80:83], 0
  v_exp_f32 v30, v92
  v_mfma_f32_16x16x32_bf16 v[60:63], a[164:167], a[84:87], v[60:63]
  ds_read_b64_tr_b16 a[216:217], v9 offset:33280
  v_fma_f32 v92, v56, s30, v23
  v_mfma_f32_16x16x32_bf16 v[60:63], a[168:171], a[88:91], v[60:63]
  v_exp_f32 v31, v93
  v_mfma_f32_16x16x32_bf16 v[60:63], a[172:175], a[92:95], v[60:63]
  v_fma_f32 v93, v57, s30, v23
  v_cvt_pk_bf16_f32 v73, v30, v31
  v_mfma_f32_16x16x32_bf16 v[64:67], a[176:179], a[80:83], 0
  v_exp_f32 v28, v92
  v_mfma_f32_16x16x32_bf16 v[64:67], a[180:183], a[84:87], v[64:67]
  ds_read_b64_tr_b16 a[222:223], v9 offset:33288
  v_fma_f32 v92, v58, s30, v23
  v_mfma_f32_16x16x32_bf16 v[64:67], a[184:187], a[88:91], v[64:67]
  ds_read_b64_tr_b16 a[228:229], v9 offset:33344
  ds_read_b64_tr_b16 a[234:235], v9 offset:33352
  v_mfma_f32_16x16x32_bf16 v[64:67], a[188:191], a[92:95], v[64:67]
  v_exp_f32 v29, v93
  v_mfma_f32_16x16x32_bf16 v[52:55], a[160:163], a[96:99], 0
  ds_read_b64_tr_b16 a[194:195], v10 offset:33280
  v_fma_f32 v93, v59, s30, v23
  v_mfma_f32_16x16x32_bf16 v[52:55], a[164:167], a[100:103], v[52:55]
  ds_read_b64_tr_b16 a[200:201], v10 offset:33288
  v_cvt_pk_bf16_f32 v74, v28, v29
  v_mfma_f32_16x16x32_bf16 v[52:55], a[168:171], a[104:107], v[52:55]
  v_exp_f32 v30, v92
  v_mfma_f32_16x16x32_bf16 v[52:55], a[172:175], a[108:111], v[52:55]
  ds_read_b64_tr_b16 a[206:207], v10 offset:33344
  v_fma_f32 v92, v60, s30, v24
  v_mfma_f32_16x16x32_bf16 v[56:59], a[176:179], a[96:99], 0
  v_exp_f32 v31, v93
  v_mfma_f32_16x16x32_bf16 v[56:59], a[180:183], a[100:103], v[56:59]
  ds_read_b64_tr_b16 a[212:213], v10 offset:33352
  v_cvt_pk_bf16_f32 v75, v30, v31
  v_mfma_f32_16x16x32_bf16 v[56:59], a[184:187], a[104:107], v[56:59]
  ds_read_b64_tr_b16 a[218:219], v11 offset:33280
  ds_read_b64_tr_b16 a[224:225], v11 offset:33288
  v_mfma_f32_16x16x32_bf16 v[56:59], a[188:191], a[108:111], v[56:59]
  ds_read_b64_tr_b16 a[230:231], v11 offset:33344
  ds_read_b64_tr_b16 a[236:237], v11 offset:33352
  v_mfma_f32_16x16x32_bf16 v[32:35], a[240:243], v[72:75], v[32:35]
  s_add_u32 m0, s24, 25344
  v_fma_f32 v93, v61, s30, v24
  s_waitcnt lgkmcnt(6)
  v_mfma_f32_16x16x32_bf16 v[96:99], a[192:195], v[72:75], v[96:99]
  v_exp_f32 v28, v92
  v_mfma_f32_16x16x32_bf16 v[100:103], a[198:201], v[72:75], v[100:103]
  s_xor_b32 s33, s27, 33619968
  v_fma_f32 v92, v62, s30, v24
  s_waitcnt lgkmcnt(5)
  v_mfma_f32_16x16x32_bf16 v[104:107], a[204:207], v[72:75], v[104:107]
  v_exp_f32 v29, v93
  s_waitcnt lgkmcnt(4)
  v_mfma_f32_16x16x32_bf16 v[108:111], a[210:213], v[72:75], v[108:111]
  buffer_load_dwordx4 v2, s[12:15], s33 offen nt lds
  v_fma_f32 v93, v63, s30, v24
  s_waitcnt lgkmcnt(2)
  v_mfma_f32_16x16x32_bf16 v[112:115], a[216:219], v[72:75], v[112:115]
  buffer_load_dwordx4 v3, s[12:15], s33 offen offset:1024 nt lds
  v_cvt_pk_bf16_f32 v76, v28, v29
  v_mfma_f32_16x16x32_bf16 v[116:119], a[222:225], v[72:75], v[116:119]
  v_exp_f32 v30, v92
  s_waitcnt lgkmcnt(0)
  v_mfma_f32_16x16x32_bf16 v[120:123], a[228:231], v[72:75], v[120:123]
  s_add_u32 m0, s25, 24960
  s_nop 0
  buffer_load_dwordx4 v4, s[16:19], s33 offen nt lds
  buffer_load_dwordx4 v5, s[16:19], s33 offen offset:1024 nt lds
  v_fma_f32 v92, v64, s30, v24
  v_mfma_f32_16x16x32_bf16 v[124:127], a[234:237], v[72:75], v[124:127]
  v_exp_f32 v31, v93
  v_fma_f32 v93, v65, s30, v24
  s_waitcnt vmcnt(20)
  s_barrier
  v_mfma_f32_16x16x32_bf16 v[60:63], a[160:163], a[112:115], 0
  v_cvt_pk_bf16_f32 v77, v30, v31
  v_exp_f32 v28, v92
  v_mfma_f32_16x16x32_bf16 v[60:63], a[164:167], a[116:119], v[60:63]
  ds_read_b128 a[160:163], v6 offset:42240
  v_fma_f32 v92, v66, s30, v24
  v_mfma_f32_16x16x32_bf16 v[60:63], a[168:171], a[120:123], v[60:63]
  v_exp_f32 v29, v93
  v_fma_f32 v93, v67, s30, v24
  v_cvt_pk_bf16_f32 v78, v28, v29
  v_mfma_f32_16x16x32_bf16 v[60:63], a[172:175], a[124:127], v[60:63]
  v_exp_f32 v30, v92
  v_mfma_f32_16x16x32_bf16 v[64:67], a[176:179], a[112:115], 0
  v_fma_f32 v92, v52, s30, v25
  v_exp_f32 v31, v93
  v_mfma_f32_16x16x32_bf16 v[64:67], a[180:183], a[116:119], v[64:67]
  v_cvt_pk_bf16_f32 v79, v30, v31
  v_fma_f32 v93, v53, s30, v25
  v_mfma_f32_16x16x32_bf16 v[64:67], a[184:187], a[120:123], v[64:67]
  v_exp_f32 v28, v92
  v_mfma_f32_16x16x32_bf16 v[64:67], a[188:191], a[124:127], v[64:67]
  ds_read_b128 a[164:167], v6 offset:42304
  v_fma_f32 v92, v54, s30, v25
  v_mfma_f32_16x16x32_bf16 v[36:39], a[240:243], v[76:79], v[36:39]
  v_exp_f32 v29, v93
  v_mfma_f32_16x16x32_bf16 v[128:131], a[192:195], v[76:79], v[128:131]
  v_fma_f32 v93, v55, s30, v25
  v_cvt_pk_bf16_f32 v80, v28, v29
  v_mfma_f32_16x16x32_bf16 v[132:135], a[198:201], v[76:79], v[132:135]
  v_exp_f32 v30, v92
  v_mfma_f32_16x16x32_bf16 v[136:139], a[204:207], v[76:79], v[136:139]
  ds_read_b128 a[168:171], v6 offset:42368
  v_fma_f32 v92, v56, s30, v25
  v_mfma_f32_16x16x32_bf16 v[140:143], a[210:213], v[76:79], v[140:143]
  v_exp_f32 v31, v93
  v_fma_f32 v93, v57, s30, v25
  v_mfma_f32_16x16x32_bf16 v[144:147], a[216:219], v[76:79], v[144:147]
  ds_read_b128 a[172:175], v6 offset:42432
  v_cvt_pk_bf16_f32 v81, v30, v31
  v_exp_f32 v28, v92
  v_mfma_f32_16x16x32_bf16 v[148:151], a[222:225], v[76:79], v[148:151]
  ds_read_b128 a[176:179], v7 offset:42240
  v_fma_f32 v92, v58, s30, v25
  v_mfma_f32_16x16x32_bf16 v[152:155], a[228:231], v[76:79], v[152:155]
  v_exp_f32 v29, v93
  v_fma_f32 v93, v59, s30, v25
  v_cvt_pk_bf16_f32 v82, v28, v29
  v_mfma_f32_16x16x32_bf16 v[156:159], a[234:237], v[76:79], v[156:159]
  v_exp_f32 v30, v92
  s_waitcnt lgkmcnt(3)
  v_mfma_f32_16x16x32_bf16 v[68:71], a[160:163], a[144:147], 0
  v_fma_f32 v92, v60, s30, v26
  v_exp_f32 v31, v93
  v_mfma_f32_16x16x32_bf16 v[68:71], a[164:167], a[148:151], v[68:71]
  v_cvt_pk_bf16_f32 v83, v30, v31
  v_fma_f32 v93, v61, s30, v26
  s_waitcnt lgkmcnt(2)
  v_mfma_f32_16x16x32_bf16 v[68:71], a[168:171], a[152:155], v[68:71]
  v_exp_f32 v28, v92
  s_waitcnt lgkmcnt(1)
  v_mfma_f32_16x16x32_bf16 v[68:71], a[172:175], a[156:159], v[68:71]
  ds_read_b128 a[180:183], v7 offset:42304
  v_fma_f32 v92, v62, s30, v26
  v_mfma_f32_16x16x32_bf16 v[40:43], a[240:243], v[80:83], v[40:43]
  v_exp_f32 v29, v93
  v_mfma_f32_16x16x32_bf16 v[160:163], a[192:195], v[80:83], v[160:163]
  v_fma_f32 v93, v63, s30, v26
  v_cvt_pk_bf16_f32 v84, v28, v29
  v_mfma_f32_16x16x32_bf16 v[164:167], a[198:201], v[80:83], v[164:167]
  v_exp_f32 v30, v92
  v_mfma_f32_16x16x32_bf16 v[168:171], a[204:207], v[80:83], v[168:171]
  ds_read_b128 a[184:187], v7 offset:42368
  v_fma_f32 v92, v64, s30, v26
  v_mfma_f32_16x16x32_bf16 v[172:175], a[210:213], v[80:83], v[172:175]
  v_exp_f32 v31, v93
  v_mfma_f32_16x16x32_bf16 v[176:179], a[216:219], v[80:83], v[176:179]
  v_fma_f32 v93, v65, s30, v26
  v_cvt_pk_bf16_f32 v85, v30, v31
  v_mfma_f32_16x16x32_bf16 v[180:183], a[222:225], v[80:83], v[180:183]
  v_exp_f32 v28, v92
  v_mfma_f32_16x16x32_bf16 v[184:187], a[228:231], v[80:83], v[184:187]
  ds_read_b128 a[188:191], v7 offset:42432
  v_fma_f32 v92, v66, s30, v26
  v_mfma_f32_16x16x32_bf16 v[188:191], a[234:237], v[80:83], v[188:191]
  v_exp_f32 v29, v93
  v_mfma_f32_16x16x32_bf16 v[52:55], a[160:163], a[64:67], 0
  v_fma_f32 v93, v67, s30, v26
  v_cvt_pk_bf16_f32 v86, v28, v29
  v_mfma_f32_16x16x32_bf16 v[52:55], a[164:167], a[68:71], v[52:55]
  v_exp_f32 v30, v92
  v_mfma_f32_16x16x32_bf16 v[52:55], a[168:171], a[72:75], v[52:55]
  ds_read_b64_tr_b16 a[196:197], v10 offset:41600
  v_fma_f32 v92, v68, s30, v27
  v_mfma_f32_16x16x32_bf16 v[52:55], a[172:175], a[76:79], v[52:55]
  v_exp_f32 v31, v93
  s_waitcnt lgkmcnt(2)
  v_mfma_f32_16x16x32_bf16 v[56:59], a[176:179], a[64:67], 0
  ds_read_b64_tr_b16 a[202:203], v10 offset:41608
  v_cvt_pk_bf16_f32 v87, v30, v31
  v_mfma_f32_16x16x32_bf16 v[56:59], a[180:183], a[68:71], v[56:59]
  ds_read_b64_tr_b16 a[208:209], v10 offset:41664
  v_fma_f32 v93, v69, s30, v27
  v_mfma_f32_16x16x32_bf16 v[56:59], a[184:187], a[72:75], v[56:59]
  ds_read_b64_tr_b16 a[214:215], v10 offset:41672
  ds_read_b64_tr_b16 a[220:221], v11 offset:41600
  s_waitcnt lgkmcnt(5)
  v_mfma_f32_16x16x32_bf16 v[56:59], a[188:191], a[76:79], v[56:59]
  v_exp_f32 v28, v92
  v_mfma_f32_16x16x32_bf16 v[44:47], a[240:243], v[84:87], v[44:47]
  ds_read_b64_tr_b16 a[226:227], v11 offset:41608
  v_fma_f32 v92, v70, s30, v27
  v_mfma_f32_16x16x32_bf16 v[192:195], a[192:195], v[84:87], v[192:195]
  ds_read_b64_tr_b16 a[232:233], v11 offset:41664
  ds_read_b64_tr_b16 a[238:239], v11 offset:41672
  v_mfma_f32_16x16x32_bf16 v[196:199], a[198:201], v[84:87], v[196:199]
  v_exp_f32 v29, v93
  v_mfma_f32_16x16x32_bf16 v[200:203], a[204:207], v[84:87], v[200:203]
  ds_read_b64_tr_b16 a[194:195], v8 offset:41600
  v_fma_f32 v93, v71, s30, v27
  v_mfma_f32_16x16x32_bf16 v[204:207], a[210:213], v[84:87], v[204:207]
  ds_read_b64_tr_b16 a[200:201], v8 offset:41608
  v_cvt_pk_bf16_f32 v90, v28, v29
  v_mfma_f32_16x16x32_bf16 v[208:211], a[216:219], v[84:87], v[208:211]
  v_exp_f32 v30, v92
  v_mfma_f32_16x16x32_bf16 v[212:215], a[222:225], v[84:87], v[212:215]
  ds_read_b64_tr_b16 a[206:207], v8 offset:41664
  v_fma_f32 v92, v52, s30, v23
  v_mfma_f32_16x16x32_bf16 v[216:219], a[228:231], v[84:87], v[216:219]
  v_exp_f32 v31, v93
  v_mfma_f32_16x16x32_bf16 v[220:223], a[234:237], v[84:87], v[220:223]
  ds_read_b64_tr_b16 a[212:213], v8 offset:41672
  v_cvt_pk_bf16_f32 v91, v30, v31
  v_mfma_f32_16x16x32_bf16 v[60:63], a[160:163], a[80:83], 0
  ds_read_b64_tr_b16 a[218:219], v9 offset:41600
  ds_read_b64_tr_b16 a[224:225], v9 offset:41608
  v_mfma_f32_16x16x32_bf16 v[60:63], a[164:167], a[84:87], v[60:63]
  ds_read_b64_tr_b16 a[230:231], v9 offset:41664
  ds_read_b64_tr_b16 a[236:237], v9 offset:41672
  v_mfma_f32_16x16x32_bf16 v[60:63], a[168:171], a[88:91], v[60:63]
  s_add_u32 m0, s24, 33792
  v_fma_f32 v93, v53, s30, v23
  v_mfma_f32_16x16x32_bf16 v[60:63], a[172:175], a[92:95], v[60:63]
  v_exp_f32 v28, v92
  v_mfma_f32_16x16x32_bf16 v[64:67], a[176:179], a[80:83], 0
  s_xor_b32 s33, s27, 33628160
  v_fma_f32 v92, v54, s30, v23
  v_mfma_f32_16x16x32_bf16 v[64:67], a[180:183], a[84:87], v[64:67]
  v_exp_f32 v29, v93
  v_mfma_f32_16x16x32_bf16 v[64:67], a[184:187], a[88:91], v[64:67]
  v_fma_f32 v93, v55, s30, v23
  v_cvt_pk_bf16_f32 v72, v28, v29
  v_mfma_f32_16x16x32_bf16 v[64:67], a[188:191], a[92:95], v[64:67]
  v_exp_f32 v30, v92
  v_mfma_f32_16x16x32_bf16 v[48:51], a[240:243], v[88:91], v[48:51]
  buffer_load_dwordx4 v2, s[12:15], s33 offen nt lds
  v_fma_f32 v92, v56, s30, v23
  s_waitcnt lgkmcnt(0)
  v_mfma_f32_16x16x32_bf16 v[224:227], a[192:195], v[88:91], v[224:227]
  v_exp_f32 v31, v93
  v_mfma_f32_16x16x32_bf16 v[228:231], a[198:201], v[88:91], v[228:231]
  v_fma_f32 v93, v57, s30, v23
  v_cvt_pk_bf16_f32 v73, v30, v31
  v_mfma_f32_16x16x32_bf16 v[232:235], a[204:207], v[88:91], v[232:235]
  v_exp_f32 v28, v92
  v_mfma_f32_16x16x32_bf16 v[236:239], a[210:213], v[88:91], v[236:239]
  buffer_load_dwordx4 v3, s[12:15], s33 offen offset:1024 nt lds
  v_fma_f32 v92, v58, s30, v23
  v_mfma_f32_16x16x32_bf16 v[240:243], a[216:219], v[88:91], v[240:243]
  v_exp_f32 v29, v93
  v_mfma_f32_16x16x32_bf16 v[244:247], a[222:225], v[88:91], v[244:247]
  v_fma_f32 v93, v59, s30, v23
  v_cvt_pk_bf16_f32 v74, v28, v29
  v_mfma_f32_16x16x32_bf16 v[248:251], a[228:231], v[88:91], v[248:251]
  v_exp_f32 v30, v92
  v_mfma_f32_16x16x32_bf16 v[252:255], a[234:237], v[88:91], v[252:255]
  s_add_u32 m0, s25, 33280
  v_fma_f32 v92, v60, s30, v24
  v_mfma_f32_16x16x32_bf16 v[52:55], a[160:163], a[96:99], 0
  v_exp_f32 v31, v93
  v_mfma_f32_16x16x32_bf16 v[52:55], a[164:167], a[100:103], v[52:55]
  v_cvt_pk_bf16_f32 v75, v30, v31
  v_fma_f32 v93, v61, s30, v24
  v_mfma_f32_16x16x32_bf16 v[52:55], a[168:171], a[104:107], v[52:55]
  v_exp_f32 v28, v92
  v_mfma_f32_16x16x32_bf16 v[52:55], a[172:175], a[108:111], v[52:55]
  buffer_load_dwordx4 v4, s[16:19], s33 offen nt lds
  v_fma_f32 v92, v62, s30, v24
  v_mfma_f32_16x16x32_bf16 v[56:59], a[176:179], a[96:99], 0
  v_exp_f32 v29, v93
  v_mfma_f32_16x16x32_bf16 v[56:59], a[180:183], a[100:103], v[56:59]
  v_fma_f32 v93, v63, s30, v24
  v_cvt_pk_bf16_f32 v76, v28, v29
  v_mfma_f32_16x16x32_bf16 v[56:59], a[184:187], a[104:107], v[56:59]
  v_exp_f32 v30, v92
  v_mfma_f32_16x16x32_bf16 v[56:59], a[188:191], a[108:111], v[56:59]
  buffer_load_dwordx4 v5, s[16:19], s33 offen offset:1024 nt lds
  v_fma_f32 v92, v64, s30, v24
  v_mfma_f32_16x16x32_bf16 v[32:35], a[240:243], v[72:75], v[32:35]
  v_exp_f32 v31, v93
  v_mfma_f32_16x16x32_bf16 v[96:99], a[194:197], v[72:75], v[96:99]
  v_fma_f32 v93, v65, s30, v24
  v_cvt_pk_bf16_f32 v77, v30, v31
  v_mfma_f32_16x16x32_bf16 v[100:103], a[200:203], v[72:75], v[100:103]
  v_exp_f32 v28, v92
  v_mfma_f32_16x16x32_bf16 v[104:107], a[206:209], v[72:75], v[104:107]
  v_fma_f32 v92, v66, s30, v24
  v_mul_u32_u24 v18, 0x110, v0
  v_mfma_f32_16x16x32_bf16 v[108:111], a[212:215], v[72:75], v[108:111]
  v_exp_f32 v29, v93
  v_mfma_f32_16x16x32_bf16 v[112:115], a[218:221], v[72:75], v[112:115]
  v_fma_f32 v93, v67, s30, v24
  v_cvt_pk_bf16_f32 v78, v28, v29
  v_mfma_f32_16x16x32_bf16 v[116:119], a[224:227], v[72:75], v[116:119]
  v_exp_f32 v30, v92
  v_mfma_f32_16x16x32_bf16 v[120:123], a[230:233], v[72:75], v[120:123]
  v_fma_f32 v92, v52, s30, v25
  v_add3_u32 v18, v18, v1, s26
  v_mfma_f32_16x16x32_bf16 v[124:127], a[236:239], v[72:75], v[124:127]
  v_exp_f32 v31, v93
  s_waitcnt vmcnt(20)
  s_barrier
  v_mfma_f32_16x16x32_bf16 v[60:63], a[160:163], a[112:115], 0
  v_cvt_pk_bf16_f32 v79, v30, v31
  v_fma_f32 v93, v53, s30, v25
  v_mfma_f32_16x16x32_bf16 v[60:63], a[164:167], a[116:119], v[60:63]
  v_exp_f32 v28, v92
  v_mfma_f32_16x16x32_bf16 v[60:63], a[168:171], a[120:123], v[60:63]
  ds_read_b128 a[160:163], v6 offset:50688
  v_fma_f32 v92, v54, s30, v25
  v_mfma_f32_16x16x32_bf16 v[60:63], a[172:175], a[124:127], v[60:63]
  v_exp_f32 v29, v93
  v_mfma_f32_16x16x32_bf16 v[64:67], a[176:179], a[112:115], 0
  v_fma_f32 v93, v55, s30, v25
  v_cvt_pk_bf16_f32 v80, v28, v29
  v_mfma_f32_16x16x32_bf16 v[64:67], a[180:183], a[116:119], v[64:67]
  v_exp_f32 v30, v92
  v_mfma_f32_16x16x32_bf16 v[64:67], a[184:187], a[120:123], v[64:67]
  ds_read_b128 a[164:167], v6 offset:50752
  v_fma_f32 v92, v56, s30, v25
  v_mfma_f32_16x16x32_bf16 v[64:67], a[188:191], a[124:127], v[64:67]
  v_exp_f32 v31, v93
  v_mfma_f32_16x16x32_bf16 v[36:39], a[240:243], v[76:79], v[36:39]
  ds_read_b128 a[168:171], v6 offset:50816
  v_fma_f32 v93, v57, s30, v25
  v_mfma_f32_16x16x32_bf16 v[128:131], a[194:197], v[76:79], v[128:131]
  ds_read_b128 a[172:175], v6 offset:50880
  v_cvt_pk_bf16_f32 v81, v30, v31
  v_mfma_f32_16x16x32_bf16 v[132:135], a[200:203], v[76:79], v[132:135]
  v_exp_f32 v28, v92
  v_mfma_f32_16x16x32_bf16 v[136:139], a[206:209], v[76:79], v[136:139]
  ds_read_b128 a[176:179], v7 offset:50688
  v_fma_f32 v92, v58, s30, v25
  v_mfma_f32_16x16x32_bf16 v[140:143], a[212:215], v[76:79], v[140:143]
  v_exp_f32 v29, v93
  v_mfma_f32_16x16x32_bf16 v[144:147], a[218:221], v[76:79], v[144:147]
  v_fma_f32 v93, v59, s30, v25
  v_cvt_pk_bf16_f32 v82, v28, v29
  v_mfma_f32_16x16x32_bf16 v[148:151], a[224:227], v[76:79], v[148:151]
  v_exp_f32 v30, v92
  v_mfma_f32_16x16x32_bf16 v[152:155], a[230:233], v[76:79], v[152:155]
  ds_read_b128 a[180:183], v7 offset:50752
  v_fma_f32 v92, v60, s30, v26
  v_mfma_f32_16x16x32_bf16 v[156:159], a[236:239], v[76:79], v[156:159]
  v_exp_f32 v31, v93
  s_waitcnt lgkmcnt(2)
  v_mfma_f32_16x16x32_bf16 v[68:71], a[160:163], a[144:147], 0
  v_cvt_pk_bf16_f32 v83, v30, v31
  v_fma_f32 v93, v61, s30, v26
  v_mfma_f32_16x16x32_bf16 v[68:71], a[164:167], a[148:151], v[68:71]
  v_exp_f32 v28, v92
  v_mfma_f32_16x16x32_bf16 v[68:71], a[168:171], a[152:155], v[68:71]
  ds_read_b128 a[184:187], v7 offset:50816
  v_fma_f32 v92, v62, s30, v26
  v_mfma_f32_16x16x32_bf16 v[68:71], a[172:175], a[156:159], v[68:71]
  v_exp_f32 v29, v93
  v_mfma_f32_16x16x32_bf16 v[40:43], a[240:243], v[80:83], v[40:43]
  v_fma_f32 v93, v63, s30, v26
  v_cvt_pk_bf16_f32 v84, v28, v29
  v_mfma_f32_16x16x32_bf16 v[160:163], a[194:197], v[80:83], v[160:163]
  v_exp_f32 v30, v92
  v_mfma_f32_16x16x32_bf16 v[164:167], a[200:203], v[80:83], v[164:167]
  ds_read_b128 a[188:191], v7 offset:50880
  v_fma_f32 v92, v64, s30, v26
  v_mfma_f32_16x16x32_bf16 v[168:171], a[206:209], v[80:83], v[168:171]
  v_exp_f32 v31, v93
  v_mfma_f32_16x16x32_bf16 v[172:175], a[212:215], v[80:83], v[172:175]
  v_fma_f32 v93, v65, s30, v26
  v_cvt_pk_bf16_f32 v85, v30, v31
  v_mfma_f32_16x16x32_bf16 v[176:179], a[218:221], v[80:83], v[176:179]
  v_exp_f32 v28, v92
  v_mfma_f32_16x16x32_bf16 v[180:183], a[224:227], v[80:83], v[180:183]
  ds_read_b64_tr_b16 a[192:193], v8 offset:49920
  v_fma_f32 v92, v66, s30, v26
  v_mfma_f32_16x16x32_bf16 v[184:187], a[230:233], v[80:83], v[184:187]
  v_exp_f32 v29, v93
  v_mfma_f32_16x16x32_bf16 v[188:191], a[236:239], v[80:83], v[188:191]
  v_fma_f32 v93, v67, s30, v26
  v_cvt_pk_bf16_f32 v86, v28, v29
  v_mfma_f32_16x16x32_bf16 v[52:55], a[160:163], a[64:67], 0
  v_exp_f32 v30, v92
  v_mfma_f32_16x16x32_bf16 v[52:55], a[164:167], a[68:71], v[52:55]
  ds_read_b64_tr_b16 a[198:199], v8 offset:49928
  v_fma_f32 v92, v68, s30, v27
  v_mfma_f32_16x16x32_bf16 v[52:55], a[168:171], a[72:75], v[52:55]
  v_exp_f32 v31, v93
  v_mfma_f32_16x16x32_bf16 v[52:55], a[172:175], a[76:79], v[52:55]
  v_cvt_pk_bf16_f32 v87, v30, v31
  v_fma_f32 v93, v69, s30, v27
  s_waitcnt lgkmcnt(1)
  v_mfma_f32_16x16x32_bf16 v[56:59], a[176:179], a[64:67], 0
  v_exp_f32 v28, v92
  v_mfma_f32_16x16x32_bf16 v[56:59], a[180:183], a[68:71], v[56:59]
  ds_read_b64_tr_b16 a[204:205], v8 offset:49984
  v_fma_f32 v92, v70, s30, v27
  v_mfma_f32_16x16x32_bf16 v[56:59], a[184:187], a[72:75], v[56:59]
  v_exp_f32 v29, v93
  v_mfma_f32_16x16x32_bf16 v[56:59], a[188:191], a[76:79], v[56:59]
  v_fma_f32 v93, v71, s30, v27
  v_cvt_pk_bf16_f32 v88, v28, v29
  v_mfma_f32_16x16x32_bf16 v[44:47], a[240:243], v[84:87], v[44:47]
  v_exp_f32 v30, v92
  v_mfma_f32_16x16x32_bf16 v[192:195], a[194:197], v[84:87], v[192:195]
  ds_read_b64_tr_b16 a[210:211], v8 offset:49992
  v_fma_f32 v92, v52, s30, v23
  v_mfma_f32_16x16x32_bf16 v[196:199], a[200:203], v[84:87], v[196:199]
  v_exp_f32 v31, v93
  v_mfma_f32_16x16x32_bf16 v[200:203], a[206:209], v[84:87], v[200:203]
  v_cvt_pk_bf16_f32 v89, v30, v31
  v_fma_f32 v93, v53, s30, v23
  v_mfma_f32_16x16x32_bf16 v[204:207], a[212:215], v[84:87], v[204:207]
  v_exp_f32 v28, v92
  v_mfma_f32_16x16x32_bf16 v[208:211], a[218:221], v[84:87], v[208:211]
  ds_read_b64_tr_b16 a[216:217], v9 offset:49920
  v_fma_f32 v92, v54, s30, v23
  v_mfma_f32_16x16x32_bf16 v[212:215], a[224:227], v[84:87], v[212:215]
  v_exp_f32 v29, v93
  v_mfma_f32_16x16x32_bf16 v[216:219], a[230:233], v[84:87], v[216:219]
  v_fma_f32 v93, v55, s30, v23
  v_cvt_pk_bf16_f32 v72, v28, v29
  v_mfma_f32_16x16x32_bf16 v[220:223], a[236:239], v[84:87], v[220:223]
  v_exp_f32 v30, v92
  v_mfma_f32_16x16x32_bf16 v[60:63], a[160:163], a[80:83], 0
  ds_read_b64_tr_b16 a[222:223], v9 offset:49928
  v_fma_f32 v92, v56, s30, v23
  v_mfma_f32_16x16x32_bf16 v[60:63], a[164:167], a[84:87], v[60:63]
  v_exp_f32 v31, v93
  v_mfma_f32_16x16x32_bf16 v[60:63], a[168:171], a[88:91], v[60:63]
  v_fma_f32 v93, v57, s30, v23
  v_cvt_pk_bf16_f32 v73, v30, v31
  v_mfma_f32_16x16x32_bf16 v[60:63], a[172:175], a[92:95], v[60:63]
  v_exp_f32 v28, v92
  v_mfma_f32_16x16x32_bf16 v[64:67], a[176:179], a[80:83], 0
  ds_read_b64_tr_b16 a[228:229], v9 offset:49984
  v_fma_f32 v92, v58, s30, v23
  v_mfma_f32_16x16x32_bf16 v[64:67], a[180:183], a[84:87], v[64:67]
  v_exp_f32 v29, v93
  v_mfma_f32_16x16x32_bf16 v[64:67], a[184:187], a[88:91], v[64:67]
  ds_read_b64_tr_b16 a[234:235], v9 offset:49992
  v_fma_f32 v93, v59, s30, v23
  v_mfma_f32_16x16x32_bf16 v[64:67], a[188:191], a[92:95], v[64:67]
  ds_read_b64_tr_b16 a[194:195], v10 offset:49920
  v_cvt_pk_bf16_f32 v74, v28, v29
  v_mfma_f32_16x16x32_bf16 v[52:55], a[160:163], a[96:99], 0
  v_exp_f32 v30, v92
  v_mfma_f32_16x16x32_bf16 v[52:55], a[164:167], a[100:103], v[52:55]
  ds_read_b64_tr_b16 a[200:201], v10 offset:49928
  v_fma_f32 v92, v60, s30, v24
  v_mfma_f32_16x16x32_bf16 v[52:55], a[168:171], a[104:107], v[52:55]
  ds_read_b64_tr_b16 a[206:207], v10 offset:49984
  ds_read_b64_tr_b16 a[212:213], v10 offset:49992
  v_mfma_f32_16x16x32_bf16 v[52:55], a[172:175], a[108:111], v[52:55]
  v_exp_f32 v31, v93
  v_mfma_f32_16x16x32_bf16 v[56:59], a[176:179], a[96:99], 0
  ds_read_b64_tr_b16 a[218:219], v11 offset:49920
  v_cvt_pk_bf16_f32 v75, v30, v31
  v_mfma_f32_16x16x32_bf16 v[56:59], a[180:183], a[100:103], v[56:59]
  ds_read_b64_tr_b16 a[224:225], v11 offset:49928
  ds_read_b64_tr_b16 a[230:231], v11 offset:49984
  v_mfma_f32_16x16x32_bf16 v[56:59], a[184:187], a[104:107], v[56:59]
  ds_read_b64_tr_b16 a[236:237], v11 offset:49992
  v_fma_f32 v93, v61, s30, v24
  v_mfma_f32_16x16x32_bf16 v[56:59], a[188:191], a[108:111], v[56:59]
  v_exp_f32 v28, v92
  v_mfma_f32_16x16x32_bf16 v[32:35], a[240:243], v[72:75], v[32:35]
  s_add_u32 m0, s24, 42240
  v_fma_f32 v92, v62, s30, v24
  s_waitcnt lgkmcnt(4)
  v_mfma_f32_16x16x32_bf16 v[96:99], a[192:195], v[72:75], v[96:99]
  v_exp_f32 v29, v93
  v_mfma_f32_16x16x32_bf16 v[100:103], a[198:201], v[72:75], v[100:103]
  s_xor_b32 s33, s27, 33636352
  v_fma_f32 v93, v63, s30, v24
  v_mfma_f32_16x16x32_bf16 v[104:107], a[204:207], v[72:75], v[104:107]
  buffer_load_dwordx4 v2, s[12:15], s33 offen nt lds
  v_cvt_pk_bf16_f32 v76, v28, v29
  v_mfma_f32_16x16x32_bf16 v[108:111], a[210:213], v[72:75], v[108:111]
  buffer_load_dwordx4 v3, s[12:15], s33 offen offset:1024 nt lds
  s_add_u32 m0, s25, 41600
  s_waitcnt lgkmcnt(0)
  v_mfma_f32_16x16x32_bf16 v[112:115], a[216:219], v[72:75], v[112:115]
  v_exp_f32 v30, v92
  v_mfma_f32_16x16x32_bf16 v[116:119], a[222:225], v[72:75], v[116:119]
  buffer_load_dwordx4 v4, s[16:19], s33 offen nt lds
  v_fma_f32 v92, v64, s30, v24
  v_mfma_f32_16x16x32_bf16 v[120:123], a[228:231], v[72:75], v[120:123]
  buffer_load_dwordx4 v5, s[16:19], s33 offen offset:1024 nt lds
  ds_read_b128 a[128:131], v18 offset:0
  v_mfma_f32_16x16x32_bf16 v[124:127], a[234:237], v[72:75], v[124:127]
  v_exp_f32 v31, v93
  v_fma_f32 v93, v65, s30, v24
  s_waitcnt vmcnt(20)
  s_barrier
  v_mfma_f32_16x16x32_bf16 v[60:63], a[160:163], a[112:115], 0
  v_cvt_pk_bf16_f32 v77, v30, v31
  v_exp_f32 v28, v92
  v_mfma_f32_16x16x32_bf16 v[60:63], a[164:167], a[116:119], v[60:63]
  ds_read_b128 a[160:163], v6 offset:0
  v_fma_f32 v92, v66, s30, v24
  v_mfma_f32_16x16x32_bf16 v[60:63], a[168:171], a[120:123], v[60:63]
  v_exp_f32 v29, v93
  v_fma_f32 v93, v67, s30, v24
  v_cvt_pk_bf16_f32 v78, v28, v29
  v_mfma_f32_16x16x32_bf16 v[60:63], a[172:175], a[124:127], v[60:63]
  v_exp_f32 v30, v92
  v_mfma_f32_16x16x32_bf16 v[64:67], a[176:179], a[112:115], 0
  v_fma_f32 v92, v52, s30, v25
  v_exp_f32 v31, v93
  v_mfma_f32_16x16x32_bf16 v[64:67], a[180:183], a[116:119], v[64:67]
  v_cvt_pk_bf16_f32 v79, v30, v31
  v_fma_f32 v93, v53, s30, v25
  v_mfma_f32_16x16x32_bf16 v[64:67], a[184:187], a[120:123], v[64:67]
  v_exp_f32 v28, v92
  v_mfma_f32_16x16x32_bf16 v[64:67], a[188:191], a[124:127], v[64:67]
  ds_read_b128 a[164:167], v6 offset:64
  v_fma_f32 v92, v54, s30, v25
  v_mfma_f32_16x16x32_bf16 v[36:39], a[240:243], v[76:79], v[36:39]
  v_exp_f32 v29, v93
  v_mfma_f32_16x16x32_bf16 v[128:131], a[192:195], v[76:79], v[128:131]
  v_fma_f32 v93, v55, s30, v25
  v_cvt_pk_bf16_f32 v80, v28, v29
  v_mfma_f32_16x16x32_bf16 v[132:135], a[198:201], v[76:79], v[132:135]
  v_exp_f32 v30, v92
  v_mfma_f32_16x16x32_bf16 v[136:139], a[204:207], v[76:79], v[136:139]
  ds_read_b128 a[168:171], v6 offset:128
  v_fma_f32 v92, v56, s30, v25
  v_mfma_f32_16x16x32_bf16 v[140:143], a[210:213], v[76:79], v[140:143]
  v_exp_f32 v31, v93
  v_fma_f32 v93, v57, s30, v25
  v_mfma_f32_16x16x32_bf16 v[144:147], a[216:219], v[76:79], v[144:147]
  ds_read_b128 a[172:175], v6 offset:192
  v_cvt_pk_bf16_f32 v81, v30, v31
  v_exp_f32 v28, v92
  v_mfma_f32_16x16x32_bf16 v[148:151], a[222:225], v[76:79], v[148:151]
  ds_read_b128 a[176:179], v7 offset:0
  v_fma_f32 v92, v58, s30, v25
  v_mfma_f32_16x16x32_bf16 v[152:155], a[228:231], v[76:79], v[152:155]
  v_exp_f32 v29, v93
  v_fma_f32 v93, v59, s30, v25
  v_cvt_pk_bf16_f32 v82, v28, v29
  v_mfma_f32_16x16x32_bf16 v[156:159], a[234:237], v[76:79], v[156:159]
  v_exp_f32 v30, v92
  s_waitcnt lgkmcnt(3)
  v_mfma_f32_16x16x32_bf16 v[68:71], a[160:163], a[144:147], 0
  v_fma_f32 v92, v60, s30, v26
  v_exp_f32 v31, v93
  v_mfma_f32_16x16x32_bf16 v[68:71], a[164:167], a[148:151], v[68:71]
  v_cvt_pk_bf16_f32 v83, v30, v31
  v_fma_f32 v93, v61, s30, v26
  s_waitcnt lgkmcnt(2)
  v_mfma_f32_16x16x32_bf16 v[68:71], a[168:171], a[152:155], v[68:71]
  v_exp_f32 v28, v92
  s_waitcnt lgkmcnt(1)
  v_mfma_f32_16x16x32_bf16 v[68:71], a[172:175], a[156:159], v[68:71]
  ds_read_b128 a[180:183], v7 offset:64
  v_fma_f32 v92, v62, s30, v26
  v_mfma_f32_16x16x32_bf16 v[40:43], a[240:243], v[80:83], v[40:43]
  v_exp_f32 v29, v93
  v_mfma_f32_16x16x32_bf16 v[160:163], a[192:195], v[80:83], v[160:163]
  v_fma_f32 v93, v63, s30, v26
  v_cvt_pk_bf16_f32 v84, v28, v29
  v_mfma_f32_16x16x32_bf16 v[164:167], a[198:201], v[80:83], v[164:167]
  v_exp_f32 v30, v92
  v_mfma_f32_16x16x32_bf16 v[168:171], a[204:207], v[80:83], v[168:171]
  ds_read_b128 a[184:187], v7 offset:128
  v_fma_f32 v92, v64, s30, v26
  v_mfma_f32_16x16x32_bf16 v[172:175], a[210:213], v[80:83], v[172:175]
  v_exp_f32 v31, v93
  v_mfma_f32_16x16x32_bf16 v[176:179], a[216:219], v[80:83], v[176:179]
  v_fma_f32 v93, v65, s30, v26
  v_cvt_pk_bf16_f32 v85, v30, v31
  v_mfma_f32_16x16x32_bf16 v[180:183], a[222:225], v[80:83], v[180:183]
  v_exp_f32 v28, v92
  v_mfma_f32_16x16x32_bf16 v[184:187], a[228:231], v[80:83], v[184:187]
  ds_read_b128 a[188:191], v7 offset:192
  v_fma_f32 v92, v66, s30, v26
  v_mfma_f32_16x16x32_bf16 v[188:191], a[234:237], v[80:83], v[188:191]
  v_exp_f32 v29, v93
  v_mfma_f32_16x16x32_bf16 v[52:55], a[160:163], a[64:67], 0
  v_fma_f32 v93, v67, s30, v26
  v_cvt_pk_bf16_f32 v86, v28, v29
  v_mfma_f32_16x16x32_bf16 v[52:55], a[164:167], a[68:71], v[52:55]
  v_exp_f32 v30, v92
  v_mfma_f32_16x16x32_bf16 v[52:55], a[168:171], a[72:75], v[52:55]
  ds_read_b64_tr_b16 a[196:197], v10 offset:0
  v_fma_f32 v92, v68, s30, v27
  v_mfma_f32_16x16x32_bf16 v[52:55], a[172:175], a[76:79], v[52:55]
  v_exp_f32 v31, v93
  s_waitcnt lgkmcnt(2)
  v_mfma_f32_16x16x32_bf16 v[56:59], a[176:179], a[64:67], 0
  ds_read_b64_tr_b16 a[202:203], v10 offset:8
  v_cvt_pk_bf16_f32 v87, v30, v31
  v_mfma_f32_16x16x32_bf16 v[56:59], a[180:183], a[68:71], v[56:59]
  ds_read_b64_tr_b16 a[208:209], v10 offset:64
  v_fma_f32 v93, v69, s30, v27
  v_mfma_f32_16x16x32_bf16 v[56:59], a[184:187], a[72:75], v[56:59]
  ds_read_b64_tr_b16 a[214:215], v10 offset:72
  ds_read_b64_tr_b16 a[220:221], v11 offset:0
  s_waitcnt lgkmcnt(5)
  v_mfma_f32_16x16x32_bf16 v[56:59], a[188:191], a[76:79], v[56:59]
  v_exp_f32 v28, v92
  v_mfma_f32_16x16x32_bf16 v[44:47], a[240:243], v[84:87], v[44:47]
  ds_read_b64_tr_b16 a[226:227], v11 offset:8
  v_fma_f32 v92, v70, s30, v27
  v_mfma_f32_16x16x32_bf16 v[192:195], a[192:195], v[84:87], v[192:195]
  ds_read_b64_tr_b16 a[232:233], v11 offset:64
  ds_read_b64_tr_b16 a[238:239], v11 offset:72
  v_mfma_f32_16x16x32_bf16 v[196:199], a[198:201], v[84:87], v[196:199]
  v_exp_f32 v29, v93
  v_mfma_f32_16x16x32_bf16 v[200:203], a[204:207], v[84:87], v[200:203]
  ds_read_b64_tr_b16 a[194:195], v8 offset:0
  v_fma_f32 v93, v71, s30, v27
  v_mfma_f32_16x16x32_bf16 v[204:207], a[210:213], v[84:87], v[204:207]
  ds_read_b64_tr_b16 a[200:201], v8 offset:8
  v_cvt_pk_bf16_f32 v90, v28, v29
  v_mfma_f32_16x16x32_bf16 v[208:211], a[216:219], v[84:87], v[208:211]
  v_exp_f32 v30, v92
  v_mfma_f32_16x16x32_bf16 v[212:215], a[222:225], v[84:87], v[212:215]
  ds_read_b64_tr_b16 a[206:207], v8 offset:64
  v_fma_f32 v92, v52, s30, v23
  v_mfma_f32_16x16x32_bf16 v[216:219], a[228:231], v[84:87], v[216:219]
  v_exp_f32 v31, v93
  v_mfma_f32_16x16x32_bf16 v[220:223], a[234:237], v[84:87], v[220:223]
  ds_read_b64_tr_b16 a[212:213], v8 offset:72
  v_cvt_pk_bf16_f32 v91, v30, v31
  v_mfma_f32_16x16x32_bf16 v[60:63], a[160:163], a[80:83], 0
  ds_read_b64_tr_b16 a[218:219], v9 offset:0
  ds_read_b64_tr_b16 a[224:225], v9 offset:8
  v_mfma_f32_16x16x32_bf16 v[60:63], a[164:167], a[84:87], v[60:63]
  ds_read_b64_tr_b16 a[230:231], v9 offset:64
  ds_read_b64_tr_b16 a[236:237], v9 offset:72
  v_mfma_f32_16x16x32_bf16 v[60:63], a[168:171], a[88:91], v[60:63]
  s_add_u32 m0, s24, 50688
  v_fma_f32 v93, v53, s30, v23
  v_mfma_f32_16x16x32_bf16 v[60:63], a[172:175], a[92:95], v[60:63]
  v_exp_f32 v28, v92
  v_mfma_f32_16x16x32_bf16 v[64:67], a[176:179], a[80:83], 0
  s_xor_b32 s33, s27, 33644544
  v_fma_f32 v92, v54, s30, v23
  v_mfma_f32_16x16x32_bf16 v[64:67], a[180:183], a[84:87], v[64:67]
  v_exp_f32 v29, v93
  v_mfma_f32_16x16x32_bf16 v[64:67], a[184:187], a[88:91], v[64:67]
  v_fma_f32 v93, v55, s30, v23
  v_cvt_pk_bf16_f32 v72, v28, v29
  v_mfma_f32_16x16x32_bf16 v[64:67], a[188:191], a[92:95], v[64:67]
  v_exp_f32 v30, v92
  v_mfma_f32_16x16x32_bf16 v[48:51], a[240:243], v[88:91], v[48:51]
  buffer_load_dwordx4 v2, s[12:15], s33 offen nt lds
  v_fma_f32 v92, v56, s30, v23
  s_waitcnt lgkmcnt(0)
  v_mfma_f32_16x16x32_bf16 v[224:227], a[192:195], v[88:91], v[224:227]
  v_exp_f32 v31, v93
  v_mfma_f32_16x16x32_bf16 v[228:231], a[198:201], v[88:91], v[228:231]
  v_fma_f32 v93, v57, s30, v23
  v_cvt_pk_bf16_f32 v73, v30, v31
  v_mfma_f32_16x16x32_bf16 v[232:235], a[204:207], v[88:91], v[232:235]
  v_exp_f32 v28, v92
  v_mfma_f32_16x16x32_bf16 v[236:239], a[210:213], v[88:91], v[236:239]
  buffer_load_dwordx4 v3, s[12:15], s33 offen offset:1024 nt lds
  v_fma_f32 v92, v58, s30, v23
  v_mfma_f32_16x16x32_bf16 v[240:243], a[216:219], v[88:91], v[240:243]
  v_exp_f32 v29, v93
  v_mfma_f32_16x16x32_bf16 v[244:247], a[222:225], v[88:91], v[244:247]
  v_fma_f32 v93, v59, s30, v23
  v_cvt_pk_bf16_f32 v74, v28, v29
  v_mfma_f32_16x16x32_bf16 v[248:251], a[228:231], v[88:91], v[248:251]
  v_exp_f32 v30, v92
  v_mfma_f32_16x16x32_bf16 v[252:255], a[234:237], v[88:91], v[252:255]
  s_add_u32 m0, s25, 49920
  v_fma_f32 v92, v60, s30, v24
  v_mfma_f32_16x16x32_bf16 v[52:55], a[160:163], a[96:99], 0
  v_exp_f32 v31, v93
  v_mfma_f32_16x16x32_bf16 v[52:55], a[164:167], a[100:103], v[52:55]
  v_cvt_pk_bf16_f32 v75, v30, v31
  v_fma_f32 v93, v61, s30, v24
  v_mfma_f32_16x16x32_bf16 v[52:55], a[168:171], a[104:107], v[52:55]
  v_exp_f32 v28, v92
  v_mfma_f32_16x16x32_bf16 v[52:55], a[172:175], a[108:111], v[52:55]
  buffer_load_dwordx4 v4, s[16:19], s33 offen nt lds
  v_fma_f32 v92, v62, s30, v24
  v_mfma_f32_16x16x32_bf16 v[56:59], a[176:179], a[96:99], 0
  v_exp_f32 v29, v93
  v_mfma_f32_16x16x32_bf16 v[56:59], a[180:183], a[100:103], v[56:59]
  v_fma_f32 v93, v63, s30, v24
  v_cvt_pk_bf16_f32 v76, v28, v29
  v_mfma_f32_16x16x32_bf16 v[56:59], a[184:187], a[104:107], v[56:59]
  v_exp_f32 v30, v92
  v_mfma_f32_16x16x32_bf16 v[56:59], a[188:191], a[108:111], v[56:59]
  buffer_load_dwordx4 v5, s[16:19], s33 offen offset:1024 nt lds
  v_fma_f32 v92, v64, s30, v24
  v_mfma_f32_16x16x32_bf16 v[32:35], a[240:243], v[72:75], v[32:35]
  v_exp_f32 v31, v93
  v_mfma_f32_16x16x32_bf16 v[96:99], a[194:197], v[72:75], v[96:99]
  v_fma_f32 v93, v65, s30, v24
  v_cvt_pk_bf16_f32 v77, v30, v31
  v_mfma_f32_16x16x32_bf16 v[100:103], a[200:203], v[72:75], v[100:103]
  v_exp_f32 v28, v92
  v_mfma_f32_16x16x32_bf16 v[104:107], a[206:209], v[72:75], v[104:107]
  v_fma_f32 v92, v66, s30, v24
  ds_read_b128 a[132:135], v18 offset:2176
  v_mfma_f32_16x16x32_bf16 v[108:111], a[212:215], v[72:75], v[108:111]
  v_exp_f32 v29, v93
  v_mfma_f32_16x16x32_bf16 v[112:115], a[218:221], v[72:75], v[112:115]
  v_fma_f32 v93, v67, s30, v24
  v_cvt_pk_bf16_f32 v78, v28, v29
  v_mfma_f32_16x16x32_bf16 v[116:119], a[224:227], v[72:75], v[116:119]
  v_exp_f32 v30, v92
  v_mfma_f32_16x16x32_bf16 v[120:123], a[230:233], v[72:75], v[120:123]
  v_fma_f32 v92, v52, s30, v25
  v_lshl_add_u32 v13, v0, 8, v1
  v_mfma_f32_16x16x32_bf16 v[124:127], a[236:239], v[72:75], v[124:127]
  v_exp_f32 v31, v93
  s_waitcnt vmcnt(20)
  s_barrier
  v_mfma_f32_16x16x32_bf16 v[60:63], a[160:163], a[112:115], 0
  v_cvt_pk_bf16_f32 v79, v30, v31
  v_fma_f32 v93, v53, s30, v25
  v_mfma_f32_16x16x32_bf16 v[60:63], a[164:167], a[116:119], v[60:63]
  v_exp_f32 v28, v92
  v_mfma_f32_16x16x32_bf16 v[60:63], a[168:171], a[120:123], v[60:63]
  ds_read_b128 a[160:163], v6 offset:8448
  v_fma_f32 v92, v54, s30, v25
  v_mfma_f32_16x16x32_bf16 v[60:63], a[172:175], a[124:127], v[60:63]
  v_exp_f32 v29, v93
  v_mfma_f32_16x16x32_bf16 v[64:67], a[176:179], a[112:115], 0
  v_fma_f32 v93, v55, s30, v25
  v_cvt_pk_bf16_f32 v80, v28, v29
  v_mfma_f32_16x16x32_bf16 v[64:67], a[180:183], a[116:119], v[64:67]
  v_exp_f32 v30, v92
  v_mfma_f32_16x16x32_bf16 v[64:67], a[184:187], a[120:123], v[64:67]
  ds_read_b128 a[164:167], v6 offset:8512
  v_fma_f32 v92, v56, s30, v25
  v_mfma_f32_16x16x32_bf16 v[64:67], a[188:191], a[124:127], v[64:67]
  v_exp_f32 v31, v93
  v_mfma_f32_16x16x32_bf16 v[36:39], a[240:243], v[76:79], v[36:39]
  ds_read_b128 a[168:171], v6 offset:8576
  v_fma_f32 v93, v57, s30, v25
  v_mfma_f32_16x16x32_bf16 v[128:131], a[194:197], v[76:79], v[128:131]
  ds_read_b128 a[172:175], v6 offset:8640
  v_cvt_pk_bf16_f32 v81, v30, v31
  v_mfma_f32_16x16x32_bf16 v[132:135], a[200:203], v[76:79], v[132:135]
  v_exp_f32 v28, v92
  v_mfma_f32_16x16x32_bf16 v[136:139], a[206:209], v[76:79], v[136:139]
  ds_read_b128 a[176:179], v7 offset:8448
  v_fma_f32 v92, v58, s30, v25
  v_mfma_f32_16x16x32_bf16 v[140:143], a[212:215], v[76:79], v[140:143]
  v_exp_f32 v29, v93
  v_mfma_f32_16x16x32_bf16 v[144:147], a[218:221], v[76:79], v[144:147]
  v_fma_f32 v93, v59, s30, v25
  v_cvt_pk_bf16_f32 v82, v28, v29
  v_mfma_f32_16x16x32_bf16 v[148:151], a[224:227], v[76:79], v[148:151]
  v_exp_f32 v30, v92
  v_mfma_f32_16x16x32_bf16 v[152:155], a[230:233], v[76:79], v[152:155]
  ds_read_b128 a[180:183], v7 offset:8512
  v_fma_f32 v92, v60, s30, v26
  v_mfma_f32_16x16x32_bf16 v[156:159], a[236:239], v[76:79], v[156:159]
  v_exp_f32 v31, v93
  s_waitcnt lgkmcnt(2)
  v_mfma_f32_16x16x32_bf16 v[68:71], a[160:163], a[144:147], 0
  v_cvt_pk_bf16_f32 v83, v30, v31
  v_fma_f32 v93, v61, s30, v26
  v_mfma_f32_16x16x32_bf16 v[68:71], a[164:167], a[148:151], v[68:71]
  v_exp_f32 v28, v92
  v_mfma_f32_16x16x32_bf16 v[68:71], a[168:171], a[152:155], v[68:71]
  ds_read_b128 a[184:187], v7 offset:8576
  v_fma_f32 v92, v62, s30, v26
  v_mfma_f32_16x16x32_bf16 v[68:71], a[172:175], a[156:159], v[68:71]
  v_exp_f32 v29, v93
  v_mfma_f32_16x16x32_bf16 v[40:43], a[240:243], v[80:83], v[40:43]
  v_fma_f32 v93, v63, s30, v26
  v_cvt_pk_bf16_f32 v84, v28, v29
  v_mfma_f32_16x16x32_bf16 v[160:163], a[194:197], v[80:83], v[160:163]
  v_exp_f32 v30, v92
  v_mfma_f32_16x16x32_bf16 v[164:167], a[200:203], v[80:83], v[164:167]
  ds_read_b128 a[188:191], v7 offset:8640
  v_fma_f32 v92, v64, s30, v26
  v_mfma_f32_16x16x32_bf16 v[168:171], a[206:209], v[80:83], v[168:171]
  v_exp_f32 v31, v93
  v_mfma_f32_16x16x32_bf16 v[172:175], a[212:215], v[80:83], v[172:175]
  v_fma_f32 v93, v65, s30, v26
  v_cvt_pk_bf16_f32 v85, v30, v31
  v_mfma_f32_16x16x32_bf16 v[176:179], a[218:221], v[80:83], v[176:179]
  v_exp_f32 v28, v92
  v_mfma_f32_16x16x32_bf16 v[180:183], a[224:227], v[80:83], v[180:183]
  ds_read_b64_tr_b16 a[192:193], v8 offset:8320
  v_fma_f32 v92, v66, s30, v26
  v_mfma_f32_16x16x32_bf16 v[184:187], a[230:233], v[80:83], v[184:187]
  v_exp_f32 v29, v93
  v_mfma_f32_16x16x32_bf16 v[188:191], a[236:239], v[80:83], v[188:191]
  v_fma_f32 v93, v67, s30, v26
  v_cvt_pk_bf16_f32 v86, v28, v29
  v_mfma_f32_16x16x32_bf16 v[52:55], a[160:163], a[64:67], 0
  v_exp_f32 v30, v92
  v_mfma_f32_16x16x32_bf16 v[52:55], a[164:167], a[68:71], v[52:55]
  ds_read_b64_tr_b16 a[198:199], v8 offset:8328
  v_fma_f32 v92, v68, s30, v27
  v_mfma_f32_16x16x32_bf16 v[52:55], a[168:171], a[72:75], v[52:55]
  v_exp_f32 v31, v93
  v_mfma_f32_16x16x32_bf16 v[52:55], a[172:175], a[76:79], v[52:55]
  v_cvt_pk_bf16_f32 v87, v30, v31
  v_fma_f32 v93, v69, s30, v27
  s_waitcnt lgkmcnt(1)
  v_mfma_f32_16x16x32_bf16 v[56:59], a[176:179], a[64:67], 0
  v_exp_f32 v28, v92
  v_mfma_f32_16x16x32_bf16 v[56:59], a[180:183], a[68:71], v[56:59]
  ds_read_b64_tr_b16 a[204:205], v8 offset:8384
  v_fma_f32 v92, v70, s30, v27
  v_mfma_f32_16x16x32_bf16 v[56:59], a[184:187], a[72:75], v[56:59]
  v_exp_f32 v29, v93
  v_mfma_f32_16x16x32_bf16 v[56:59], a[188:191], a[76:79], v[56:59]
  v_fma_f32 v93, v71, s30, v27
  v_cvt_pk_bf16_f32 v88, v28, v29
  v_mfma_f32_16x16x32_bf16 v[44:47], a[240:243], v[84:87], v[44:47]
  v_exp_f32 v30, v92
  v_mfma_f32_16x16x32_bf16 v[192:195], a[194:197], v[84:87], v[192:195]
  ds_read_b64_tr_b16 a[210:211], v8 offset:8392
  v_fma_f32 v92, v52, s30, v23
  v_mfma_f32_16x16x32_bf16 v[196:199], a[200:203], v[84:87], v[196:199]
  v_exp_f32 v31, v93
  v_mfma_f32_16x16x32_bf16 v[200:203], a[206:209], v[84:87], v[200:203]
  v_cvt_pk_bf16_f32 v89, v30, v31
  v_fma_f32 v93, v53, s30, v23
  v_mfma_f32_16x16x32_bf16 v[204:207], a[212:215], v[84:87], v[204:207]
  v_exp_f32 v28, v92
  v_mfma_f32_16x16x32_bf16 v[208:211], a[218:221], v[84:87], v[208:211]
  ds_read_b64_tr_b16 a[216:217], v9 offset:8320
  v_fma_f32 v92, v54, s30, v23
  v_mfma_f32_16x16x32_bf16 v[212:215], a[224:227], v[84:87], v[212:215]
  v_exp_f32 v29, v93
  v_mfma_f32_16x16x32_bf16 v[216:219], a[230:233], v[84:87], v[216:219]
  v_fma_f32 v93, v55, s30, v23
  v_cvt_pk_bf16_f32 v72, v28, v29
  v_mfma_f32_16x16x32_bf16 v[220:223], a[236:239], v[84:87], v[220:223]
  v_exp_f32 v30, v92
  v_mfma_f32_16x16x32_bf16 v[60:63], a[160:163], a[80:83], 0
  ds_read_b64_tr_b16 a[222:223], v9 offset:8328
  v_fma_f32 v92, v56, s30, v23
  v_mfma_f32_16x16x32_bf16 v[60:63], a[164:167], a[84:87], v[60:63]
  v_exp_f32 v31, v93
  v_mfma_f32_16x16x32_bf16 v[60:63], a[168:171], a[88:91], v[60:63]
  v_fma_f32 v93, v57, s30, v23
  v_cvt_pk_bf16_f32 v73, v30, v31
  v_mfma_f32_16x16x32_bf16 v[60:63], a[172:175], a[92:95], v[60:63]
  v_exp_f32 v28, v92
  v_mfma_f32_16x16x32_bf16 v[64:67], a[176:179], a[80:83], 0
  ds_read_b64_tr_b16 a[228:229], v9 offset:8384
  v_fma_f32 v92, v58, s30, v23
  v_mfma_f32_16x16x32_bf16 v[64:67], a[180:183], a[84:87], v[64:67]
  v_exp_f32 v29, v93
  v_mfma_f32_16x16x32_bf16 v[64:67], a[184:187], a[88:91], v[64:67]
  ds_read_b64_tr_b16 a[234:235], v9 offset:8392
  v_fma_f32 v93, v59, s30, v23
  v_mfma_f32_16x16x32_bf16 v[64:67], a[188:191], a[92:95], v[64:67]
  ds_read_b64_tr_b16 a[194:195], v10 offset:8320
  v_cvt_pk_bf16_f32 v74, v28, v29
  v_mfma_f32_16x16x32_bf16 v[52:55], a[160:163], a[96:99], 0
  v_exp_f32 v30, v92
  v_mfma_f32_16x16x32_bf16 v[52:55], a[164:167], a[100:103], v[52:55]
  ds_read_b64_tr_b16 a[200:201], v10 offset:8328
  v_fma_f32 v92, v60, s30, v24
  v_mfma_f32_16x16x32_bf16 v[52:55], a[168:171], a[104:107], v[52:55]
  ds_read_b64_tr_b16 a[206:207], v10 offset:8384
  ds_read_b64_tr_b16 a[212:213], v10 offset:8392
  v_mfma_f32_16x16x32_bf16 v[52:55], a[172:175], a[108:111], v[52:55]
  v_exp_f32 v31, v93
  v_mfma_f32_16x16x32_bf16 v[56:59], a[176:179], a[96:99], 0
  ds_read_b64_tr_b16 a[218:219], v11 offset:8320
  v_cvt_pk_bf16_f32 v75, v30, v31
  v_mfma_f32_16x16x32_bf16 v[56:59], a[180:183], a[100:103], v[56:59]
  ds_read_b64_tr_b16 a[224:225], v11 offset:8328
  ds_read_b64_tr_b16 a[230:231], v11 offset:8384
  v_mfma_f32_16x16x32_bf16 v[56:59], a[184:187], a[104:107], v[56:59]
  ds_read_b64_tr_b16 a[236:237], v11 offset:8392
  v_fma_f32 v93, v61, s30, v24
  v_mfma_f32_16x16x32_bf16 v[56:59], a[188:191], a[108:111], v[56:59]
  v_exp_f32 v28, v92
  v_mfma_f32_16x16x32_bf16 v[32:35], a[240:243], v[72:75], v[32:35]
  s_add_u32 m0, s24, 0
  v_fma_f32 v92, v62, s30, v24
  s_waitcnt lgkmcnt(4)
  v_mfma_f32_16x16x32_bf16 v[96:99], a[192:195], v[72:75], v[96:99]
  v_exp_f32 v29, v93
  v_mfma_f32_16x16x32_bf16 v[100:103], a[198:201], v[72:75], v[100:103]
  s_xor_b32 s33, s27, 33652736
  v_fma_f32 v93, v63, s30, v24
  v_mfma_f32_16x16x32_bf16 v[104:107], a[204:207], v[72:75], v[104:107]
  buffer_load_dwordx4 v2, s[12:15], s33 offen nt lds
  v_cvt_pk_bf16_f32 v76, v28, v29
  v_mfma_f32_16x16x32_bf16 v[108:111], a[210:213], v[72:75], v[108:111]
  buffer_load_dwordx4 v3, s[12:15], s33 offen offset:1024 nt lds
  s_add_u32 m0, s25, 0
  s_waitcnt lgkmcnt(0)
  v_mfma_f32_16x16x32_bf16 v[112:115], a[216:219], v[72:75], v[112:115]
  v_exp_f32 v30, v92
  v_mfma_f32_16x16x32_bf16 v[116:119], a[222:225], v[72:75], v[116:119]
  buffer_load_dwordx4 v4, s[16:19], s33 offen nt lds
  v_fma_f32 v92, v64, s30, v24
  v_mfma_f32_16x16x32_bf16 v[120:123], a[228:231], v[72:75], v[120:123]
  buffer_load_dwordx4 v5, s[16:19], s33 offen offset:1024 nt lds
  v_exp_f32 v31, v93
  v_mfma_f32_16x16x32_bf16 v[124:127], a[234:237], v[72:75], v[124:127]
  v_fma_f32 v93, v65, s30, v24
  v_cvt_pk_bf16_f32 v77, v30, v31
  s_waitcnt vmcnt(20)
  s_barrier
  v_mfma_f32_16x16x32_bf16 v[60:63], a[160:163], a[112:115], 0
  v_exp_f32 v28, v92
  v_mfma_f32_16x16x32_bf16 v[60:63], a[164:167], a[116:119], v[60:63]
  ds_read_b128 a[160:163], v6 offset:16896
  v_fma_f32 v92, v66, s30, v24
  v_mfma_f32_16x16x32_bf16 v[60:63], a[168:171], a[120:123], v[60:63]
  v_exp_f32 v29, v93
  v_fma_f32 v93, v67, s30, v24
  v_cvt_pk_bf16_f32 v78, v28, v29
  v_mfma_f32_16x16x32_bf16 v[60:63], a[172:175], a[124:127], v[60:63]
  v_exp_f32 v30, v92
  v_mfma_f32_16x16x32_bf16 v[64:67], a[176:179], a[112:115], 0
  v_fma_f32 v92, v52, s30, v25
  v_exp_f32 v31, v93
  v_mfma_f32_16x16x32_bf16 v[64:67], a[180:183], a[116:119], v[64:67]
  v_cvt_pk_bf16_f32 v79, v30, v31
  v_fma_f32 v93, v53, s30, v25
  v_mfma_f32_16x16x32_bf16 v[64:67], a[184:187], a[120:123], v[64:67]
  v_exp_f32 v28, v92
  v_mfma_f32_16x16x32_bf16 v[64:67], a[188:191], a[124:127], v[64:67]
  ds_read_b128 a[164:167], v6 offset:16960
  v_fma_f32 v92, v54, s30, v25
  v_mfma_f32_16x16x32_bf16 v[36:39], a[240:243], v[76:79], v[36:39]
  v_exp_f32 v29, v93
  v_mfma_f32_16x16x32_bf16 v[128:131], a[192:195], v[76:79], v[128:131]
  v_fma_f32 v93, v55, s30, v25
  v_cvt_pk_bf16_f32 v80, v28, v29
  v_mfma_f32_16x16x32_bf16 v[132:135], a[198:201], v[76:79], v[132:135]
  v_exp_f32 v30, v92
  v_mfma_f32_16x16x32_bf16 v[136:139], a[204:207], v[76:79], v[136:139]
  ds_read_b128 a[168:171], v6 offset:17024
  v_fma_f32 v92, v56, s30, v25
  v_mfma_f32_16x16x32_bf16 v[140:143], a[210:213], v[76:79], v[140:143]
  v_exp_f32 v31, v93
  v_fma_f32 v93, v57, s30, v25
  v_mfma_f32_16x16x32_bf16 v[144:147], a[216:219], v[76:79], v[144:147]
  ds_read_b128 a[172:175], v6 offset:17088
  v_cvt_pk_bf16_f32 v81, v30, v31
  v_exp_f32 v28, v92
  v_mfma_f32_16x16x32_bf16 v[148:151], a[222:225], v[76:79], v[148:151]
  ds_read_b128 a[176:179], v7 offset:16896
  v_fma_f32 v92, v58, s30, v25
  v_mfma_f32_16x16x32_bf16 v[152:155], a[228:231], v[76:79], v[152:155]
  v_exp_f32 v29, v93
  v_fma_f32 v93, v59, s30, v25
  v_cvt_pk_bf16_f32 v82, v28, v29
  v_mfma_f32_16x16x32_bf16 v[156:159], a[234:237], v[76:79], v[156:159]
  v_exp_f32 v30, v92
  s_waitcnt lgkmcnt(3)
  v_mfma_f32_16x16x32_bf16 v[68:71], a[160:163], a[144:147], 0
  v_fma_f32 v92, v60, s30, v26
  v_exp_f32 v31, v93
  v_mfma_f32_16x16x32_bf16 v[68:71], a[164:167], a[148:151], v[68:71]
  v_cvt_pk_bf16_f32 v83, v30, v31
  v_fma_f32 v93, v61, s30, v26
  s_waitcnt lgkmcnt(2)
  v_mfma_f32_16x16x32_bf16 v[68:71], a[168:171], a[152:155], v[68:71]
  v_exp_f32 v28, v92
  s_waitcnt lgkmcnt(1)
  v_mfma_f32_16x16x32_bf16 v[68:71], a[172:175], a[156:159], v[68:71]
  ds_read_b128 a[180:183], v7 offset:16960
  v_fma_f32 v92, v62, s30, v26
  v_mfma_f32_16x16x32_bf16 v[40:43], a[240:243], v[80:83], v[40:43]
  v_exp_f32 v29, v93
  v_mfma_f32_16x16x32_bf16 v[160:163], a[192:195], v[80:83], v[160:163]
  v_fma_f32 v93, v63, s30, v26
  v_cvt_pk_bf16_f32 v84, v28, v29
  v_mfma_f32_16x16x32_bf16 v[164:167], a[198:201], v[80:83], v[164:167]
  v_exp_f32 v30, v92
  v_mfma_f32_16x16x32_bf16 v[168:171], a[204:207], v[80:83], v[168:171]
  ds_read_b128 a[184:187], v7 offset:17024
  v_fma_f32 v92, v64, s30, v26
  v_mfma_f32_16x16x32_bf16 v[172:175], a[210:213], v[80:83], v[172:175]
  v_exp_f32 v31, v93
  v_mfma_f32_16x16x32_bf16 v[176:179], a[216:219], v[80:83], v[176:179]
  v_fma_f32 v93, v65, s30, v26
  v_cvt_pk_bf16_f32 v85, v30, v31
  v_mfma_f32_16x16x32_bf16 v[180:183], a[222:225], v[80:83], v[180:183]
  v_exp_f32 v28, v92
  v_mfma_f32_16x16x32_bf16 v[184:187], a[228:231], v[80:83], v[184:187]
  ds_read_b128 a[188:191], v7 offset:17088
  v_fma_f32 v92, v66, s30, v26
  v_mfma_f32_16x16x32_bf16 v[188:191], a[234:237], v[80:83], v[188:191]
  v_exp_f32 v29, v93
  v_mfma_f32_16x16x32_bf16 v[52:55], a[160:163], a[64:67], 0
  v_fma_f32 v93, v67, s30, v26
  v_cvt_pk_bf16_f32 v86, v28, v29
  v_mfma_f32_16x16x32_bf16 v[52:55], a[164:167], a[68:71], v[52:55]
  v_exp_f32 v30, v92
  v_mfma_f32_16x16x32_bf16 v[52:55], a[168:171], a[72:75], v[52:55]
  ds_read_b64_tr_b16 a[196:197], v10 offset:16640
  v_fma_f32 v92, v68, s30, v27
  v_mfma_f32_16x16x32_bf16 v[52:55], a[172:175], a[76:79], v[52:55]
  v_exp_f32 v31, v93
  s_waitcnt lgkmcnt(2)
  v_mfma_f32_16x16x32_bf16 v[56:59], a[176:179], a[64:67], 0
  ds_read_b64_tr_b16 a[202:203], v10 offset:16648
  v_cvt_pk_bf16_f32 v87, v30, v31
  v_mfma_f32_16x16x32_bf16 v[56:59], a[180:183], a[68:71], v[56:59]
  ds_read_b64_tr_b16 a[208:209], v10 offset:16704
  v_fma_f32 v93, v69, s30, v27
  v_mfma_f32_16x16x32_bf16 v[56:59], a[184:187], a[72:75], v[56:59]
  ds_read_b64_tr_b16 a[214:215], v10 offset:16712
  ds_read_b64_tr_b16 a[220:221], v11 offset:16640
  s_waitcnt lgkmcnt(5)
  v_mfma_f32_16x16x32_bf16 v[56:59], a[188:191], a[76:79], v[56:59]
  v_exp_f32 v28, v92
  v_mfma_f32_16x16x32_bf16 v[44:47], a[240:243], v[84:87], v[44:47]
  ds_read_b64_tr_b16 a[226:227], v11 offset:16648
  v_fma_f32 v92, v70, s30, v27
  v_mfma_f32_16x16x32_bf16 v[192:195], a[192:195], v[84:87], v[192:195]
  ds_read_b64_tr_b16 a[232:233], v11 offset:16704
  ds_read_b64_tr_b16 a[238:239], v11 offset:16712
  v_mfma_f32_16x16x32_bf16 v[196:199], a[198:201], v[84:87], v[196:199]
  v_exp_f32 v29, v93
  v_mfma_f32_16x16x32_bf16 v[200:203], a[204:207], v[84:87], v[200:203]
  ds_read_b64_tr_b16 a[194:195], v8 offset:16640
  v_fma_f32 v93, v71, s30, v27
  v_mfma_f32_16x16x32_bf16 v[204:207], a[210:213], v[84:87], v[204:207]
  ds_read_b64_tr_b16 a[200:201], v8 offset:16648
  v_cvt_pk_bf16_f32 v90, v28, v29
  v_mfma_f32_16x16x32_bf16 v[208:211], a[216:219], v[84:87], v[208:211]
  v_exp_f32 v30, v92
  v_mfma_f32_16x16x32_bf16 v[212:215], a[222:225], v[84:87], v[212:215]
  ds_read_b64_tr_b16 a[206:207], v8 offset:16704
  v_fma_f32 v92, v52, s30, v23
  v_mfma_f32_16x16x32_bf16 v[216:219], a[228:231], v[84:87], v[216:219]
  v_exp_f32 v31, v93
  v_mfma_f32_16x16x32_bf16 v[220:223], a[234:237], v[84:87], v[220:223]
  ds_read_b64_tr_b16 a[212:213], v8 offset:16712
  v_cvt_pk_bf16_f32 v91, v30, v31
  v_mfma_f32_16x16x32_bf16 v[60:63], a[160:163], a[80:83], 0
  ds_read_b64_tr_b16 a[218:219], v9 offset:16640
  ds_read_b64_tr_b16 a[224:225], v9 offset:16648
  v_mfma_f32_16x16x32_bf16 v[60:63], a[164:167], a[84:87], v[60:63]
  ds_read_b64_tr_b16 a[230:231], v9 offset:16704
  ds_read_b64_tr_b16 a[236:237], v9 offset:16712
  v_mfma_f32_16x16x32_bf16 v[60:63], a[168:171], a[88:91], v[60:63]
  s_add_u32 m0, s24, 8448
  v_fma_f32 v93, v53, s30, v23
  v_mfma_f32_16x16x32_bf16 v[60:63], a[172:175], a[92:95], v[60:63]
  v_exp_f32 v28, v92
  v_mfma_f32_16x16x32_bf16 v[64:67], a[176:179], a[80:83], 0
  s_xor_b32 s33, s27, 33660928
  v_fma_f32 v92, v54, s30, v23
  v_mfma_f32_16x16x32_bf16 v[64:67], a[180:183], a[84:87], v[64:67]
  v_exp_f32 v29, v93
  v_mfma_f32_16x16x32_bf16 v[64:67], a[184:187], a[88:91], v[64:67]
  v_fma_f32 v93, v55, s30, v23
  v_cvt_pk_bf16_f32 v72, v28, v29
  v_mfma_f32_16x16x32_bf16 v[64:67], a[188:191], a[92:95], v[64:67]
  v_exp_f32 v30, v92
  v_mfma_f32_16x16x32_bf16 v[48:51], a[240:243], v[88:91], v[48:51]
  buffer_load_dwordx4 v2, s[12:15], s33 offen nt lds
  v_fma_f32 v92, v56, s30, v23
  s_waitcnt lgkmcnt(0)
  v_mfma_f32_16x16x32_bf16 v[224:227], a[192:195], v[88:91], v[224:227]
  v_exp_f32 v31, v93
  v_mfma_f32_16x16x32_bf16 v[228:231], a[198:201], v[88:91], v[228:231]
  v_fma_f32 v93, v57, s30, v23
  v_cvt_pk_bf16_f32 v73, v30, v31
  v_mfma_f32_16x16x32_bf16 v[232:235], a[204:207], v[88:91], v[232:235]
  v_exp_f32 v28, v92
  v_mfma_f32_16x16x32_bf16 v[236:239], a[210:213], v[88:91], v[236:239]
  buffer_load_dwordx4 v3, s[12:15], s33 offen offset:1024 nt lds
  v_fma_f32 v92, v58, s30, v23
  v_mfma_f32_16x16x32_bf16 v[240:243], a[216:219], v[88:91], v[240:243]
  v_exp_f32 v29, v93
  v_mfma_f32_16x16x32_bf16 v[244:247], a[222:225], v[88:91], v[244:247]
  v_fma_f32 v93, v59, s30, v23
  v_cvt_pk_bf16_f32 v74, v28, v29
  v_mfma_f32_16x16x32_bf16 v[248:251], a[228:231], v[88:91], v[248:251]
  v_exp_f32 v30, v92
  v_mfma_f32_16x16x32_bf16 v[252:255], a[234:237], v[88:91], v[252:255]
  s_add_u32 m0, s25, 8320
  v_fma_f32 v92, v60, s30, v24
  v_mfma_f32_16x16x32_bf16 v[52:55], a[160:163], a[96:99], 0
  v_exp_f32 v31, v93
  v_mfma_f32_16x16x32_bf16 v[52:55], a[164:167], a[100:103], v[52:55]
  v_cvt_pk_bf16_f32 v75, v30, v31
  v_fma_f32 v93, v61, s30, v24
  v_mfma_f32_16x16x32_bf16 v[52:55], a[168:171], a[104:107], v[52:55]
  v_exp_f32 v28, v92
  v_mfma_f32_16x16x32_bf16 v[52:55], a[172:175], a[108:111], v[52:55]
  buffer_load_dwordx4 v4, s[16:19], s33 offen nt lds
  v_fma_f32 v92, v62, s30, v24
  v_mfma_f32_16x16x32_bf16 v[56:59], a[176:179], a[96:99], 0
  v_exp_f32 v29, v93
  v_mfma_f32_16x16x32_bf16 v[56:59], a[180:183], a[100:103], v[56:59]
  v_fma_f32 v93, v63, s30, v24
  v_cvt_pk_bf16_f32 v76, v28, v29
  v_mfma_f32_16x16x32_bf16 v[56:59], a[184:187], a[104:107], v[56:59]
  v_exp_f32 v30, v92
  v_mfma_f32_16x16x32_bf16 v[56:59], a[188:191], a[108:111], v[56:59]
  buffer_load_dwordx4 v5, s[16:19], s33 offen offset:1024 nt lds
  v_fma_f32 v92, v64, s30, v24
  v_mfma_f32_16x16x32_bf16 v[32:35], a[240:243], v[72:75], v[32:35]
  v_exp_f32 v31, v93
  v_mfma_f32_16x16x32_bf16 v[96:99], a[194:197], v[72:75], v[96:99]
  v_fma_f32 v93, v65, s30, v24
  v_cvt_pk_bf16_f32 v77, v30, v31
  v_mfma_f32_16x16x32_bf16 v[100:103], a[200:203], v[72:75], v[100:103]
  v_exp_f32 v28, v92
  v_mfma_f32_16x16x32_bf16 v[104:107], a[206:209], v[72:75], v[104:107]
  v_fma_f32 v92, v66, s30, v24
  v_exp_f32 v29, v93
  v_mfma_f32_16x16x32_bf16 v[108:111], a[212:215], v[72:75], v[108:111]
  v_fma_f32 v93, v67, s30, v24
  v_cvt_pk_bf16_f32 v78, v28, v29
  v_mfma_f32_16x16x32_bf16 v[112:115], a[218:221], v[72:75], v[112:115]
  v_exp_f32 v30, v92
  v_mfma_f32_16x16x32_bf16 v[116:119], a[224:227], v[72:75], v[116:119]
  v_fma_f32 v92, v52, s30, v25
  v_exp_f32 v31, v93
  v_mfma_f32_16x16x32_bf16 v[120:123], a[230:233], v[72:75], v[120:123]
  v_cvt_pk_bf16_f32 v79, v30, v31
  v_fma_f32 v93, v53, s30, v25
  v_mfma_f32_16x16x32_bf16 v[124:127], a[236:239], v[72:75], v[124:127]
  v_exp_f32 v28, v92
  s_waitcnt vmcnt(20)
  s_barrier
  v_mfma_f32_16x16x32_bf16 v[60:63], a[160:163], a[112:115], 0
  ds_read_b128 a[160:163], v6 offset:25344
  v_fma_f32 v92, v54, s30, v25
  v_mfma_f32_16x16x32_bf16 v[60:63], a[164:167], a[116:119], v[60:63]
  v_exp_f32 v29, v93
  v_mfma_f32_16x16x32_bf16 v[60:63], a[168:171], a[120:123], v[60:63]
  v_fma_f32 v93, v55, s30, v25
  v_cvt_pk_bf16_f32 v80, v28, v29
  v_mfma_f32_16x16x32_bf16 v[60:63], a[172:175], a[124:127], v[60:63]
  v_exp_f32 v30, v92
  v_mfma_f32_16x16x32_bf16 v[64:67], a[176:179], a[112:115], 0
  ds_read_b128 a[164:167], v6 offset:25408
  v_fma_f32 v92, v56, s30, v25
  v_mfma_f32_16x16x32_bf16 v[64:67], a[180:183], a[116:119], v[64:67]
  v_exp_f32 v31, v93
  v_mfma_f32_16x16x32_bf16 v[64:67], a[184:187], a[120:123], v[64:67]
  ds_read_b128 a[168:171], v6 offset:25472
  v_fma_f32 v93, v57, s30, v25
  v_mfma_f32_16x16x32_bf16 v[64:67], a[188:191], a[124:127], v[64:67]
  ds_read_b128 a[172:175], v6 offset:25536
  v_cvt_pk_bf16_f32 v81, v30, v31
  v_mfma_f32_16x16x32_bf16 v[36:39], a[240:243], v[76:79], v[36:39]
  v_exp_f32 v28, v92
  v_mfma_f32_16x16x32_bf16 v[128:131], a[194:197], v[76:79], v[128:131]
  ds_read_b128 a[176:179], v7 offset:25344
  v_fma_f32 v92, v58, s30, v25
  v_mfma_f32_16x16x32_bf16 v[132:135], a[200:203], v[76:79], v[132:135]
  v_exp_f32 v29, v93
  v_mfma_f32_16x16x32_bf16 v[136:139], a[206:209], v[76:79], v[136:139]
  v_fma_f32 v93, v59, s30, v25
  v_cvt_pk_bf16_f32 v82, v28, v29
  v_mfma_f32_16x16x32_bf16 v[140:143], a[212:215], v[76:79], v[140:143]
  v_exp_f32 v30, v92
  v_mfma_f32_16x16x32_bf16 v[144:147], a[218:221], v[76:79], v[144:147]
  ds_read_b128 a[180:183], v7 offset:25408
  v_fma_f32 v92, v60, s30, v26
  v_mfma_f32_16x16x32_bf16 v[148:151], a[224:227], v[76:79], v[148:151]
  v_exp_f32 v31, v93
  v_mfma_f32_16x16x32_bf16 v[152:155], a[230:233], v[76:79], v[152:155]
  v_cvt_pk_bf16_f32 v83, v30, v31
  v_fma_f32 v93, v61, s30, v26
  v_mfma_f32_16x16x32_bf16 v[156:159], a[236:239], v[76:79], v[156:159]
  v_exp_f32 v28, v92
  s_waitcnt lgkmcnt(1)
  v_mfma_f32_16x16x32_bf16 v[68:71], a[160:163], a[144:147], 0
  ds_read_b128 a[184:187], v7 offset:25472
  v_fma_f32 v92, v62, s30, v26
  v_mfma_f32_16x16x32_bf16 v[68:71], a[164:167], a[148:151], v[68:71]
  v_exp_f32 v29, v93
  v_mfma_f32_16x16x32_bf16 v[68:71], a[168:171], a[152:155], v[68:71]
  v_fma_f32 v93, v63, s30, v26
  v_cvt_pk_bf16_f32 v84, v28, v29
  v_mfma_f32_16x16x32_bf16 v[68:71], a[172:175], a[156:159], v[68:71]
  v_exp_f32 v30, v92
  v_mfma_f32_16x16x32_bf16 v[40:43], a[240:243], v[80:83], v[40:43]
  ds_read_b128 a[188:191], v7 offset:25536
  v_fma_f32 v92, v64, s30, v26
  v_mfma_f32_16x16x32_bf16 v[160:163], a[194:197], v[80:83], v[160:163]
  v_exp_f32 v31, v93
  v_mfma_f32_16x16x32_bf16 v[164:167], a[200:203], v[80:83], v[164:167]
  v_fma_f32 v93, v65, s30, v26
  v_cvt_pk_bf16_f32 v85, v30, v31
  v_mfma_f32_16x16x32_bf16 v[168:171], a[206:209], v[80:83], v[168:171]
  v_exp_f32 v28, v92
  v_mfma_f32_16x16x32_bf16 v[172:175], a[212:215], v[80:83], v[172:175]
  ds_read_b64_tr_b16 a[192:193], v8 offset:24960
  v_fma_f32 v92, v66, s30, v26
  v_mfma_f32_16x16x32_bf16 v[176:179], a[218:221], v[80:83], v[176:179]
  v_exp_f32 v29, v93
  v_mfma_f32_16x16x32_bf16 v[180:183], a[224:227], v[80:83], v[180:183]
  v_fma_f32 v93, v67, s30, v26
  v_cvt_pk_bf16_f32 v86, v28, v29
  v_mfma_f32_16x16x32_bf16 v[184:187], a[230:233], v[80:83], v[184:187]
  v_exp_f32 v30, v92
  v_mfma_f32_16x16x32_bf16 v[188:191], a[236:239], v[80:83], v[188:191]
  ds_read_b64_tr_b16 a[198:199], v8 offset:24968
  v_fma_f32 v92, v68, s30, v27
  v_mfma_f32_16x16x32_bf16 v[52:55], a[160:163], a[64:67], 0
  v_exp_f32 v31, v93
  v_mfma_f32_16x16x32_bf16 v[52:55], a[164:167], a[68:71], v[52:55]
  v_cvt_pk_bf16_f32 v87, v30, v31
  v_fma_f32 v93, v69, s30, v27
  v_mfma_f32_16x16x32_bf16 v[52:55], a[168:171], a[72:75], v[52:55]
  v_exp_f32 v28, v92
  v_mfma_f32_16x16x32_bf16 v[52:55], a[172:175], a[76:79], v[52:55]
  ds_read_b64_tr_b16 a[204:205], v8 offset:25024
  v_fma_f32 v92, v70, s30, v27
  v_mfma_f32_16x16x32_bf16 v[56:59], a[176:179], a[64:67], 0
  v_exp_f32 v29, v93
  s_waitcnt lgkmcnt(2)
  v_mfma_f32_16x16x32_bf16 v[56:59], a[180:183], a[68:71], v[56:59]
  v_fma_f32 v93, v71, s30, v27
  v_cvt_pk_bf16_f32 v88, v28, v29
  v_mfma_f32_16x16x32_bf16 v[56:59], a[184:187], a[72:75], v[56:59]
  v_exp_f32 v30, v92
  v_mfma_f32_16x16x32_bf16 v[56:59], a[188:191], a[76:79], v[56:59]
  ds_read_b64_tr_b16 a[210:211], v8 offset:25032
  v_fma_f32 v92, v52, s30, v23
  v_mfma_f32_16x16x32_bf16 v[44:47], a[240:243], v[84:87], v[44:47]
  v_exp_f32 v31, v93
  v_mfma_f32_16x16x32_bf16 v[192:195], a[194:197], v[84:87], v[192:195]
  v_cvt_pk_bf16_f32 v89, v30, v31
  v_fma_f32 v93, v53, s30, v23
  v_mfma_f32_16x16x32_bf16 v[196:199], a[200:203], v[84:87], v[196:199]
  v_exp_f32 v28, v92
  v_mfma_f32_16x16x32_bf16 v[200:203], a[206:209], v[84:87], v[200:203]
  ds_read_b64_tr_b16 a[216:217], v9 offset:24960
  v_fma_f32 v92, v54, s30, v23
  v_mfma_f32_16x16x32_bf16 v[204:207], a[212:215], v[84:87], v[204:207]
  v_exp_f32 v29, v93
  v_mfma_f32_16x16x32_bf16 v[208:211], a[218:221], v[84:87], v[208:211]
  v_fma_f32 v93, v55, s30, v23
  v_cvt_pk_bf16_f32 v72, v28, v29
  v_mfma_f32_16x16x32_bf16 v[212:215], a[224:227], v[84:87], v[212:215]
  v_exp_f32 v30, v92
  v_mfma_f32_16x16x32_bf16 v[216:219], a[230:233], v[84:87], v[216:219]
  ds_read_b64_tr_b16 a[222:223], v9 offset:24968
  v_fma_f32 v92, v56, s30, v23
  v_mfma_f32_16x16x32_bf16 v[220:223], a[236:239], v[84:87], v[220:223]
  v_exp_f32 v31, v93
  v_mfma_f32_16x16x32_bf16 v[60:63], a[160:163], a[80:83], 0
  v_fma_f32 v93, v57, s30, v23
  v_cvt_pk_bf16_f32 v73, v30, v31
  v_mfma_f32_16x16x32_bf16 v[60:63], a[164:167], a[84:87], v[60:63]
  v_exp_f32 v28, v92
  v_mfma_f32_16x16x32_bf16 v[60:63], a[168:171], a[88:91], v[60:63]
  ds_read_b64_tr_b16 a[228:229], v9 offset:25024
  v_fma_f32 v92, v58, s30, v23
  v_mfma_f32_16x16x32_bf16 v[60:63], a[172:175], a[92:95], v[60:63]
  v_exp_f32 v29, v93
  v_mfma_f32_16x16x32_bf16 v[64:67], a[176:179], a[80:83], 0
  ds_read_b64_tr_b16 a[234:235], v9 offset:25032
  v_fma_f32 v93, v59, s30, v23
  v_mfma_f32_16x16x32_bf16 v[64:67], a[180:183], a[84:87], v[64:67]
  ds_read_b64_tr_b16 a[194:195], v10 offset:24960
  v_cvt_pk_bf16_f32 v74, v28, v29
  v_mfma_f32_16x16x32_bf16 v[64:67], a[184:187], a[88:91], v[64:67]
  v_exp_f32 v30, v92
  v_mfma_f32_16x16x32_bf16 v[64:67], a[188:191], a[92:95], v[64:67]
  ds_read_b64_tr_b16 a[200:201], v10 offset:24968
  v_fma_f32 v92, v60, s30, v24
  v_mfma_f32_16x16x32_bf16 v[52:55], a[160:163], a[96:99], 0
  ds_read_b64_tr_b16 a[206:207], v10 offset:25024
  ds_read_b64_tr_b16 a[212:213], v10 offset:25032
  v_mfma_f32_16x16x32_bf16 v[52:55], a[164:167], a[100:103], v[52:55]
  v_exp_f32 v31, v93
  v_mfma_f32_16x16x32_bf16 v[52:55], a[168:171], a[104:107], v[52:55]
  ds_read_b64_tr_b16 a[218:219], v11 offset:24960
  v_cvt_pk_bf16_f32 v75, v30, v31
  v_mfma_f32_16x16x32_bf16 v[52:55], a[172:175], a[108:111], v[52:55]
  ds_read_b64_tr_b16 a[224:225], v11 offset:24968
  ds_read_b64_tr_b16 a[230:231], v11 offset:25024
  v_mfma_f32_16x16x32_bf16 v[56:59], a[176:179], a[96:99], 0
  ds_read_b64_tr_b16 a[236:237], v11 offset:25032
  v_fma_f32 v93, v61, s30, v24
  v_mfma_f32_16x16x32_bf16 v[56:59], a[180:183], a[100:103], v[56:59]
  v_exp_f32 v28, v92
  v_mfma_f32_16x16x32_bf16 v[56:59], a[184:187], a[104:107], v[56:59]
  s_add_u32 m0, s24, 16896
  v_fma_f32 v92, v62, s30, v24
  v_mfma_f32_16x16x32_bf16 v[56:59], a[188:191], a[108:111], v[56:59]
  v_exp_f32 v29, v93
  v_mfma_f32_16x16x32_bf16 v[32:35], a[240:243], v[72:75], v[32:35]
  s_xor_b32 s33, s27, 33669120
  v_fma_f32 v93, v63, s30, v24
  s_waitcnt lgkmcnt(3)
  v_mfma_f32_16x16x32_bf16 v[96:99], a[192:195], v[72:75], v[96:99]
  buffer_load_dwordx4 v2, s[12:15], s33 offen nt lds
  v_cvt_pk_bf16_f32 v76, v28, v29
  v_mfma_f32_16x16x32_bf16 v[100:103], a[198:201], v[72:75], v[100:103]
  buffer_load_dwordx4 v3, s[12:15], s33 offen offset:1024 nt lds
  s_add_u32 m0, s25, 16640
  v_mfma_f32_16x16x32_bf16 v[104:107], a[204:207], v[72:75], v[104:107]
  v_exp_f32 v30, v92
  v_mfma_f32_16x16x32_bf16 v[108:111], a[210:213], v[72:75], v[108:111]
  buffer_load_dwordx4 v4, s[16:19], s33 offen nt lds
  v_fma_f32 v92, v64, s30, v24
  v_mfma_f32_16x16x32_bf16 v[112:115], a[216:219], v[72:75], v[112:115]
  buffer_load_dwordx4 v5, s[16:19], s33 offen offset:1024 nt lds
  v_exp_f32 v31, v93
  s_waitcnt lgkmcnt(0)
  v_mfma_f32_16x16x32_bf16 v[116:119], a[222:225], v[72:75], v[116:119]
  v_fma_f32 v93, v65, s30, v24
  v_cvt_pk_bf16_f32 v77, v30, v31
  v_mfma_f32_16x16x32_bf16 v[120:123], a[228:231], v[72:75], v[120:123]
  v_exp_f32 v28, v92
  v_mfma_f32_16x16x32_bf16 v[124:127], a[234:237], v[72:75], v[124:127]
  v_fma_f32 v92, v66, s30, v24
  v_exp_f32 v29, v93
  s_waitcnt vmcnt(20)
  s_barrier
  v_mfma_f32_16x16x32_bf16 v[60:63], a[160:163], a[112:115], 0
  v_fma_f32 v93, v67, s30, v24
  v_cvt_pk_bf16_f32 v78, v28, v29
  v_mfma_f32_16x16x32_bf16 v[60:63], a[164:167], a[116:119], v[60:63]
  v_exp_f32 v30, v92
  v_mfma_f32_16x16x32_bf16 v[60:63], a[168:171], a[120:123], v[60:63]
  ds_read_b128 a[160:163], v6 offset:33792
  v_fma_f32 v92, v52, s30, v25
  v_mfma_f32_16x16x32_bf16 v[60:63], a[172:175], a[124:127], v[60:63]
  v_exp_f32 v31, v93
  v_mfma_f32_16x16x32_bf16 v[64:67], a[176:179], a[112:115], 0
  v_cvt_pk_bf16_f32 v79, v30, v31
  v_fma_f32 v93, v53, s30, v25
  v_mfma_f32_16x16x32_bf16 v[64:67], a[180:183], a[116:119], v[64:67]
  v_exp_f32 v28, v92
  v_mfma_f32_16x16x32_bf16 v[64:67], a[184:187], a[120:123], v[64:67]
  ds_read_b128 a[164:167], v6 offset:33856
  v_fma_f32 v92, v54, s30, v25
  v_mfma_f32_16x16x32_bf16 v[64:67], a[188:191], a[124:127], v[64:67]
  v_exp_f32 v29, v93
  v_mfma_f32_16x16x32_bf16 v[36:39], a[240:243], v[76:79], v[36:39]
  v_fma_f32 v93, v55, s30, v25
  v_cvt_pk_bf16_f32 v80, v28, v29
  v_mfma_f32_16x16x32_bf16 v[128:131], a[192:195], v[76:79], v[128:131]
  v_exp_f32 v30, v92
  v_mfma_f32_16x16x32_bf16 v[132:135], a[198:201], v[76:79], v[132:135]
  ds_read_b128 a[168:171], v6 offset:33920
  v_fma_f32 v92, v56, s30, v25
  v_mfma_f32_16x16x32_bf16 v[136:139], a[204:207], v[76:79], v[136:139]
  v_exp_f32 v31, v93
  v_mfma_f32_16x16x32_bf16 v[140:143], a[210:213], v[76:79], v[140:143]
  v_fma_f32 v93, v57, s30, v25
  v_cvt_pk_bf16_f32 v81, v30, v31
  v_mfma_f32_16x16x32_bf16 v[144:147], a[216:219], v[76:79], v[144:147]
  ds_read_b128 a[172:175], v6 offset:33984
  v_exp_f32 v28, v92
  v_mfma_f32_16x16x32_bf16 v[148:151], a[222:225], v[76:79], v[148:151]
  ds_read_b128 a[176:179], v7 offset:33792
  v_fma_f32 v92, v58, s30, v25
  v_mfma_f32_16x16x32_bf16 v[152:155], a[228:231], v[76:79], v[152:155]
  v_exp_f32 v29, v93
  v_fma_f32 v93, v59, s30, v25
  v_cvt_pk_bf16_f32 v82, v28, v29
  v_mfma_f32_16x16x32_bf16 v[156:159], a[234:237], v[76:79], v[156:159]
  v_exp_f32 v30, v92
  s_waitcnt lgkmcnt(2)
  v_mfma_f32_16x16x32_bf16 v[68:71], a[160:163], a[144:147], 0
  v_fma_f32 v92, v60, s30, v26
  v_exp_f32 v31, v93
  v_mfma_f32_16x16x32_bf16 v[68:71], a[164:167], a[148:151], v[68:71]
  v_cvt_pk_bf16_f32 v83, v30, v31
  v_fma_f32 v93, v61, s30, v26
  v_mfma_f32_16x16x32_bf16 v[68:71], a[168:171], a[152:155], v[68:71]
  v_exp_f32 v28, v92
  s_waitcnt lgkmcnt(1)
  v_mfma_f32_16x16x32_bf16 v[68:71], a[172:175], a[156:159], v[68:71]
  ds_read_b128 a[180:183], v7 offset:33856
  v_fma_f32 v92, v62, s30, v26
  v_mfma_f32_16x16x32_bf16 v[40:43], a[240:243], v[80:83], v[40:43]
  v_exp_f32 v29, v93
  v_mfma_f32_16x16x32_bf16 v[160:163], a[192:195], v[80:83], v[160:163]
  v_fma_f32 v93, v63, s30, v26
  v_cvt_pk_bf16_f32 v84, v28, v29
  v_mfma_f32_16x16x32_bf16 v[164:167], a[198:201], v[80:83], v[164:167]
  v_exp_f32 v30, v92
  v_mfma_f32_16x16x32_bf16 v[168:171], a[204:207], v[80:83], v[168:171]
  ds_read_b128 a[184:187], v7 offset:33920
  v_fma_f32 v92, v64, s30, v26
  v_mfma_f32_16x16x32_bf16 v[172:175], a[210:213], v[80:83], v[172:175]
  v_exp_f32 v31, v93
  v_mfma_f32_16x16x32_bf16 v[176:179], a[216:219], v[80:83], v[176:179]
  v_fma_f32 v93, v65, s30, v26
  v_cvt_pk_bf16_f32 v85, v30, v31
  v_mfma_f32_16x16x32_bf16 v[180:183], a[222:225], v[80:83], v[180:183]
  v_exp_f32 v28, v92
  v_mfma_f32_16x16x32_bf16 v[184:187], a[228:231], v[80:83], v[184:187]
  ds_read_b128 a[188:191], v7 offset:33984
  v_fma_f32 v92, v66, s30, v26
  v_mfma_f32_16x16x32_bf16 v[188:191], a[234:237], v[80:83], v[188:191]
  v_exp_f32 v29, v93
  v_mfma_f32_16x16x32_bf16 v[52:55], a[160:163], a[64:67], 0
  v_fma_f32 v93, v67, s30, v26
  v_cvt_pk_bf16_f32 v86, v28, v29
  v_mfma_f32_16x16x32_bf16 v[52:55], a[164:167], a[68:71], v[52:55]
  v_exp_f32 v30, v92
  v_mfma_f32_16x16x32_bf16 v[52:55], a[168:171], a[72:75], v[52:55]
  ds_read_b64_tr_b16 a[196:197], v10 offset:33280
  v_fma_f32 v92, v68, s30, v27
  v_mfma_f32_16x16x32_bf16 v[52:55], a[172:175], a[76:79], v[52:55]
  v_exp_f32 v31, v93
  s_waitcnt lgkmcnt(2)
  v_mfma_f32_16x16x32_bf16 v[56:59], a[176:179], a[64:67], 0
  ds_read_b64_tr_b16 a[202:203], v10 offset:33288
  v_cvt_pk_bf16_f32 v87, v30, v31
  v_mfma_f32_16x16x32_bf16 v[56:59], a[180:183], a[68:71], v[56:59]
  ds_read_b64_tr_b16 a[208:209], v10 offset:33344
  v_fma_f32 v93, v69, s30, v27
  v_mfma_f32_16x16x32_bf16 v[56:59], a[184:187], a[72:75], v[56:59]
  ds_read_b64_tr_b16 a[214:215], v10 offset:33352
  ds_read_b64_tr_b16 a[220:221], v11 offset:33280
  s_waitcnt lgkmcnt(5)
  v_mfma_f32_16x16x32_bf16 v[56:59], a[188:191], a[76:79], v[56:59]
  v_exp_f32 v28, v92
  v_mfma_f32_16x16x32_bf16 v[44:47], a[240:243], v[84:87], v[44:47]
  ds_read_b64_tr_b16 a[226:227], v11 offset:33288
  v_fma_f32 v92, v70, s30, v27
  v_mfma_f32_16x16x32_bf16 v[192:195], a[192:195], v[84:87], v[192:195]
  ds_read_b64_tr_b16 a[232:233], v11 offset:33344
  ds_read_b64_tr_b16 a[238:239], v11 offset:33352
  v_mfma_f32_16x16x32_bf16 v[196:199], a[198:201], v[84:87], v[196:199]
  v_exp_f32 v29, v93
  v_mfma_f32_16x16x32_bf16 v[200:203], a[204:207], v[84:87], v[200:203]
  ds_read_b64_tr_b16 a[194:195], v8 offset:33280
  v_fma_f32 v93, v71, s30, v27
  v_mfma_f32_16x16x32_bf16 v[204:207], a[210:213], v[84:87], v[204:207]
  ds_read_b64_tr_b16 a[200:201], v8 offset:33288
  v_cvt_pk_bf16_f32 v90, v28, v29
  v_mfma_f32_16x16x32_bf16 v[208:211], a[216:219], v[84:87], v[208:211]
  v_exp_f32 v30, v92
  v_mfma_f32_16x16x32_bf16 v[212:215], a[222:225], v[84:87], v[212:215]
  ds_read_b64_tr_b16 a[206:207], v8 offset:33344
  v_fma_f32 v92, v52, s30, v23
  v_mfma_f32_16x16x32_bf16 v[216:219], a[228:231], v[84:87], v[216:219]
  v_exp_f32 v31, v93
  v_mfma_f32_16x16x32_bf16 v[220:223], a[234:237], v[84:87], v[220:223]
  ds_read_b64_tr_b16 a[212:213], v8 offset:33352
  v_cvt_pk_bf16_f32 v91, v30, v31
  v_mfma_f32_16x16x32_bf16 v[60:63], a[160:163], a[80:83], 0
  ds_read_b64_tr_b16 a[218:219], v9 offset:33280
  ds_read_b64_tr_b16 a[224:225], v9 offset:33288
  v_mfma_f32_16x16x32_bf16 v[60:63], a[164:167], a[84:87], v[60:63]
  ds_read_b64_tr_b16 a[230:231], v9 offset:33344
  ds_read_b64_tr_b16 a[236:237], v9 offset:33352
  v_mfma_f32_16x16x32_bf16 v[60:63], a[168:171], a[88:91], v[60:63]
  s_add_u32 m0, s24, 25344
  v_fma_f32 v93, v53, s30, v23
  v_mfma_f32_16x16x32_bf16 v[60:63], a[172:175], a[92:95], v[60:63]
  v_exp_f32 v28, v92
  v_mfma_f32_16x16x32_bf16 v[64:67], a[176:179], a[80:83], 0
  s_xor_b32 s33, s27, 33677312
  v_fma_f32 v92, v54, s30, v23
  v_mfma_f32_16x16x32_bf16 v[64:67], a[180:183], a[84:87], v[64:67]
  v_exp_f32 v29, v93
  v_mfma_f32_16x16x32_bf16 v[64:67], a[184:187], a[88:91], v[64:67]
  v_fma_f32 v93, v55, s30, v23
  v_cvt_pk_bf16_f32 v72, v28, v29
  v_mfma_f32_16x16x32_bf16 v[64:67], a[188:191], a[92:95], v[64:67]
  v_exp_f32 v30, v92
  v_mfma_f32_16x16x32_bf16 v[48:51], a[240:243], v[88:91], v[48:51]
  buffer_load_dwordx4 v2, s[12:15], s33 offen nt lds
  v_fma_f32 v92, v56, s30, v23
  s_waitcnt lgkmcnt(0)
  v_mfma_f32_16x16x32_bf16 v[224:227], a[192:195], v[88:91], v[224:227]
  v_exp_f32 v31, v93
  v_mfma_f32_16x16x32_bf16 v[228:231], a[198:201], v[88:91], v[228:231]
  v_fma_f32 v93, v57, s30, v23
  v_cvt_pk_bf16_f32 v73, v30, v31
  v_mfma_f32_16x16x32_bf16 v[232:235], a[204:207], v[88:91], v[232:235]
  v_exp_f32 v28, v92
  v_mfma_f32_16x16x32_bf16 v[236:239], a[210:213], v[88:91], v[236:239]
  buffer_load_dwordx4 v3, s[12:15], s33 offen offset:1024 nt lds
  v_fma_f32 v92, v58, s30, v23
  v_mfma_f32_16x16x32_bf16 v[240:243], a[216:219], v[88:91], v[240:243]
  v_exp_f32 v29, v93
  v_mfma_f32_16x16x32_bf16 v[244:247], a[222:225], v[88:91], v[244:247]
  v_fma_f32 v93, v59, s30, v23
  v_cvt_pk_bf16_f32 v74, v28, v29
  v_mfma_f32_16x16x32_bf16 v[248:251], a[228:231], v[88:91], v[248:251]
  v_exp_f32 v30, v92
  v_mfma_f32_16x16x32_bf16 v[252:255], a[234:237], v[88:91], v[252:255]
  s_add_u32 m0, s25, 24960
  v_fma_f32 v92, v60, s30, v24
  v_mfma_f32_16x16x32_bf16 v[52:55], a[160:163], a[96:99], 0
  v_exp_f32 v31, v93
  v_mfma_f32_16x16x32_bf16 v[52:55], a[164:167], a[100:103], v[52:55]
  v_cvt_pk_bf16_f32 v75, v30, v31
  v_fma_f32 v93, v61, s30, v24
  v_mfma_f32_16x16x32_bf16 v[52:55], a[168:171], a[104:107], v[52:55]
  v_exp_f32 v28, v92
  v_mfma_f32_16x16x32_bf16 v[52:55], a[172:175], a[108:111], v[52:55]
  buffer_load_dwordx4 v4, s[16:19], s33 offen nt lds
  v_fma_f32 v92, v62, s30, v24
  v_mfma_f32_16x16x32_bf16 v[56:59], a[176:179], a[96:99], 0
  v_exp_f32 v29, v93
  v_mfma_f32_16x16x32_bf16 v[56:59], a[180:183], a[100:103], v[56:59]
  v_fma_f32 v93, v63, s30, v24
  v_cvt_pk_bf16_f32 v76, v28, v29
  v_mfma_f32_16x16x32_bf16 v[56:59], a[184:187], a[104:107], v[56:59]
  v_exp_f32 v30, v92
  v_mfma_f32_16x16x32_bf16 v[56:59], a[188:191], a[108:111], v[56:59]
  buffer_load_dwordx4 v5, s[16:19], s33 offen offset:1024 nt lds
  v_fma_f32 v92, v64, s30, v24
  v_mfma_f32_16x16x32_bf16 v[32:35], a[240:243], v[72:75], v[32:35]
  v_exp_f32 v31, v93
  v_mfma_f32_16x16x32_bf16 v[96:99], a[194:197], v[72:75], v[96:99]
  v_fma_f32 v93, v65, s30, v24
  v_cvt_pk_bf16_f32 v77, v30, v31
  v_mfma_f32_16x16x32_bf16 v[100:103], a[200:203], v[72:75], v[100:103]
  v_exp_f32 v28, v92
  v_mfma_f32_16x16x32_bf16 v[104:107], a[206:209], v[72:75], v[104:107]
  v_fma_f32 v92, v66, s30, v24
  v_exp_f32 v29, v93
  v_mfma_f32_16x16x32_bf16 v[108:111], a[212:215], v[72:75], v[108:111]
  v_fma_f32 v93, v67, s30, v24
  v_cvt_pk_bf16_f32 v78, v28, v29
  v_mfma_f32_16x16x32_bf16 v[112:115], a[218:221], v[72:75], v[112:115]
  v_exp_f32 v30, v92
  v_mfma_f32_16x16x32_bf16 v[116:119], a[224:227], v[72:75], v[116:119]
  v_fma_f32 v92, v52, s30, v25
  v_exp_f32 v31, v93
  v_mfma_f32_16x16x32_bf16 v[120:123], a[230:233], v[72:75], v[120:123]
  v_cvt_pk_bf16_f32 v79, v30, v31
  v_fma_f32 v93, v53, s30, v25
  v_mfma_f32_16x16x32_bf16 v[124:127], a[236:239], v[72:75], v[124:127]
  v_exp_f32 v28, v92
  s_waitcnt vmcnt(12)
  s_barrier
  v_mfma_f32_16x16x32_bf16 v[60:63], a[160:163], a[112:115], 0
  ds_read_b128 a[160:163], v6 offset:42240
  v_fma_f32 v92, v54, s30, v25
  v_mfma_f32_16x16x32_bf16 v[60:63], a[164:167], a[116:119], v[60:63]
  v_exp_f32 v29, v93
  v_mfma_f32_16x16x32_bf16 v[60:63], a[168:171], a[120:123], v[60:63]
  v_fma_f32 v93, v55, s30, v25
  v_cvt_pk_bf16_f32 v80, v28, v29
  v_mfma_f32_16x16x32_bf16 v[60:63], a[172:175], a[124:127], v[60:63]
  v_exp_f32 v30, v92
  v_mfma_f32_16x16x32_bf16 v[64:67], a[176:179], a[112:115], 0
  ds_read_b128 a[164:167], v6 offset:42304
  v_fma_f32 v92, v56, s30, v25
  v_mfma_f32_16x16x32_bf16 v[64:67], a[180:183], a[116:119], v[64:67]
  v_exp_f32 v31, v93
  v_mfma_f32_16x16x32_bf16 v[64:67], a[184:187], a[120:123], v[64:67]
  ds_read_b128 a[168:171], v6 offset:42368
  v_fma_f32 v93, v57, s30, v25
  v_mfma_f32_16x16x32_bf16 v[64:67], a[188:191], a[124:127], v[64:67]
  ds_read_b128 a[172:175], v6 offset:42432
  v_cvt_pk_bf16_f32 v81, v30, v31
  v_mfma_f32_16x16x32_bf16 v[36:39], a[240:243], v[76:79], v[36:39]
  v_exp_f32 v28, v92
  v_mfma_f32_16x16x32_bf16 v[128:131], a[194:197], v[76:79], v[128:131]
  ds_read_b128 a[176:179], v7 offset:42240
  v_fma_f32 v92, v58, s30, v25
  v_mfma_f32_16x16x32_bf16 v[132:135], a[200:203], v[76:79], v[132:135]
  v_exp_f32 v29, v93
  v_mfma_f32_16x16x32_bf16 v[136:139], a[206:209], v[76:79], v[136:139]
  v_fma_f32 v93, v59, s30, v25
  v_cvt_pk_bf16_f32 v82, v28, v29
  v_mfma_f32_16x16x32_bf16 v[140:143], a[212:215], v[76:79], v[140:143]
  v_exp_f32 v30, v92
  v_mfma_f32_16x16x32_bf16 v[144:147], a[218:221], v[76:79], v[144:147]
  ds_read_b128 a[180:183], v7 offset:42304
  v_fma_f32 v92, v60, s30, v26
  v_mfma_f32_16x16x32_bf16 v[148:151], a[224:227], v[76:79], v[148:151]
  v_exp_f32 v31, v93
  v_mfma_f32_16x16x32_bf16 v[152:155], a[230:233], v[76:79], v[152:155]
  v_cvt_pk_bf16_f32 v83, v30, v31
  v_fma_f32 v93, v61, s30, v26
  v_mfma_f32_16x16x32_bf16 v[156:159], a[236:239], v[76:79], v[156:159]
  v_exp_f32 v28, v92
  s_waitcnt lgkmcnt(1)
  v_mfma_f32_16x16x32_bf16 v[68:71], a[160:163], a[144:147], 0
  ds_read_b128 a[184:187], v7 offset:42368
  v_fma_f32 v92, v62, s30, v26
  v_mfma_f32_16x16x32_bf16 v[68:71], a[164:167], a[148:151], v[68:71]
  v_exp_f32 v29, v93
  v_mfma_f32_16x16x32_bf16 v[68:71], a[168:171], a[152:155], v[68:71]
  v_fma_f32 v93, v63, s30, v26
  v_cvt_pk_bf16_f32 v84, v28, v29
  v_mfma_f32_16x16x32_bf16 v[68:71], a[172:175], a[156:159], v[68:71]
  v_exp_f32 v30, v92
  v_mfma_f32_16x16x32_bf16 v[40:43], a[240:243], v[80:83], v[40:43]
  ds_read_b128 a[188:191], v7 offset:42432
  v_fma_f32 v92, v64, s30, v26
  v_mfma_f32_16x16x32_bf16 v[160:163], a[194:197], v[80:83], v[160:163]
  v_exp_f32 v31, v93
  v_mfma_f32_16x16x32_bf16 v[164:167], a[200:203], v[80:83], v[164:167]
  v_fma_f32 v93, v65, s30, v26
  v_cvt_pk_bf16_f32 v85, v30, v31
  v_mfma_f32_16x16x32_bf16 v[168:171], a[206:209], v[80:83], v[168:171]
  v_exp_f32 v28, v92
  v_mfma_f32_16x16x32_bf16 v[172:175], a[212:215], v[80:83], v[172:175]
  ds_read_b64_tr_b16 a[192:193], v8 offset:41600
  v_fma_f32 v92, v66, s30, v26
  v_mfma_f32_16x16x32_bf16 v[176:179], a[218:221], v[80:83], v[176:179]
  v_exp_f32 v29, v93
  v_mfma_f32_16x16x32_bf16 v[180:183], a[224:227], v[80:83], v[180:183]
  v_fma_f32 v93, v67, s30, v26
  v_cvt_pk_bf16_f32 v86, v28, v29
  v_mfma_f32_16x16x32_bf16 v[184:187], a[230:233], v[80:83], v[184:187]
  v_exp_f32 v30, v92
  v_mfma_f32_16x16x32_bf16 v[188:191], a[236:239], v[80:83], v[188:191]
  ds_read_b64_tr_b16 a[198:199], v8 offset:41608
  v_fma_f32 v92, v68, s30, v27
  v_mfma_f32_16x16x32_bf16 v[52:55], a[160:163], a[64:67], 0
  v_exp_f32 v31, v93
  v_mfma_f32_16x16x32_bf16 v[52:55], a[164:167], a[68:71], v[52:55]
  v_cvt_pk_bf16_f32 v87, v30, v31
  v_fma_f32 v93, v69, s30, v27
  v_mfma_f32_16x16x32_bf16 v[52:55], a[168:171], a[72:75], v[52:55]
  v_exp_f32 v28, v92
  v_mfma_f32_16x16x32_bf16 v[52:55], a[172:175], a[76:79], v[52:55]
  ds_read_b64_tr_b16 a[204:205], v8 offset:41664
  v_fma_f32 v92, v70, s30, v27
  v_mfma_f32_16x16x32_bf16 v[56:59], a[176:179], a[64:67], 0
  v_exp_f32 v29, v93
  s_waitcnt lgkmcnt(2)
  v_mfma_f32_16x16x32_bf16 v[56:59], a[180:183], a[68:71], v[56:59]
  v_fma_f32 v93, v71, s30, v27
  v_cvt_pk_bf16_f32 v88, v28, v29
  v_mfma_f32_16x16x32_bf16 v[56:59], a[184:187], a[72:75], v[56:59]
  v_exp_f32 v30, v92
  v_mfma_f32_16x16x32_bf16 v[56:59], a[188:191], a[76:79], v[56:59]
  ds_read_b64_tr_b16 a[210:211], v8 offset:41672
  v_fma_f32 v92, v52, s30, v23
  v_mfma_f32_16x16x32_bf16 v[44:47], a[240:243], v[84:87], v[44:47]
  v_exp_f32 v31, v93
  v_mfma_f32_16x16x32_bf16 v[192:195], a[194:197], v[84:87], v[192:195]
  v_cvt_pk_bf16_f32 v89, v30, v31
  v_fma_f32 v93, v53, s30, v23
  v_mfma_f32_16x16x32_bf16 v[196:199], a[200:203], v[84:87], v[196:199]
  v_exp_f32 v28, v92
  v_mfma_f32_16x16x32_bf16 v[200:203], a[206:209], v[84:87], v[200:203]
  ds_read_b64_tr_b16 a[216:217], v9 offset:41600
  v_fma_f32 v92, v54, s30, v23
  v_mfma_f32_16x16x32_bf16 v[204:207], a[212:215], v[84:87], v[204:207]
  v_exp_f32 v29, v93
  v_mfma_f32_16x16x32_bf16 v[208:211], a[218:221], v[84:87], v[208:211]
  v_fma_f32 v93, v55, s30, v23
  v_cvt_pk_bf16_f32 v72, v28, v29
  v_mfma_f32_16x16x32_bf16 v[212:215], a[224:227], v[84:87], v[212:215]
  v_exp_f32 v30, v92
  v_mfma_f32_16x16x32_bf16 v[216:219], a[230:233], v[84:87], v[216:219]
  ds_read_b64_tr_b16 a[222:223], v9 offset:41608
  v_fma_f32 v92, v56, s30, v23
  v_mfma_f32_16x16x32_bf16 v[220:223], a[236:239], v[84:87], v[220:223]
  v_exp_f32 v31, v93
  v_mfma_f32_16x16x32_bf16 v[60:63], a[160:163], a[80:83], 0
  v_fma_f32 v93, v57, s30, v23
  v_cvt_pk_bf16_f32 v73, v30, v31
  v_mfma_f32_16x16x32_bf16 v[60:63], a[164:167], a[84:87], v[60:63]
  v_exp_f32 v28, v92
  v_mfma_f32_16x16x32_bf16 v[60:63], a[168:171], a[88:91], v[60:63]
  ds_read_b64_tr_b16 a[228:229], v9 offset:41664
  v_fma_f32 v92, v58, s30, v23
  v_mfma_f32_16x16x32_bf16 v[60:63], a[172:175], a[92:95], v[60:63]
  v_exp_f32 v29, v93
  v_mfma_f32_16x16x32_bf16 v[64:67], a[176:179], a[80:83], 0
  ds_read_b64_tr_b16 a[234:235], v9 offset:41672
  v_fma_f32 v93, v59, s30, v23
  v_mfma_f32_16x16x32_bf16 v[64:67], a[180:183], a[84:87], v[64:67]
  ds_read_b64_tr_b16 a[194:195], v10 offset:41600
  v_cvt_pk_bf16_f32 v74, v28, v29
  v_mfma_f32_16x16x32_bf16 v[64:67], a[184:187], a[88:91], v[64:67]
  v_exp_f32 v30, v92
  v_mfma_f32_16x16x32_bf16 v[64:67], a[188:191], a[92:95], v[64:67]
  ds_read_b64_tr_b16 a[200:201], v10 offset:41608
  v_fma_f32 v92, v60, s30, v24
  v_mfma_f32_16x16x32_bf16 v[52:55], a[160:163], a[96:99], 0
  ds_read_b64_tr_b16 a[206:207], v10 offset:41664
  ds_read_b64_tr_b16 a[212:213], v10 offset:41672
  v_mfma_f32_16x16x32_bf16 v[52:55], a[164:167], a[100:103], v[52:55]
  v_exp_f32 v31, v93
  v_mfma_f32_16x16x32_bf16 v[52:55], a[168:171], a[104:107], v[52:55]
  ds_read_b64_tr_b16 a[218:219], v11 offset:41600
  v_cvt_pk_bf16_f32 v75, v30, v31
  v_mfma_f32_16x16x32_bf16 v[52:55], a[172:175], a[108:111], v[52:55]
  ds_read_b64_tr_b16 a[224:225], v11 offset:41608
  ds_read_b64_tr_b16 a[230:231], v11 offset:41664
  v_mfma_f32_16x16x32_bf16 v[56:59], a[176:179], a[96:99], 0
  ds_read_b64_tr_b16 a[236:237], v11 offset:41672
  v_fma_f32 v93, v61, s30, v24
  v_mfma_f32_16x16x32_bf16 v[56:59], a[180:183], a[100:103], v[56:59]
  v_exp_f32 v28, v92
  v_mfma_f32_16x16x32_bf16 v[56:59], a[184:187], a[104:107], v[56:59]
  v_fma_f32 v92, v62, s30, v24
  v_exp_f32 v29, v93
  v_mfma_f32_16x16x32_bf16 v[56:59], a[188:191], a[108:111], v[56:59]
  v_fma_f32 v93, v63, s30, v24
  v_cvt_pk_bf16_f32 v76, v28, v29
  v_mfma_f32_16x16x32_bf16 v[32:35], a[240:243], v[72:75], v[32:35]
  v_exp_f32 v30, v92
  s_waitcnt lgkmcnt(3)
  v_mfma_f32_16x16x32_bf16 v[96:99], a[192:195], v[72:75], v[96:99]
  v_fma_f32 v92, v64, s30, v24
  v_exp_f32 v31, v93
  v_mfma_f32_16x16x32_bf16 v[100:103], a[198:201], v[72:75], v[100:103]
  v_fma_f32 v93, v65, s30, v24
  v_cvt_pk_bf16_f32 v77, v30, v31
  v_mfma_f32_16x16x32_bf16 v[104:107], a[204:207], v[72:75], v[104:107]
  v_exp_f32 v28, v92
  v_mfma_f32_16x16x32_bf16 v[108:111], a[210:213], v[72:75], v[108:111]
  v_fma_f32 v92, v66, s30, v24
  v_exp_f32 v29, v93
  v_mfma_f32_16x16x32_bf16 v[112:115], a[216:219], v[72:75], v[112:115]
  v_fma_f32 v93, v67, s30, v24
  v_cvt_pk_bf16_f32 v78, v28, v29
  s_waitcnt lgkmcnt(0)
  v_mfma_f32_16x16x32_bf16 v[116:119], a[222:225], v[72:75], v[116:119]
  v_exp_f32 v30, v92
  v_mfma_f32_16x16x32_bf16 v[120:123], a[228:231], v[72:75], v[120:123]
  v_fma_f32 v92, v52, s30, v25
  v_exp_f32 v31, v93
  v_mfma_f32_16x16x32_bf16 v[124:127], a[234:237], v[72:75], v[124:127]
  v_cvt_pk_bf16_f32 v79, v30, v31
  v_fma_f32 v93, v53, s30, v25
  v_mfma_f32_16x16x32_bf16 v[60:63], a[160:163], a[112:115], 0
  v_exp_f32 v28, v92
  v_mfma_f32_16x16x32_bf16 v[60:63], a[164:167], a[116:119], v[60:63]
  ds_read_b128 a[160:163], v6 offset:50688
  v_fma_f32 v92, v54, s30, v25
  v_mfma_f32_16x16x32_bf16 v[60:63], a[168:171], a[120:123], v[60:63]
  v_exp_f32 v29, v93
  v_mfma_f32_16x16x32_bf16 v[60:63], a[172:175], a[124:127], v[60:63]
  v_fma_f32 v93, v55, s30, v25
  v_cvt_pk_bf16_f32 v80, v28, v29
  v_mfma_f32_16x16x32_bf16 v[64:67], a[176:179], a[112:115], 0
  v_exp_f32 v30, v92
  v_mfma_f32_16x16x32_bf16 v[64:67], a[180:183], a[116:119], v[64:67]
  ds_read_b128 a[164:167], v6 offset:50752
  v_fma_f32 v92, v56, s30, v25
  v_mfma_f32_16x16x32_bf16 v[64:67], a[184:187], a[120:123], v[64:67]
  v_exp_f32 v31, v93
  v_mfma_f32_16x16x32_bf16 v[64:67], a[188:191], a[124:127], v[64:67]
  ds_read_b128 a[168:171], v6 offset:50816
  v_fma_f32 v93, v57, s30, v25
  v_mfma_f32_16x16x32_bf16 v[36:39], a[240:243], v[76:79], v[36:39]
  ds_read_b128 a[172:175], v6 offset:50880
  v_cvt_pk_bf16_f32 v81, v30, v31
  v_mfma_f32_16x16x32_bf16 v[128:131], a[192:195], v[76:79], v[128:131]
  v_exp_f32 v28, v92
  v_mfma_f32_16x16x32_bf16 v[132:135], a[198:201], v[76:79], v[132:135]
  ds_read_b128 a[176:179], v7 offset:50688
  v_fma_f32 v92, v58, s30, v25
  v_mfma_f32_16x16x32_bf16 v[136:139], a[204:207], v[76:79], v[136:139]
  v_exp_f32 v29, v93
  v_mfma_f32_16x16x32_bf16 v[140:143], a[210:213], v[76:79], v[140:143]
  v_fma_f32 v93, v59, s30, v25
  v_cvt_pk_bf16_f32 v82, v28, v29
  v_mfma_f32_16x16x32_bf16 v[144:147], a[216:219], v[76:79], v[144:147]
  v_exp_f32 v30, v92
  v_mfma_f32_16x16x32_bf16 v[148:151], a[222:225], v[76:79], v[148:151]
  ds_read_b128 a[180:183], v7 offset:50752
  v_fma_f32 v92, v60, s30, v26
  v_mfma_f32_16x16x32_bf16 v[152:155], a[228:231], v[76:79], v[152:155]
  v_exp_f32 v31, v93
  v_mfma_f32_16x16x32_bf16 v[156:159], a[234:237], v[76:79], v[156:159]
  v_cvt_pk_bf16_f32 v83, v30, v31
  v_fma_f32 v93, v61, s30, v26
  s_waitcnt lgkmcnt(1)
  v_mfma_f32_16x16x32_bf16 v[68:71], a[160:163], a[144:147], 0
  v_exp_f32 v28, v92
  v_mfma_f32_16x16x32_bf16 v[68:71], a[164:167], a[148:151], v[68:71]
  ds_read_b128 a[184:187], v7 offset:50816
  v_fma_f32 v92, v62, s30, v26
  v_mfma_f32_16x16x32_bf16 v[68:71], a[168:171], a[152:155], v[68:71]
  v_exp_f32 v29, v93
  v_mfma_f32_16x16x32_bf16 v[68:71], a[172:175], a[156:159], v[68:71]
  v_fma_f32 v93, v63, s30, v26
  v_cvt_pk_bf16_f32 v84, v28, v29
  v_mfma_f32_16x16x32_bf16 v[40:43], a[240:243], v[80:83], v[40:43]
  v_exp_f32 v30, v92
  v_mfma_f32_16x16x32_bf16 v[160:163], a[192:195], v[80:83], v[160:163]
  ds_read_b128 a[188:191], v7 offset:50880
  v_fma_f32 v92, v64, s30, v26
  v_mfma_f32_16x16x32_bf16 v[164:167], a[198:201], v[80:83], v[164:167]
  v_exp_f32 v31, v93
  v_mfma_f32_16x16x32_bf16 v[168:171], a[204:207], v[80:83], v[168:171]
  v_fma_f32 v93, v65, s30, v26
  v_cvt_pk_bf16_f32 v85, v30, v31
  v_mfma_f32_16x16x32_bf16 v[172:175], a[210:213], v[80:83], v[172:175]
  v_exp_f32 v28, v92
  v_mfma_f32_16x16x32_bf16 v[176:179], a[216:219], v[80:83], v[176:179]
  ds_read_b64_tr_b16 a[196:197], v10 offset:49920
  v_fma_f32 v92, v66, s30, v26
  v_mfma_f32_16x16x32_bf16 v[180:183], a[222:225], v[80:83], v[180:183]
  v_exp_f32 v29, v93
  v_mfma_f32_16x16x32_bf16 v[184:187], a[228:231], v[80:83], v[184:187]
  v_fma_f32 v93, v67, s30, v26
  v_cvt_pk_bf16_f32 v86, v28, v29
  v_mfma_f32_16x16x32_bf16 v[188:191], a[234:237], v[80:83], v[188:191]
  v_exp_f32 v30, v92
  v_mfma_f32_16x16x32_bf16 v[52:55], a[160:163], a[64:67], 0
  ds_read_b64_tr_b16 a[202:203], v10 offset:49928
  v_fma_f32 v92, v68, s30, v27
  v_mfma_f32_16x16x32_bf16 v[52:55], a[164:167], a[68:71], v[52:55]
  v_exp_f32 v31, v93
  v_mfma_f32_16x16x32_bf16 v[52:55], a[168:171], a[72:75], v[52:55]
  v_cvt_pk_bf16_f32 v87, v30, v31
  v_fma_f32 v93, v69, s30, v27
  v_mfma_f32_16x16x32_bf16 v[52:55], a[172:175], a[76:79], v[52:55]
  ds_read_b64_tr_b16 a[208:209], v10 offset:49984
  ds_read_b64_tr_b16 a[214:215], v10 offset:49992
  v_mfma_f32_16x16x32_bf16 v[56:59], a[176:179], a[64:67], 0
  v_exp_f32 v28, v92
  s_waitcnt lgkmcnt(3)
  v_mfma_f32_16x16x32_bf16 v[56:59], a[180:183], a[68:71], v[56:59]
  ds_read_b64_tr_b16 a[220:221], v11 offset:49920
  v_fma_f32 v92, v70, s30, v27
  v_mfma_f32_16x16x32_bf16 v[56:59], a[184:187], a[72:75], v[56:59]
  ds_read_b64_tr_b16 a[226:227], v11 offset:49928
  ds_read_b64_tr_b16 a[232:233], v11 offset:49984
  v_mfma_f32_16x16x32_bf16 v[56:59], a[188:191], a[76:79], v[56:59]
  v_exp_f32 v29, v93
  v_mfma_f32_16x16x32_bf16 v[44:47], a[240:243], v[84:87], v[44:47]
  ds_read_b64_tr_b16 a[238:239], v11 offset:49992
  v_fma_f32 v93, v71, s30, v27
  v_mfma_f32_16x16x32_bf16 v[192:195], a[192:195], v[84:87], v[192:195]
  ds_read_b64_tr_b16 a[194:195], v8 offset:49920
  v_cvt_pk_bf16_f32 v90, v28, v29
  v_mfma_f32_16x16x32_bf16 v[196:199], a[198:201], v[84:87], v[196:199]
  v_exp_f32 v30, v92
  v_mfma_f32_16x16x32_bf16 v[200:203], a[204:207], v[84:87], v[200:203]
  ds_read_b64_tr_b16 a[200:201], v8 offset:49928
  v_fma_f32 v92, v52, s30, v23
  v_mfma_f32_16x16x32_bf16 v[204:207], a[210:213], v[84:87], v[204:207]
  ds_read_b64_tr_b16 a[206:207], v8 offset:49984
  ds_read_b64_tr_b16 a[212:213], v8 offset:49992
  v_mfma_f32_16x16x32_bf16 v[208:211], a[216:219], v[84:87], v[208:211]
  v_exp_f32 v31, v93
  v_mfma_f32_16x16x32_bf16 v[212:215], a[222:225], v[84:87], v[212:215]
  ds_read_b64_tr_b16 a[218:219], v9 offset:49920
  v_cvt_pk_bf16_f32 v91, v30, v31
  v_mfma_f32_16x16x32_bf16 v[216:219], a[228:231], v[84:87], v[216:219]
  ds_read_b64_tr_b16 a[224:225], v9 offset:49928
  ds_read_b64_tr_b16 a[230:231], v9 offset:49984
  v_mfma_f32_16x16x32_bf16 v[220:223], a[234:237], v[84:87], v[220:223]
  ds_read_b64_tr_b16 a[236:237], v9 offset:49992
  v_fma_f32 v93, v53, s30, v23
  v_mfma_f32_16x16x32_bf16 v[60:63], a[160:163], a[80:83], 0
  v_exp_f32 v28, v92
  v_mfma_f32_16x16x32_bf16 v[60:63], a[164:167], a[84:87], v[60:63]
  v_fma_f32 v92, v54, s30, v23
  v_exp_f32 v29, v93
  v_mfma_f32_16x16x32_bf16 v[60:63], a[168:171], a[88:91], v[60:63]
  v_fma_f32 v93, v55, s30, v23
  v_cvt_pk_bf16_f32 v72, v28, v29
  v_mfma_f32_16x16x32_bf16 v[60:63], a[172:175], a[92:95], v[60:63]
  v_exp_f32 v30, v92
  v_mfma_f32_16x16x32_bf16 v[64:67], a[176:179], a[80:83], 0
  v_fma_f32 v92, v56, s30, v23
  v_exp_f32 v31, v93
  v_mfma_f32_16x16x32_bf16 v[64:67], a[180:183], a[84:87], v[64:67]
  v_fma_f32 v93, v57, s30, v23
  v_cvt_pk_bf16_f32 v73, v30, v31
  v_mfma_f32_16x16x32_bf16 v[64:67], a[184:187], a[88:91], v[64:67]
  v_exp_f32 v28, v92
  v_mfma_f32_16x16x32_bf16 v[64:67], a[188:191], a[92:95], v[64:67]
  v_fma_f32 v92, v58, s30, v23
  v_exp_f32 v29, v93
  v_mfma_f32_16x16x32_bf16 v[48:51], a[240:243], v[88:91], v[48:51]
  v_fma_f32 v93, v59, s30, v23
  v_cvt_pk_bf16_f32 v74, v28, v29
  s_waitcnt lgkmcnt(0)
  v_mfma_f32_16x16x32_bf16 v[224:227], a[192:195], v[88:91], v[224:227]
  v_exp_f32 v30, v92
  v_mfma_f32_16x16x32_bf16 v[228:231], a[198:201], v[88:91], v[228:231]
  v_fma_f32 v92, v60, s30, v24
  v_exp_f32 v31, v93
  v_mfma_f32_16x16x32_bf16 v[232:235], a[204:207], v[88:91], v[232:235]
  v_cvt_pk_bf16_f32 v75, v30, v31
  v_fma_f32 v93, v61, s30, v24
  v_mfma_f32_16x16x32_bf16 v[236:239], a[210:213], v[88:91], v[236:239]
  v_exp_f32 v28, v92
  v_mfma_f32_16x16x32_bf16 v[240:243], a[216:219], v[88:91], v[240:243]
  v_fma_f32 v92, v62, s30, v24
  v_exp_f32 v29, v93
  v_mfma_f32_16x16x32_bf16 v[244:247], a[222:225], v[88:91], v[244:247]
  v_fma_f32 v93, v63, s30, v24
  v_cvt_pk_bf16_f32 v76, v28, v29
  v_mfma_f32_16x16x32_bf16 v[248:251], a[228:231], v[88:91], v[248:251]
  v_exp_f32 v30, v92
  v_mfma_f32_16x16x32_bf16 v[252:255], a[234:237], v[88:91], v[252:255]
  v_fma_f32 v92, v64, s30, v24
  v_exp_f32 v31, v93
  v_mfma_f32_16x16x32_bf16 v[52:55], a[160:163], a[96:99], 0
  v_fma_f32 v93, v65, s30, v24
  v_cvt_pk_bf16_f32 v77, v30, v31
  v_mfma_f32_16x16x32_bf16 v[52:55], a[164:167], a[100:103], v[52:55]
  v_exp_f32 v28, v92
  v_mfma_f32_16x16x32_bf16 v[52:55], a[168:171], a[104:107], v[52:55]
  v_fma_f32 v92, v66, s30, v24
  v_exp_f32 v29, v93
  v_mfma_f32_16x16x32_bf16 v[52:55], a[172:175], a[108:111], v[52:55]
  v_fma_f32 v93, v67, s30, v24
  v_cvt_pk_bf16_f32 v78, v28, v29
  v_mfma_f32_16x16x32_bf16 v[56:59], a[176:179], a[96:99], 0
  v_exp_f32 v30, v92
  v_mfma_f32_16x16x32_bf16 v[56:59], a[180:183], a[100:103], v[56:59]
  v_mfma_f32_16x16x32_bf16 v[56:59], a[184:187], a[104:107], v[56:59]
  s_nop 1
  v_fma_f32 v92, v52, s30, v25
  v_exp_f32 v31, v93
  v_mfma_f32_16x16x32_bf16 v[56:59], a[188:191], a[108:111], v[56:59]
  v_cvt_pk_bf16_f32 v79, v30, v31
  v_fma_f32 v93, v53, s30, v25
  v_mfma_f32_16x16x32_bf16 v[32:35], a[240:243], v[72:75], v[32:35]
  v_exp_f32 v28, v92
  v_mfma_f32_16x16x32_bf16 v[96:99], a[194:197], v[72:75], v[96:99]
  v_fma_f32 v92, v54, s30, v25
  v_exp_f32 v29, v93
  v_mfma_f32_16x16x32_bf16 v[100:103], a[200:203], v[72:75], v[100:103]
  v_fma_f32 v93, v55, s30, v25
  v_cvt_pk_bf16_f32 v80, v28, v29
  v_mfma_f32_16x16x32_bf16 v[104:107], a[206:209], v[72:75], v[104:107]
  v_exp_f32 v30, v92
  v_mfma_f32_16x16x32_bf16 v[108:111], a[212:215], v[72:75], v[108:111]
  v_fma_f32 v92, v56, s30, v25
  v_exp_f32 v31, v93
  v_mfma_f32_16x16x32_bf16 v[112:115], a[218:221], v[72:75], v[112:115]
  v_fma_f32 v93, v57, s30, v25
  v_cvt_pk_bf16_f32 v81, v30, v31
  v_mfma_f32_16x16x32_bf16 v[116:119], a[224:227], v[72:75], v[116:119]
  v_exp_f32 v28, v92
  v_mfma_f32_16x16x32_bf16 v[120:123], a[230:233], v[72:75], v[120:123]
  v_fma_f32 v92, v58, s30, v25
  v_exp_f32 v29, v93
  v_mfma_f32_16x16x32_bf16 v[124:127], a[236:239], v[72:75], v[124:127]
  v_fma_f32 v93, v59, s30, v25
  v_cvt_pk_bf16_f32 v82, v28, v29
  v_mfma_f32_16x16x32_bf16 v[60:63], a[160:163], a[112:115], 0
  ds_read_b128 a[160:163], v6 offset:0
  ds_read_b64_tr_b16 a[192:193], v8 offset:0
  v_mfma_f32_16x16x32_bf16 v[60:63], a[164:167], a[116:119], v[60:63]
  ds_read_b128 a[164:167], v6 offset:64
  ds_read_b64_tr_b16 a[198:199], v8 offset:8
  v_mfma_f32_16x16x32_bf16 v[60:63], a[168:171], a[120:123], v[60:63]
  ds_read_b128 a[168:171], v6 offset:128
  ds_read_b64_tr_b16 a[204:205], v8 offset:64
  v_mfma_f32_16x16x32_bf16 v[60:63], a[172:175], a[124:127], v[60:63]
  s_add_u32 s35, s28, 0
  buffer_store_dwordx4 a[0:3], v17, s[20:23], s35 offen offset:0 nt
  v_mfma_f32_16x16x32_bf16 v[64:67], a[176:179], a[112:115], 0
  ds_read_b128 a[172:175], v6 offset:192
  ds_read_b128 a[176:179], v7 offset:0
  v_mfma_f32_16x16x32_bf16 v[64:67], a[180:183], a[116:119], v[64:67]
  v_exp_f32 v30, v92
  v_mfma_f32_16x16x32_bf16 v[64:67], a[184:187], a[120:123], v[64:67]
  ds_read_b128 a[180:183], v7 offset:64
  v_fma_f32 v92, v60, s30, v26
  v_mfma_f32_16x16x32_bf16 v[64:67], a[188:191], a[124:127], v[64:67]
  v_exp_f32 v31, v93
  v_mfma_f32_16x16x32_bf16 v[36:39], a[240:243], v[76:79], v[36:39]
  v_cvt_pk_bf16_f32 v83, v30, v31
  v_fma_f32 v93, v61, s30, v26
  v_mfma_f32_16x16x32_bf16 v[128:131], a[194:197], v[76:79], v[128:131]
  v_exp_f32 v28, v92
  v_mfma_f32_16x16x32_bf16 v[132:135], a[200:203], v[76:79], v[132:135]
  ds_read_b128 a[184:187], v7 offset:128
  v_fma_f32 v92, v62, s30, v26
  v_mfma_f32_16x16x32_bf16 v[136:139], a[206:209], v[76:79], v[136:139]
  v_exp_f32 v29, v93
  v_mfma_f32_16x16x32_bf16 v[140:143], a[212:215], v[76:79], v[140:143]
  v_fma_f32 v93, v63, s30, v26
  v_cvt_pk_bf16_f32 v84, v28, v29
  v_mfma_f32_16x16x32_bf16 v[144:147], a[218:221], v[76:79], v[144:147]
  buffer_store_dwordx4 a[4:7], v17, s[20:23], s35 offen offset:1024 nt
  ds_read_b128 a[188:191], v7 offset:192
  v_mfma_f32_16x16x32_bf16 v[148:151], a[224:227], v[76:79], v[148:151]
  v_exp_f32 v30, v92
  v_mfma_f32_16x16x32_bf16 v[152:155], a[230:233], v[76:79], v[152:155]
  ds_read_b64_tr_b16 a[210:211], v8 offset:72
  v_fma_f32 v92, v64, s30, v26
  v_mfma_f32_16x16x32_bf16 v[156:159], a[236:239], v[76:79], v[156:159]
  v_exp_f32 v31, v93
  s_waitcnt lgkmcnt(2)
  v_mfma_f32_16x16x32_bf16 v[68:71], a[160:163], a[144:147], 0
  v_fma_f32 v93, v65, s30, v26
  v_cvt_pk_bf16_f32 v85, v30, v31
  v_mfma_f32_16x16x32_bf16 v[68:71], a[164:167], a[148:151], v[68:71]
  v_exp_f32 v28, v92
  v_mfma_f32_16x16x32_bf16 v[68:71], a[168:171], a[152:155], v[68:71]
  ds_read_b64_tr_b16 a[216:217], v9 offset:0
  v_fma_f32 v92, v66, s30, v26
  v_mfma_f32_16x16x32_bf16 v[68:71], a[172:175], a[156:159], v[68:71]
  v_exp_f32 v29, v93
  v_mfma_f32_16x16x32_bf16 v[40:43], a[240:243], v[80:83], v[40:43]
  v_fma_f32 v93, v67, s30, v26
  v_cvt_pk_bf16_f32 v86, v28, v29
  v_mfma_f32_16x16x32_bf16 v[160:163], a[194:197], v[80:83], v[160:163]
  v_exp_f32 v30, v92
  v_mfma_f32_16x16x32_bf16 v[164:167], a[200:203], v[80:83], v[164:167]
  ds_read_b64_tr_b16 a[222:223], v9 offset:8
  v_fma_f32 v92, v68, s30, v27
  v_mfma_f32_16x16x32_bf16 v[168:171], a[206:209], v[80:83], v[168:171]
  v_exp_f32 v31, v93
  v_mfma_f32_16x16x32_bf16 v[172:175], a[212:215], v[80:83], v[172:175]
  v_cvt_pk_bf16_f32 v87, v30, v31
  v_fma_f32 v93, v69, s30, v27
  v_mfma_f32_16x16x32_bf16 v[176:179], a[218:221], v[80:83], v[176:179]
  v_exp_f32 v28, v92
  v_mfma_f32_16x16x32_bf16 v[180:183], a[224:227], v[80:83], v[180:183]
  buffer_store_dwordx4 a[8:11], v17, s[20:23], s35 offen offset:2048 nt
  v_fma_f32 v92, v70, s30, v27
  v_mfma_f32_16x16x32_bf16 v[184:187], a[230:233], v[80:83], v[184:187]
  v_exp_f32 v29, v93
  v_mfma_f32_16x16x32_bf16 v[188:191], a[236:239], v[80:83], v[188:191]
  v_fma_f32 v93, v71, s30, v27
  v_cvt_pk_bf16_f32 v88, v28, v29
  v_mfma_f32_16x16x32_bf16 v[52:55], a[160:163], a[64:67], 0
  v_exp_f32 v30, v92
  v_mfma_f32_16x16x32_bf16 v[52:55], a[164:167], a[68:71], v[52:55]
  ds_read_b64_tr_b16 a[228:229], v9 offset:64
  ds_read_b64_tr_b16 a[234:235], v9 offset:72
  v_mfma_f32_16x16x32_bf16 v[52:55], a[168:171], a[72:75], v[52:55]
  v_mfma_f32_16x16x32_bf16 v[52:55], a[172:175], a[76:79], v[52:55]
  v_mfma_f32_16x16x32_bf16 v[56:59], a[176:179], a[64:67], 0
  v_mfma_f32_16x16x32_bf16 v[56:59], a[180:183], a[68:71], v[56:59]
  v_mfma_f32_16x16x32_bf16 v[56:59], a[184:187], a[72:75], v[56:59]
  s_nop 4
  v_fma_f32 v92, v52, s30, v23
  v_exp_f32 v31, v93
  s_waitcnt lgkmcnt(2)
  v_mfma_f32_16x16x32_bf16 v[56:59], a[188:191], a[76:79], v[56:59]
  v_cvt_pk_bf16_f32 v89, v30, v31
  v_fma_f32 v93, v53, s30, v23
  v_mfma_f32_16x16x32_bf16 v[44:47], a[240:243], v[84:87], v[44:47]
  v_exp_f32 v28, v92
  v_mfma_f32_16x16x32_bf16 v[192:195], a[194:197], v[84:87], v[192:195]
  ds_read_b64_tr_b16 a[194:195], v10 offset:0
  v_fma_f32 v92, v54, s30, v23
  v_mfma_f32_16x16x32_bf16 v[196:199], a[200:203], v[84:87], v[196:199]
  v_exp_f32 v29, v93
  v_mfma_f32_16x16x32_bf16 v[200:203], a[206:209], v[84:87], v[200:203]
  v_fma_f32 v93, v55, s30, v23
  v_cvt_pk_bf16_f32 v72, v28, v29
  v_mfma_f32_16x16x32_bf16 v[204:207], a[212:215], v[84:87], v[204:207]
  v_exp_f32 v30, v92
  v_mfma_f32_16x16x32_bf16 v[208:211], a[218:221], v[84:87], v[208:211]
  buffer_store_dwordx4 a[12:15], v17, s[20:23], s35 offen offset:3072 nt
  v_fma_f32 v92, v56, s30, v23
  v_mfma_f32_16x16x32_bf16 v[212:215], a[224:227], v[84:87], v[212:215]
  v_exp_f32 v31, v93
  v_mfma_f32_16x16x32_bf16 v[216:219], a[230:233], v[84:87], v[216:219]
  v_fma_f32 v93, v57, s30, v23
  v_cvt_pk_bf16_f32 v73, v30, v31
  v_mfma_f32_16x16x32_bf16 v[220:223], a[236:239], v[84:87], v[220:223]
  v_exp_f32 v28, v92
  v_mfma_f32_16x16x32_bf16 v[60:63], a[160:163], a[80:83], 0
  ds_read_b64_tr_b16 a[200:201], v10 offset:8
  v_fma_f32 v92, v58, s30, v23
  v_mfma_f32_16x16x32_bf16 v[60:63], a[164:167], a[84:87], v[60:63]
  v_exp_f32 v29, v93
  v_mfma_f32_16x16x32_bf16 v[60:63], a[168:171], a[88:91], v[60:63]
  v_fma_f32 v93, v59, s30, v23
  v_cvt_pk_bf16_f32 v74, v28, v29
  v_mfma_f32_16x16x32_bf16 v[60:63], a[172:175], a[92:95], v[60:63]
  v_exp_f32 v30, v92
  v_mfma_f32_16x16x32_bf16 v[64:67], a[176:179], a[80:83], 0
  ds_read_b64_tr_b16 a[206:207], v10 offset:64
  ds_read_b64_tr_b16 a[212:213], v10 offset:72
  v_mfma_f32_16x16x32_bf16 v[64:67], a[180:183], a[84:87], v[64:67]
  ds_read_b64_tr_b16 a[218:219], v11 offset:0
  ds_read_b64_tr_b16 a[224:225], v11 offset:8
  v_mfma_f32_16x16x32_bf16 v[64:67], a[184:187], a[88:91], v[64:67]
  ds_read_b64_tr_b16 a[230:231], v11 offset:64
  v_fma_f32 v92, v60, s30, v24
  v_mfma_f32_16x16x32_bf16 v[64:67], a[188:191], a[92:95], v[64:67]
  v_exp_f32 v31, v93
  v_mfma_f32_16x16x32_bf16 v[52:55], a[160:163], a[96:99], 0
  ds_read_b64_tr_b16 a[236:237], v11 offset:72
  v_cvt_pk_bf16_f32 v75, v30, v31
  v_mfma_f32_16x16x32_bf16 v[52:55], a[164:167], a[100:103], v[52:55]
  s_add_u32 s35, s28, 4096
  buffer_store_dwordx4 a[16:19], v17, s[20:23], s35 offen offset:0 nt
  v_fma_f32 v93, v61, s30, v24
  v_mfma_f32_16x16x32_bf16 v[52:55], a[168:171], a[104:107], v[52:55]
  v_exp_f32 v28, v92
  v_mfma_f32_16x16x32_bf16 v[52:55], a[172:175], a[108:111], v[52:55]
  v_fma_f32 v92, v62, s30, v24
  v_exp_f32 v29, v93
  v_mfma_f32_16x16x32_bf16 v[56:59], a[176:179], a[96:99], 0
  v_fma_f32 v93, v63, s30, v24
  v_cvt_pk_bf16_f32 v76, v28, v29
  v_mfma_f32_16x16x32_bf16 v[56:59], a[180:183], a[100:103], v[56:59]
  v_exp_f32 v30, v92
  v_mfma_f32_16x16x32_bf16 v[56:59], a[184:187], a[104:107], v[56:59]
  v_fma_f32 v92, v64, s30, v24
  v_exp_f32 v31, v93
  v_mfma_f32_16x16x32_bf16 v[56:59], a[188:191], a[108:111], v[56:59]
  v_fma_f32 v93, v65, s30, v24
  v_cvt_pk_bf16_f32 v77, v30, v31
  v_mfma_f32_16x16x32_bf16 v[32:35], a[240:243], v[72:75], v[32:35]
  v_exp_f32 v28, v92
  s_waitcnt lgkmcnt(0)
  v_mfma_f32_16x16x32_bf16 v[96:99], a[192:195], v[72:75], v[96:99]
  v_fma_f32 v92, v66, s30, v24
  v_exp_f32 v29, v93
  v_mfma_f32_16x16x32_bf16 v[100:103], a[198:201], v[72:75], v[100:103]
  v_fma_f32 v93, v67, s30, v24
  v_cvt_pk_bf16_f32 v78, v28, v29
  v_mfma_f32_16x16x32_bf16 v[104:107], a[204:207], v[72:75], v[104:107]
  v_exp_f32 v30, v92
  v_mfma_f32_16x16x32_bf16 v[108:111], a[210:213], v[72:75], v[108:111]
  v_fma_f32 v92, v52, s30, v25
  v_exp_f32 v31, v93
  v_mfma_f32_16x16x32_bf16 v[112:115], a[216:219], v[72:75], v[112:115]
  v_cvt_pk_bf16_f32 v79, v30, v31
  v_fma_f32 v93, v53, s30, v25
  v_mfma_f32_16x16x32_bf16 v[116:119], a[222:225], v[72:75], v[116:119]
  v_exp_f32 v28, v92
  v_mfma_f32_16x16x32_bf16 v[120:123], a[228:231], v[72:75], v[120:123]
  buffer_store_dwordx4 a[20:23], v17, s[20:23], s35 offen offset:1024 nt
  v_fma_f32 v92, v54, s30, v25
  v_mfma_f32_16x16x32_bf16 v[124:127], a[234:237], v[72:75], v[124:127]
  v_exp_f32 v29, v93
  s_waitcnt vmcnt(6)
  s_barrier
  v_mfma_f32_16x16x32_bf16 v[60:63], a[160:163], a[112:115], 0
  v_fma_f32 v93, v55, s30, v25
  v_cvt_pk_bf16_f32 v80, v28, v29
  v_mfma_f32_16x16x32_bf16 v[60:63], a[164:167], a[116:119], v[60:63]
  ds_read_b128 a[160:163], v6 offset:8448
  ds_read_b128 a[164:167], v6 offset:8512
  v_mfma_f32_16x16x32_bf16 v[60:63], a[168:171], a[120:123], v[60:63]
  v_exp_f32 v30, v92
  v_mfma_f32_16x16x32_bf16 v[60:63], a[172:175], a[124:127], v[60:63]
  ds_read_b128 a[168:171], v6 offset:8576
  v_fma_f32 v92, v56, s30, v25
  v_mfma_f32_16x16x32_bf16 v[64:67], a[176:179], a[112:115], 0
  v_exp_f32 v31, v93
  v_mfma_f32_16x16x32_bf16 v[64:67], a[180:183], a[116:119], v[64:67]
  v_fma_f32 v93, v57, s30, v25
  v_cvt_pk_bf16_f32 v81, v30, v31
  v_mfma_f32_16x16x32_bf16 v[64:67], a[184:187], a[120:123], v[64:67]
  v_exp_f32 v28, v92
  v_mfma_f32_16x16x32_bf16 v[64:67], a[188:191], a[124:127], v[64:67]
  ds_read_b128 a[172:175], v6 offset:8640
  v_fma_f32 v92, v58, s30, v25
  v_mfma_f32_16x16x32_bf16 v[36:39], a[240:243], v[76:79], v[36:39]
  v_exp_f32 v29, v93
  v_mfma_f32_16x16x32_bf16 v[128:131], a[192:195], v[76:79], v[128:131]
  v_fma_f32 v93, v59, s30, v25
  v_cvt_pk_bf16_f32 v82, v28, v29
  v_mfma_f32_16x16x32_bf16 v[132:135], a[198:201], v[76:79], v[132:135]
  v_exp_f32 v30, v92
  v_mfma_f32_16x16x32_bf16 v[136:139], a[204:207], v[76:79], v[136:139]
  buffer_store_dwordx4 a[24:27], v17, s[20:23], s35 offen offset:2048 nt
  v_fma_f32 v92, v60, s30, v26
  v_mfma_f32_16x16x32_bf16 v[140:143], a[210:213], v[76:79], v[140:143]
  v_exp_f32 v31, v93
  v_mfma_f32_16x16x32_bf16 v[144:147], a[216:219], v[76:79], v[144:147]
  v_cvt_pk_bf16_f32 v83, v30, v31
  v_fma_f32 v93, v61, s30, v26
  v_mfma_f32_16x16x32_bf16 v[148:151], a[222:225], v[76:79], v[148:151]
  v_exp_f32 v28, v92
  v_mfma_f32_16x16x32_bf16 v[152:155], a[228:231], v[76:79], v[152:155]
  ds_read_b128 a[176:179], v7 offset:8448
  v_fma_f32 v92, v62, s30, v26
  v_mfma_f32_16x16x32_bf16 v[156:159], a[234:237], v[76:79], v[156:159]
  v_exp_f32 v29, v93
  s_waitcnt lgkmcnt(1)
  v_mfma_f32_16x16x32_bf16 v[68:71], a[160:163], a[144:147], 0
  v_fma_f32 v93, v63, s30, v26
  v_cvt_pk_bf16_f32 v84, v28, v29
  v_mfma_f32_16x16x32_bf16 v[68:71], a[164:167], a[148:151], v[68:71]
  v_exp_f32 v30, v92
  v_mfma_f32_16x16x32_bf16 v[68:71], a[168:171], a[152:155], v[68:71]
  ds_read_b128 a[180:183], v7 offset:8512
  v_fma_f32 v92, v64, s30, v26
  v_mfma_f32_16x16x32_bf16 v[68:71], a[172:175], a[156:159], v[68:71]
  v_exp_f32 v31, v93
  v_mfma_f32_16x16x32_bf16 v[40:43], a[240:243], v[80:83], v[40:43]
  ds_read_b128 a[184:187], v7 offset:8576
  v_fma_f32 v93, v65, s30, v26
  v_mfma_f32_16x16x32_bf16 v[160:163], a[192:195], v[80:83], v[160:163]
  ds_read_b128 a[188:191], v7 offset:8640
  v_cvt_pk_bf16_f32 v85, v30, v31
  v_mfma_f32_16x16x32_bf16 v[164:167], a[198:201], v[80:83], v[164:167]
  v_exp_f32 v28, v92
  v_mfma_f32_16x16x32_bf16 v[168:171], a[204:207], v[80:83], v[168:171]
  ds_read_b64_tr_b16 a[196:197], v10 offset:8320
  v_fma_f32 v92, v66, s30, v26
  v_mfma_f32_16x16x32_bf16 v[172:175], a[210:213], v[80:83], v[172:175]
  v_exp_f32 v29, v93
  v_mfma_f32_16x16x32_bf16 v[176:179], a[216:219], v[80:83], v[176:179]
  v_fma_f32 v93, v67, s30, v26
  v_cvt_pk_bf16_f32 v86, v28, v29
  v_mfma_f32_16x16x32_bf16 v[180:183], a[222:225], v[80:83], v[180:183]
  v_exp_f32 v30, v92
  v_mfma_f32_16x16x32_bf16 v[184:187], a[228:231], v[80:83], v[184:187]
  buffer_store_dwordx4 a[28:31], v17, s[20:23], s35 offen offset:3072 nt
  v_fma_f32 v92, v68, s30, v27
  v_mfma_f32_16x16x32_bf16 v[188:191], a[234:237], v[80:83], v[188:191]
  v_exp_f32 v31, v93
  v_mfma_f32_16x16x32_bf16 v[52:55], a[160:163], a[64:67], 0
  v_cvt_pk_bf16_f32 v87, v30, v31
  v_fma_f32 v93, v69, s30, v27
  v_mfma_f32_16x16x32_bf16 v[52:55], a[164:167], a[68:71], v[52:55]
  ds_read_b64_tr_b16 a[202:203], v10 offset:8328
  ds_read_b64_tr_b16 a[208:209], v10 offset:8384
  v_mfma_f32_16x16x32_bf16 v[52:55], a[168:171], a[72:75], v[52:55]
  v_exp_f32 v28, v92
  v_mfma_f32_16x16x32_bf16 v[52:55], a[172:175], a[76:79], v[52:55]
  ds_read_b64_tr_b16 a[214:215], v10 offset:8392
  v_fma_f32 v92, v70, s30, v27
  s_waitcnt lgkmcnt(3)
  v_mfma_f32_16x16x32_bf16 v[56:59], a[176:179], a[64:67], 0
  ds_read_b64_tr_b16 a[220:221], v11 offset:8320
  ds_read_b64_tr_b16 a[226:227], v11 offset:8328
  v_mfma_f32_16x16x32_bf16 v[56:59], a[180:183], a[68:71], v[56:59]
  v_exp_f32 v29, v93
  v_mfma_f32_16x16x32_bf16 v[56:59], a[184:187], a[72:75], v[56:59]
  ds_read_b64_tr_b16 a[232:233], v11 offset:8384
  v_fma_f32 v93, v71, s30, v27
  v_mfma_f32_16x16x32_bf16 v[56:59], a[188:191], a[76:79], v[56:59]
  ds_read_b64_tr_b16 a[238:239], v11 offset:8392
  v_cvt_pk_bf16_f32 v90, v28, v29
  v_mfma_f32_16x16x32_bf16 v[44:47], a[240:243], v[84:87], v[44:47]
  v_exp_f32 v30, v92
  v_mfma_f32_16x16x32_bf16 v[192:195], a[192:195], v[84:87], v[192:195]
  ds_read_b64_tr_b16 a[194:195], v8 offset:8320
  v_fma_f32 v92, v52, s30, v23
  v_mfma_f32_16x16x32_bf16 v[196:199], a[198:201], v[84:87], v[196:199]
  ds_read_b64_tr_b16 a[200:201], v8 offset:8328
  v_exp_f32 v31, v93
  v_mfma_f32_16x16x32_bf16 v[200:203], a[204:207], v[84:87], v[200:203]
  ds_read_b64_tr_b16 a[206:207], v8 offset:8384
  v_cvt_pk_bf16_f32 v91, v30, v31
  v_mfma_f32_16x16x32_bf16 v[204:207], a[210:213], v[84:87], v[204:207]
  ds_read_b64_tr_b16 a[212:213], v8 offset:8392
  v_fma_f32 v93, v53, s30, v23
  v_mfma_f32_16x16x32_bf16 v[208:211], a[216:219], v[84:87], v[208:211]
  ds_read_b64_tr_b16 a[218:219], v9 offset:8320
  s_add_u32 s35, s28, 8192
  buffer_store_dwordx4 a[32:35], v17, s[20:23], s35 offen offset:0 nt
  v_mfma_f32_16x16x32_bf16 v[212:215], a[222:225], v[84:87], v[212:215]
  ds_read_b64_tr_b16 a[224:225], v9 offset:8328
  v_exp_f32 v28, v92
  v_mfma_f32_16x16x32_bf16 v[216:219], a[228:231], v[84:87], v[216:219]
  ds_read_b64_tr_b16 a[230:231], v9 offset:8384
  v_fma_f32 v92, v54, s30, v23
  v_mfma_f32_16x16x32_bf16 v[220:223], a[234:237], v[84:87], v[220:223]
  ds_read_b64_tr_b16 a[236:237], v9 offset:8392
  v_exp_f32 v29, v93
  v_mfma_f32_16x16x32_bf16 v[60:63], a[160:163], a[80:83], 0
  v_fma_f32 v93, v55, s30, v23
  v_cvt_pk_bf16_f32 v72, v28, v29
  v_mfma_f32_16x16x32_bf16 v[60:63], a[164:167], a[84:87], v[60:63]
  v_exp_f32 v30, v92
  v_mfma_f32_16x16x32_bf16 v[60:63], a[168:171], a[88:91], v[60:63]
  v_fma_f32 v92, v56, s30, v23
  v_exp_f32 v31, v93
  v_mfma_f32_16x16x32_bf16 v[60:63], a[172:175], a[92:95], v[60:63]
  v_fma_f32 v93, v57, s30, v23
  v_cvt_pk_bf16_f32 v73, v30, v31
  v_mfma_f32_16x16x32_bf16 v[64:67], a[176:179], a[80:83], 0
  v_exp_f32 v28, v92
  v_mfma_f32_16x16x32_bf16 v[64:67], a[180:183], a[84:87], v[64:67]
  v_fma_f32 v92, v58, s30, v23
  v_exp_f32 v29, v93
  v_mfma_f32_16x16x32_bf16 v[64:67], a[184:187], a[88:91], v[64:67]
  v_fma_f32 v93, v59, s30, v23
  v_cvt_pk_bf16_f32 v74, v28, v29
  v_mfma_f32_16x16x32_bf16 v[64:67], a[188:191], a[92:95], v[64:67]
  v_exp_f32 v30, v92
  v_mfma_f32_16x16x32_bf16 v[48:51], a[240:243], v[88:91], v[48:51]
  v_fma_f32 v92, v60, s30, v24
  v_exp_f32 v31, v93
  s_waitcnt lgkmcnt(0)
  v_mfma_f32_16x16x32_bf16 v[224:227], a[192:195], v[88:91], v[224:227]
  v_cvt_pk_bf16_f32 v75, v30, v31
  v_fma_f32 v93, v61, s30, v24
  v_mfma_f32_16x16x32_bf16 v[228:231], a[198:201], v[88:91], v[228:231]
  buffer_store_dwordx4 a[36:39], v17, s[20:23], s35 offen offset:1024 nt
  v_exp_f32 v28, v92
  v_mfma_f32_16x16x32_bf16 v[232:235], a[204:207], v[88:91], v[232:235]
  v_fma_f32 v92, v62, s30, v24
  v_exp_f32 v29, v93
  v_mfma_f32_16x16x32_bf16 v[236:239], a[210:213], v[88:91], v[236:239]
  v_fma_f32 v93, v63, s30, v24
  v_cvt_pk_bf16_f32 v76, v28, v29
  v_mfma_f32_16x16x32_bf16 v[240:243], a[216:219], v[88:91], v[240:243]
  v_exp_f32 v30, v92
  v_mfma_f32_16x16x32_bf16 v[244:247], a[222:225], v[88:91], v[244:247]
  v_fma_f32 v92, v64, s30, v24
  v_exp_f32 v31, v93
  v_mfma_f32_16x16x32_bf16 v[248:251], a[228:231], v[88:91], v[248:251]
  v_fma_f32 v93, v65, s30, v24
  v_cvt_pk_bf16_f32 v77, v30, v31
  v_mfma_f32_16x16x32_bf16 v[252:255], a[234:237], v[88:91], v[252:255]
  v_exp_f32 v28, v92
  v_mfma_f32_16x16x32_bf16 v[52:55], a[160:163], a[96:99], 0
  v_fma_f32 v92, v66, s30, v24
  v_exp_f32 v29, v93
  v_mfma_f32_16x16x32_bf16 v[52:55], a[164:167], a[100:103], v[52:55]
  v_fma_f32 v93, v67, s30, v24
  v_cvt_pk_bf16_f32 v78, v28, v29
  v_mfma_f32_16x16x32_bf16 v[52:55], a[168:171], a[104:107], v[52:55]
  v_exp_f32 v30, v92
  v_mfma_f32_16x16x32_bf16 v[52:55], a[172:175], a[108:111], v[52:55]
  v_mfma_f32_16x16x32_bf16 v[56:59], a[176:179], a[96:99], 0
  v_mfma_f32_16x16x32_bf16 v[56:59], a[180:183], a[100:103], v[56:59]
  v_mfma_f32_16x16x32_bf16 v[56:59], a[184:187], a[104:107], v[56:59]
  s_nop 4
  v_fma_f32 v92, v52, s30, v25
  v_exp_f32 v31, v93
  v_mfma_f32_16x16x32_bf16 v[56:59], a[188:191], a[108:111], v[56:59]
  v_cvt_pk_bf16_f32 v79, v30, v31
  v_fma_f32 v93, v53, s30, v25
  v_mfma_f32_16x16x32_bf16 v[32:35], a[240:243], v[72:75], v[32:35]
  buffer_store_dwordx4 a[40:43], v17, s[20:23], s35 offen offset:2048 nt
  v_exp_f32 v28, v92
  v_mfma_f32_16x16x32_bf16 v[96:99], a[194:197], v[72:75], v[96:99]
  v_fma_f32 v92, v54, s30, v25
  v_exp_f32 v29, v93
  v_mfma_f32_16x16x32_bf16 v[100:103], a[200:203], v[72:75], v[100:103]
  v_fma_f32 v93, v55, s30, v25
  v_cvt_pk_bf16_f32 v80, v28, v29
  v_mfma_f32_16x16x32_bf16 v[104:107], a[206:209], v[72:75], v[104:107]
  v_exp_f32 v30, v92
  v_mfma_f32_16x16x32_bf16 v[108:111], a[212:215], v[72:75], v[108:111]
  v_fma_f32 v92, v56, s30, v25
  v_exp_f32 v31, v93
  v_mfma_f32_16x16x32_bf16 v[112:115], a[218:221], v[72:75], v[112:115]
  v_fma_f32 v93, v57, s30, v25
  v_cvt_pk_bf16_f32 v81, v30, v31
  v_mfma_f32_16x16x32_bf16 v[116:119], a[224:227], v[72:75], v[116:119]
  v_exp_f32 v28, v92
  v_mfma_f32_16x16x32_bf16 v[120:123], a[230:233], v[72:75], v[120:123]
  v_fma_f32 v92, v58, s30, v25
  v_exp_f32 v29, v93
  v_mfma_f32_16x16x32_bf16 v[124:127], a[236:239], v[72:75], v[124:127]
  v_fma_f32 v93, v59, s30, v25
  v_cvt_pk_bf16_f32 v82, v28, v29
  v_mfma_f32_16x16x32_bf16 v[60:63], a[160:163], a[112:115], 0
  ds_read_b128 a[160:163], v6 offset:16896
  ds_read_b64_tr_b16 a[192:193], v8 offset:16640
  v_mfma_f32_16x16x32_bf16 v[60:63], a[164:167], a[116:119], v[60:63]
  ds_read_b128 a[164:167], v6 offset:16960
  ds_read_b64_tr_b16 a[198:199], v8 offset:16648
  v_mfma_f32_16x16x32_bf16 v[60:63], a[168:171], a[120:123], v[60:63]
  ds_read_b128 a[168:171], v6 offset:17024
  ds_read_b64_tr_b16 a[204:205], v8 offset:16704
  v_mfma_f32_16x16x32_bf16 v[60:63], a[172:175], a[124:127], v[60:63]
  ds_read_b128 a[172:175], v6 offset:17088
  ds_read_b64_tr_b16 a[210:211], v8 offset:16712
  v_mfma_f32_16x16x32_bf16 v[64:67], a[176:179], a[112:115], 0
  v_exp_f32 v30, v92
  v_mfma_f32_16x16x32_bf16 v[64:67], a[180:183], a[116:119], v[64:67]
  ds_read_b128 a[176:179], v7 offset:16896
  ds_read_b128 a[180:183], v7 offset:16960
  v_mfma_f32_16x16x32_bf16 v[64:67], a[184:187], a[120:123], v[64:67]
  buffer_store_dwordx4 a[44:47], v17, s[20:23], s35 offen offset:3072 nt
  v_fma_f32 v92, v60, s30, v26
  v_mfma_f32_16x16x32_bf16 v[64:67], a[188:191], a[124:127], v[64:67]
  v_exp_f32 v31, v93
  v_mfma_f32_16x16x32_bf16 v[36:39], a[240:243], v[76:79], v[36:39]
  v_cvt_pk_bf16_f32 v83, v30, v31
  v_fma_f32 v93, v61, s30, v26
  v_mfma_f32_16x16x32_bf16 v[128:131], a[194:197], v[76:79], v[128:131]
  v_exp_f32 v28, v92
  v_mfma_f32_16x16x32_bf16 v[132:135], a[200:203], v[76:79], v[132:135]
  ds_read_b128 a[184:187], v7 offset:17024
  v_fma_f32 v92, v62, s30, v26
  v_mfma_f32_16x16x32_bf16 v[136:139], a[206:209], v[76:79], v[136:139]
  v_exp_f32 v29, v93
  v_mfma_f32_16x16x32_bf16 v[140:143], a[212:215], v[76:79], v[140:143]
  v_fma_f32 v93, v63, s30, v26
  v_cvt_pk_bf16_f32 v84, v28, v29
  v_mfma_f32_16x16x32_bf16 v[144:147], a[218:221], v[76:79], v[144:147]
  v_exp_f32 v30, v92
  v_mfma_f32_16x16x32_bf16 v[148:151], a[224:227], v[76:79], v[148:151]
  ds_read_b128 a[188:191], v7 offset:17088
  v_fma_f32 v92, v64, s30, v26
  v_mfma_f32_16x16x32_bf16 v[152:155], a[230:233], v[76:79], v[152:155]
  v_exp_f32 v31, v93
  v_mfma_f32_16x16x32_bf16 v[156:159], a[236:239], v[76:79], v[156:159]
  v_fma_f32 v93, v65, s30, v26
  v_cvt_pk_bf16_f32 v85, v30, v31
  s_waitcnt lgkmcnt(1)
  v_mfma_f32_16x16x32_bf16 v[68:71], a[160:163], a[144:147], 0
  v_exp_f32 v28, v92
  v_mfma_f32_16x16x32_bf16 v[68:71], a[164:167], a[148:151], v[68:71]
  ds_read_b64_tr_b16 a[216:217], v9 offset:16640
  v_fma_f32 v92, v66, s30, v26
  v_mfma_f32_16x16x32_bf16 v[68:71], a[168:171], a[152:155], v[68:71]
  v_exp_f32 v29, v93
  v_mfma_f32_16x16x32_bf16 v[68:71], a[172:175], a[156:159], v[68:71]
  v_fma_f32 v93, v67, s30, v26
  v_cvt_pk_bf16_f32 v86, v28, v29
  v_mfma_f32_16x16x32_bf16 v[40:43], a[240:243], v[80:83], v[40:43]
  s_add_u32 s35, s28, 12288
  buffer_store_dwordx4 a[48:51], v17, s[20:23], s35 offen offset:0 nt
  v_mfma_f32_16x16x32_bf16 v[160:163], a[194:197], v[80:83], v[160:163]
  v_exp_f32 v30, v92
  v_mfma_f32_16x16x32_bf16 v[164:167], a[200:203], v[80:83], v[164:167]
  ds_read_b64_tr_b16 a[222:223], v9 offset:16648
  v_fma_f32 v92, v68, s30, v27
  v_mfma_f32_16x16x32_bf16 v[168:171], a[206:209], v[80:83], v[168:171]
  v_exp_f32 v31, v93
  v_mfma_f32_16x16x32_bf16 v[172:175], a[212:215], v[80:83], v[172:175]
  v_cvt_pk_bf16_f32 v87, v30, v31
  v_fma_f32 v93, v69, s30, v27
  v_mfma_f32_16x16x32_bf16 v[176:179], a[218:221], v[80:83], v[176:179]
  v_exp_f32 v28, v92
  v_mfma_f32_16x16x32_bf16 v[180:183], a[224:227], v[80:83], v[180:183]
  ds_read_b64_tr_b16 a[228:229], v9 offset:16704
  v_fma_f32 v92, v70, s30, v27
  v_mfma_f32_16x16x32_bf16 v[184:187], a[230:233], v[80:83], v[184:187]
  v_exp_f32 v29, v93
  v_mfma_f32_16x16x32_bf16 v[188:191], a[236:239], v[80:83], v[188:191]
  v_fma_f32 v93, v71, s30, v27
  v_cvt_pk_bf16_f32 v88, v28, v29
  v_mfma_f32_16x16x32_bf16 v[52:55], a[160:163], a[64:67], 0
  v_exp_f32 v30, v92
  v_mfma_f32_16x16x32_bf16 v[52:55], a[164:167], a[68:71], v[52:55]
  ds_read_b64_tr_b16 a[234:235], v9 offset:16712
  v_mfma_f32_16x16x32_bf16 v[52:55], a[168:171], a[72:75], v[52:55]
  v_mfma_f32_16x16x32_bf16 v[52:55], a[172:175], a[76:79], v[52:55]
  buffer_store_dwordx4 a[52:55], v17, s[20:23], s35 offen offset:1024 nt
  v_mfma_f32_16x16x32_bf16 v[56:59], a[176:179], a[64:67], 0
  v_mfma_f32_16x16x32_bf16 v[56:59], a[180:183], a[68:71], v[56:59]
  v_mfma_f32_16x16x32_bf16 v[56:59], a[184:187], a[72:75], v[56:59]
  s_nop 3
  v_fma_f32 v92, v52, s30, v23
  v_exp_f32 v31, v93
  s_waitcnt lgkmcnt(1)
  v_mfma_f32_16x16x32_bf16 v[56:59], a[188:191], a[76:79], v[56:59]
  v_cvt_pk_bf16_f32 v89, v30, v31
  v_fma_f32 v93, v53, s30, v23
  v_mfma_f32_16x16x32_bf16 v[44:47], a[240:243], v[84:87], v[44:47]
  v_exp_f32 v28, v92
  v_mfma_f32_16x16x32_bf16 v[192:195], a[194:197], v[84:87], v[192:195]
  ds_read_b64_tr_b16 a[194:195], v10 offset:16640
  v_fma_f32 v92, v54, s30, v23
  v_mfma_f32_16x16x32_bf16 v[196:199], a[200:203], v[84:87], v[196:199]
  v_exp_f32 v29, v93
  v_mfma_f32_16x16x32_bf16 v[200:203], a[206:209], v[84:87], v[200:203]
  v_fma_f32 v93, v55, s30, v23
  v_cvt_pk_bf16_f32 v72, v28, v29
  v_mfma_f32_16x16x32_bf16 v[204:207], a[212:215], v[84:87], v[204:207]
  v_exp_f32 v30, v92
  v_mfma_f32_16x16x32_bf16 v[208:211], a[218:221], v[84:87], v[208:211]
  ds_read_b64_tr_b16 a[200:201], v10 offset:16648
  v_fma_f32 v92, v56, s30, v23
  v_mfma_f32_16x16x32_bf16 v[212:215], a[224:227], v[84:87], v[212:215]
  v_exp_f32 v31, v93
  v_mfma_f32_16x16x32_bf16 v[216:219], a[230:233], v[84:87], v[216:219]
  v_fma_f32 v93, v57, s30, v23
  v_cvt_pk_bf16_f32 v73, v30, v31
  v_mfma_f32_16x16x32_bf16 v[220:223], a[236:239], v[84:87], v[220:223]
  v_exp_f32 v28, v92
  v_mfma_f32_16x16x32_bf16 v[60:63], a[160:163], a[80:83], 0
  ds_read_b64_tr_b16 a[206:207], v10 offset:16704
  v_fma_f32 v92, v58, s30, v23
  v_mfma_f32_16x16x32_bf16 v[60:63], a[164:167], a[84:87], v[60:63]
  v_exp_f32 v29, v93
  v_mfma_f32_16x16x32_bf16 v[60:63], a[168:171], a[88:91], v[60:63]
  v_fma_f32 v93, v59, s30, v23
  v_cvt_pk_bf16_f32 v74, v28, v29
  v_mfma_f32_16x16x32_bf16 v[60:63], a[172:175], a[92:95], v[60:63]
  v_exp_f32 v30, v92
  v_mfma_f32_16x16x32_bf16 v[64:67], a[176:179], a[80:83], 0
  buffer_store_dwordx4 a[56:59], v17, s[20:23], s35 offen offset:2048 nt
  ds_read_b64_tr_b16 a[212:213], v10 offset:16712
  v_mfma_f32_16x16x32_bf16 v[64:67], a[180:183], a[84:87], v[64:67]
  ds_read_b64_tr_b16 a[218:219], v11 offset:16640
  ds_read_b64_tr_b16 a[224:225], v11 offset:16648
  v_mfma_f32_16x16x32_bf16 v[64:67], a[184:187], a[88:91], v[64:67]
  ds_read_b64_tr_b16 a[230:231], v11 offset:16704
  v_fma_f32 v92, v60, s30, v24
  v_mfma_f32_16x16x32_bf16 v[64:67], a[188:191], a[92:95], v[64:67]
  v_exp_f32 v31, v93
  v_mfma_f32_16x16x32_bf16 v[52:55], a[160:163], a[96:99], 0
  ds_read_b64_tr_b16 a[236:237], v11 offset:16712
  v_cvt_pk_bf16_f32 v75, v30, v31
  v_mfma_f32_16x16x32_bf16 v[52:55], a[164:167], a[100:103], v[52:55]
  v_fma_f32 v93, v61, s30, v24
  v_exp_f32 v28, v92
  v_mfma_f32_16x16x32_bf16 v[52:55], a[168:171], a[104:107], v[52:55]
  v_fma_f32 v92, v62, s30, v24
  v_exp_f32 v29, v93
  v_mfma_f32_16x16x32_bf16 v[52:55], a[172:175], a[108:111], v[52:55]
  v_fma_f32 v93, v63, s30, v24
  v_cvt_pk_bf16_f32 v76, v28, v29
  v_mfma_f32_16x16x32_bf16 v[56:59], a[176:179], a[96:99], 0
  v_exp_f32 v30, v92
  v_mfma_f32_16x16x32_bf16 v[56:59], a[180:183], a[100:103], v[56:59]
  v_fma_f32 v92, v64, s30, v24
  v_exp_f32 v31, v93
  v_mfma_f32_16x16x32_bf16 v[56:59], a[184:187], a[104:107], v[56:59]
  v_fma_f32 v93, v65, s30, v24
  v_cvt_pk_bf16_f32 v77, v30, v31
  v_mfma_f32_16x16x32_bf16 v[56:59], a[188:191], a[108:111], v[56:59]
  v_exp_f32 v28, v92
  v_mfma_f32_16x16x32_bf16 v[32:35], a[240:243], v[72:75], v[32:35]
  buffer_store_dwordx4 a[60:63], v17, s[20:23], s35 offen offset:3072 nt
  v_fma_f32 v92, v66, s30, v24
  s_waitcnt lgkmcnt(0)
  v_mfma_f32_16x16x32_bf16 v[96:99], a[192:195], v[72:75], v[96:99]
  v_exp_f32 v29, v93
  v_mfma_f32_16x16x32_bf16 v[100:103], a[198:201], v[72:75], v[100:103]
  v_fma_f32 v93, v67, s30, v24
  v_cvt_pk_bf16_f32 v78, v28, v29
  v_mfma_f32_16x16x32_bf16 v[104:107], a[204:207], v[72:75], v[104:107]
  v_exp_f32 v30, v92
  v_mfma_f32_16x16x32_bf16 v[108:111], a[210:213], v[72:75], v[108:111]
  v_fma_f32 v92, v52, s30, v25
  v_exp_f32 v31, v93
  v_mfma_f32_16x16x32_bf16 v[112:115], a[216:219], v[72:75], v[112:115]
  v_cvt_pk_bf16_f32 v79, v30, v31
  v_fma_f32 v93, v53, s30, v25
  v_mfma_f32_16x16x32_bf16 v[116:119], a[222:225], v[72:75], v[116:119]
  v_exp_f32 v28, v92
  v_mfma_f32_16x16x32_bf16 v[120:123], a[228:231], v[72:75], v[120:123]
  v_fma_f32 v92, v54, s30, v25
  v_exp_f32 v29, v93
  v_mfma_f32_16x16x32_bf16 v[124:127], a[234:237], v[72:75], v[124:127]
  v_fma_f32 v93, v55, s30, v25
  v_cvt_pk_bf16_f32 v80, v28, v29
  v_mfma_f32_16x16x32_bf16 v[60:63], a[160:163], a[112:115], 0
  ds_read_b128 a[160:163], v6 offset:25344
  ds_read_b64_tr_b16 a[196:197], v10 offset:24960
  v_mfma_f32_16x16x32_bf16 v[60:63], a[164:167], a[116:119], v[60:63]
  v_exp_f32 v30, v92
  v_mfma_f32_16x16x32_bf16 v[60:63], a[168:171], a[120:123], v[60:63]
  ds_read_b128 a[164:167], v6 offset:25408
  v_fma_f32 v92, v56, s30, v25
  v_mfma_f32_16x16x32_bf16 v[60:63], a[172:175], a[124:127], v[60:63]
  v_exp_f32 v31, v93
  v_mfma_f32_16x16x32_bf16 v[64:67], a[176:179], a[112:115], 0
  ds_read_b128 a[168:171], v6 offset:25472
  v_fma_f32 v93, v57, s30, v25
  v_mfma_f32_16x16x32_bf16 v[64:67], a[180:183], a[116:119], v[64:67]
  ds_read_b128 a[172:175], v6 offset:25536
  v_cvt_pk_bf16_f32 v81, v30, v31
  v_mfma_f32_16x16x32_bf16 v[64:67], a[184:187], a[120:123], v[64:67]
  v_exp_f32 v28, v92
  v_mfma_f32_16x16x32_bf16 v[64:67], a[188:191], a[124:127], v[64:67]
  ds_read_b128 a[176:179], v7 offset:25344
  v_fma_f32 v92, v58, s30, v25
  v_mfma_f32_16x16x32_bf16 v[36:39], a[240:243], v[76:79], v[36:39]
  v_exp_f32 v29, v93
  v_mfma_f32_16x16x32_bf16 v[128:131], a[192:195], v[76:79], v[128:131]
  v_fma_f32 v93, v59, s30, v25
  v_cvt_pk_bf16_f32 v82, v28, v29
  v_mfma_f32_16x16x32_bf16 v[132:135], a[198:201], v[76:79], v[132:135]
  s_add_u32 s35, s29, 0
  buffer_store_dwordx4 a[128:131], v13, s[20:23], s35 offen offset:0 nt
  v_mfma_f32_16x16x32_bf16 v[136:139], a[204:207], v[76:79], v[136:139]
  v_exp_f32 v30, v92
  v_mfma_f32_16x16x32_bf16 v[140:143], a[210:213], v[76:79], v[140:143]
  ds_read_b128 a[180:183], v7 offset:25408
  v_fma_f32 v92, v60, s30, v26
  v_mfma_f32_16x16x32_bf16 v[144:147], a[216:219], v[76:79], v[144:147]
  v_exp_f32 v31, v93
  v_mfma_f32_16x16x32_bf16 v[148:151], a[222:225], v[76:79], v[148:151]
  v_cvt_pk_bf16_f32 v83, v30, v31
  v_fma_f32 v93, v61, s30, v26
  v_mfma_f32_16x16x32_bf16 v[152:155], a[228:231], v[76:79], v[152:155]
  v_exp_f32 v28, v92
  v_mfma_f32_16x16x32_bf16 v[156:159], a[234:237], v[76:79], v[156:159]
  ds_read_b128 a[184:187], v7 offset:25472
  v_fma_f32 v92, v62, s30, v26
  s_waitcnt lgkmcnt(2)
  v_mfma_f32_16x16x32_bf16 v[68:71], a[160:163], a[144:147], 0
  v_exp_f32 v29, v93
  v_mfma_f32_16x16x32_bf16 v[68:71], a[164:167], a[148:151], v[68:71]
  v_fma_f32 v93, v63, s30, v26
  v_cvt_pk_bf16_f32 v84, v28, v29
  v_mfma_f32_16x16x32_bf16 v[68:71], a[168:171], a[152:155], v[68:71]
  v_exp_f32 v30, v92
  v_mfma_f32_16x16x32_bf16 v[68:71], a[172:175], a[156:159], v[68:71]
  ds_read_b128 a[188:191], v7 offset:25536
  v_fma_f32 v92, v64, s30, v26
  v_mfma_f32_16x16x32_bf16 v[40:43], a[240:243], v[80:83], v[40:43]
  v_exp_f32 v31, v93
  v_mfma_f32_16x16x32_bf16 v[160:163], a[192:195], v[80:83], v[160:163]
  v_fma_f32 v93, v65, s30, v26
  v_cvt_pk_bf16_f32 v85, v30, v31
  v_mfma_f32_16x16x32_bf16 v[164:167], a[198:201], v[80:83], v[164:167]
  v_exp_f32 v28, v92
  v_mfma_f32_16x16x32_bf16 v[168:171], a[204:207], v[80:83], v[168:171]
  buffer_store_dwordx4 a[132:135], v13, s[20:23], s35 offen offset:2048 nt
  v_fma_f32 v92, v66, s30, v26
  v_mfma_f32_16x16x32_bf16 v[172:175], a[210:213], v[80:83], v[172:175]
  v_exp_f32 v29, v93
  v_mfma_f32_16x16x32_bf16 v[176:179], a[216:219], v[80:83], v[176:179]
  v_fma_f32 v93, v67, s30, v26
  v_cvt_pk_bf16_f32 v86, v28, v29
  v_mfma_f32_16x16x32_bf16 v[180:183], a[222:225], v[80:83], v[180:183]
  v_exp_f32 v30, v92
  v_mfma_f32_16x16x32_bf16 v[184:187], a[228:231], v[80:83], v[184:187]
  ds_read_b64_tr_b16 a[202:203], v10 offset:24968
  v_fma_f32 v92, v68, s30, v27
  v_mfma_f32_16x16x32_bf16 v[188:191], a[234:237], v[80:83], v[188:191]
  v_exp_f32 v31, v93
  v_mfma_f32_16x16x32_bf16 v[52:55], a[160:163], a[64:67], 0
  v_cvt_pk_bf16_f32 v87, v30, v31
  v_fma_f32 v93, v69, s30, v27
  v_mfma_f32_16x16x32_bf16 v[52:55], a[164:167], a[68:71], v[52:55]
  ds_read_b64_tr_b16 a[208:209], v10 offset:25024
  ds_read_b64_tr_b16 a[214:215], v10 offset:25032
  v_mfma_f32_16x16x32_bf16 v[52:55], a[168:171], a[72:75], v[52:55]
  v_exp_f32 v28, v92
  v_mfma_f32_16x16x32_bf16 v[52:55], a[172:175], a[76:79], v[52:55]
  ds_read_b64_tr_b16 a[220:221], v11 offset:24960
  v_fma_f32 v92, v70, s30, v27
  v_mfma_f32_16x16x32_bf16 v[56:59], a[176:179], a[64:67], 0
  ds_read_b64_tr_b16 a[226:227], v11 offset:24968
  ds_read_b64_tr_b16 a[232:233], v11 offset:25024
  s_waitcnt lgkmcnt(5)
  v_mfma_f32_16x16x32_bf16 v[56:59], a[180:183], a[68:71], v[56:59]
  v_exp_f32 v29, v93
  v_mfma_f32_16x16x32_bf16 v[56:59], a[184:187], a[72:75], v[56:59]
  ds_read_b64_tr_b16 a[238:239], v11 offset:25032
  v_fma_f32 v93, v71, s30, v27
  v_mfma_f32_16x16x32_bf16 v[56:59], a[188:191], a[76:79], v[56:59]
  v_cvt_pk_bf16_f32 v90, v28, v29
  v_exp_f32 v30, v92
  v_mfma_f32_16x16x32_bf16 v[44:47], a[240:243], v[84:87], v[44:47]
  v_fma_f32 v92, v52, s30, v23
  v_exp_f32 v31, v93
  v_mfma_f32_16x16x32_bf16 v[192:195], a[192:195], v[84:87], v[192:195]
  ds_read_b64_tr_b16 a[194:195], v8 offset:24960
  v_cvt_pk_bf16_f32 v91, v30, v31
  v_mfma_f32_16x16x32_bf16 v[196:199], a[198:201], v[84:87], v[196:199]
  ds_read_b64_tr_b16 a[200:201], v8 offset:24968
  v_fma_f32 v93, v53, s30, v23
  v_mfma_f32_16x16x32_bf16 v[200:203], a[204:207], v[84:87], v[200:203]
  ds_read_b64_tr_b16 a[206:207], v8 offset:25024
  v_exp_f32 v28, v92
  v_mfma_f32_16x16x32_bf16 v[204:207], a[210:213], v[84:87], v[204:207]
  ds_read_b64_tr_b16 a[212:213], v8 offset:25032
  v_fma_f32 v92, v54, s30, v23
  v_mfma_f32_16x16x32_bf16 v[208:211], a[216:219], v[84:87], v[208:211]
  ds_read_b64_tr_b16 a[218:219], v9 offset:24960
  v_exp_f32 v29, v93
  v_mfma_f32_16x16x32_bf16 v[212:215], a[222:225], v[84:87], v[212:215]
  ds_read_b64_tr_b16 a[224:225], v9 offset:24968
  v_fma_f32 v93, v55, s30, v23
  v_mfma_f32_16x16x32_bf16 v[216:219], a[228:231], v[84:87], v[216:219]
  ds_read_b64_tr_b16 a[230:231], v9 offset:25024
  v_cvt_pk_bf16_f32 v72, v28, v29
  v_mfma_f32_16x16x32_bf16 v[220:223], a[234:237], v[84:87], v[220:223]
  ds_read_b64_tr_b16 a[236:237], v9 offset:25032
  v_exp_f32 v30, v92
  v_mfma_f32_16x16x32_bf16 v[60:63], a[160:163], a[80:83], 0
  v_fma_f32 v92, v56, s30, v23
  v_exp_f32 v31, v93
  v_mfma_f32_16x16x32_bf16 v[60:63], a[164:167], a[84:87], v[60:63]
  v_fma_f32 v93, v57, s30, v23
  v_cvt_pk_bf16_f32 v73, v30, v31
  v_mfma_f32_16x16x32_bf16 v[60:63], a[168:171], a[88:91], v[60:63]
  v_exp_f32 v28, v92
  v_mfma_f32_16x16x32_bf16 v[60:63], a[172:175], a[92:95], v[60:63]
  v_fma_f32 v92, v58, s30, v23
  v_exp_f32 v29, v93
  v_mfma_f32_16x16x32_bf16 v[64:67], a[176:179], a[80:83], 0
  v_fma_f32 v93, v59, s30, v23
  v_cvt_pk_bf16_f32 v74, v28, v29
  v_mfma_f32_16x16x32_bf16 v[64:67], a[180:183], a[84:87], v[64:67]
  v_exp_f32 v30, v92
  v_mfma_f32_16x16x32_bf16 v[64:67], a[184:187], a[88:91], v[64:67]
  v_fma_f32 v92, v60, s30, v24
  v_exp_f32 v31, v93
  v_mfma_f32_16x16x32_bf16 v[64:67], a[188:191], a[92:95], v[64:67]
  v_cvt_pk_bf16_f32 v75, v30, v31
  v_fma_f32 v93, v61, s30, v24
  v_mfma_f32_16x16x32_bf16 v[48:51], a[240:243], v[88:91], v[48:51]
  v_exp_f32 v28, v92
  s_waitcnt lgkmcnt(0)
  v_mfma_f32_16x16x32_bf16 v[224:227], a[192:195], v[88:91], v[224:227]
  v_fma_f32 v92, v62, s30, v24
  v_exp_f32 v29, v93
  v_mfma_f32_16x16x32_bf16 v[228:231], a[198:201], v[88:91], v[228:231]
  v_fma_f32 v93, v63, s30, v24
  v_cvt_pk_bf16_f32 v76, v28, v29
  v_mfma_f32_16x16x32_bf16 v[232:235], a[204:207], v[88:91], v[232:235]
  v_exp_f32 v30, v92
  v_mfma_f32_16x16x32_bf16 v[236:239], a[210:213], v[88:91], v[236:239]
  v_fma_f32 v92, v64, s30, v24
  v_exp_f32 v31, v93
  v_mfma_f32_16x16x32_bf16 v[240:243], a[216:219], v[88:91], v[240:243]
  v_fma_f32 v93, v65, s30, v24
  v_cvt_pk_bf16_f32 v77, v30, v31
  v_mfma_f32_16x16x32_bf16 v[244:247], a[222:225], v[88:91], v[244:247]
  v_exp_f32 v28, v92
  v_mfma_f32_16x16x32_bf16 v[248:251], a[228:231], v[88:91], v[248:251]
  v_fma_f32 v92, v66, s30, v24
  v_exp_f32 v29, v93
  v_mfma_f32_16x16x32_bf16 v[252:255], a[234:237], v[88:91], v[252:255]
  v_fma_f32 v93, v67, s30, v24
  v_cvt_pk_bf16_f32 v78, v28, v29
  v_mfma_f32_16x16x32_bf16 v[52:55], a[160:163], a[96:99], 0
  v_exp_f32 v30, v92
  v_mfma_f32_16x16x32_bf16 v[52:55], a[164:167], a[100:103], v[52:55]
  v_mfma_f32_16x16x32_bf16 v[52:55], a[168:171], a[104:107], v[52:55]
  s_add_u32 s36, s26, 4352
  v_add_u32 v0, s36, v17
  v_bfe_u32 v1, v17, 1, 7
  v_mov_b32 v18, v27
  v_mov_b32 v19, v48
  ds_write_b128 v0, v[240:243] offset:0
  ds_write_b128 v0, v[244:247] offset:1024
  ds_write_b128 v0, v[248:251] offset:2048
  ds_write_b128 v0, v[252:255] offset:3072
  v_add_u32 v0, s36, v1
  ds_write_b64 v0, v[18:19] offset:4096
  v_mfma_f32_16x16x32_bf16 v[52:55], a[172:175], a[108:111], v[52:55]
  v_mfma_f32_16x16x32_bf16 v[56:59], a[176:179], a[96:99], 0
  v_mfma_f32_16x16x32_bf16 v[56:59], a[180:183], a[100:103], v[56:59]
  v_mfma_f32_16x16x32_bf16 v[56:59], a[184:187], a[104:107], v[56:59]
  s_nop 4
  v_fma_f32 v92, v52, s30, v25
  v_exp_f32 v31, v93
  v_mfma_f32_16x16x32_bf16 v[56:59], a[188:191], a[108:111], v[56:59]
  v_cvt_pk_bf16_f32 v79, v30, v31
  v_fma_f32 v93, v53, s30, v25
  v_mfma_f32_16x16x32_bf16 v[32:35], a[240:243], v[72:75], v[32:35]
  v_exp_f32 v28, v92
  v_mfma_f32_16x16x32_bf16 v[96:99], a[194:197], v[72:75], v[96:99]
  v_fma_f32 v92, v54, s30, v25
  v_exp_f32 v29, v93
  v_mfma_f32_16x16x32_bf16 v[100:103], a[200:203], v[72:75], v[100:103]
  v_fma_f32 v93, v55, s30, v25
  v_cvt_pk_bf16_f32 v80, v28, v29
  v_mfma_f32_16x16x32_bf16 v[104:107], a[206:209], v[72:75], v[104:107]
  v_exp_f32 v30, v92
  v_mfma_f32_16x16x32_bf16 v[108:111], a[212:215], v[72:75], v[108:111]
  v_fma_f32 v92, v56, s30, v25
  v_exp_f32 v31, v93
  v_mfma_f32_16x16x32_bf16 v[112:115], a[218:221], v[72:75], v[112:115]
  v_fma_f32 v93, v57, s30, v25
  v_cvt_pk_bf16_f32 v81, v30, v31
  v_mfma_f32_16x16x32_bf16 v[116:119], a[224:227], v[72:75], v[116:119]
  v_exp_f32 v28, v92
  v_mfma_f32_16x16x32_bf16 v[120:123], a[230:233], v[72:75], v[120:123]
  v_fma_f32 v92, v58, s30, v25
  v_exp_f32 v29, v93
  v_mfma_f32_16x16x32_bf16 v[124:127], a[236:239], v[72:75], v[124:127]
  v_fma_f32 v93, v59, s30, v25
  v_cvt_pk_bf16_f32 v82, v28, v29
  s_waitcnt lgkmcnt(0)
  s_barrier
  v_mfma_f32_16x16x32_bf16 v[60:63], a[160:163], a[112:115], 0
  v_add_u32 v0, s40, v1
  ds_read_b64 v[20:21], v0 offset:4096
  v_add_u32 v0, s40, v17
  ds_read_b128 v[240:243], v0 offset:0
  ds_read_b128 v[244:247], v0 offset:1024
  ds_read_b128 v[248:251], v0 offset:2048
  ds_read_b128 v[252:255], v0 offset:3072
  v_rcp_f32 v22, v32
  v_cmp_nge_f32 vcc, s32, v32
  s_nop 0
  s_or_b64 s[42:43], s[42:43], vcc
  v_pk_mul_f32 v[96:97], v[96:97], v[22:23] op_sel_hi:[1,0]
  v_pk_mul_f32 v[98:99], v[98:99], v[22:23] op_sel_hi:[1,0]
  v_pk_mul_f32 v[100:101], v[100:101], v[22:23] op_sel_hi:[1,0]
  v_pk_mul_f32 v[102:103], v[102:103], v[22:23] op_sel_hi:[1,0]
  v_cvt_pk_bf16_f32 v96, v96, v97
  v_cvt_pk_bf16_f32 v97, v98, v99
  v_cvt_pk_bf16_f32 v98, v100, v101
  v_cvt_pk_bf16_f32 v99, v102, v103
  ds_write_b128 v14, v[96:99] offset:0
  v_pk_mul_f32 v[104:105], v[104:105], v[22:23] op_sel_hi:[1,0]
  v_pk_mul_f32 v[106:107], v[106:107], v[22:23] op_sel_hi:[1,0]
  v_pk_mul_f32 v[108:109], v[108:109], v[22:23] op_sel_hi:[1,0]
  v_pk_mul_f32 v[110:111], v[110:111], v[22:23] op_sel_hi:[1,0]
  v_cvt_pk_bf16_f32 v104, v104, v105
  v_cvt_pk_bf16_f32 v105, v106, v107
  v_cvt_pk_bf16_f32 v106, v108, v109
  v_cvt_pk_bf16_f32 v107, v110, v111
  ds_write_b128 v14, v[104:107] offset:64
  v_pk_mul_f32 v[112:113], v[112:113], v[22:23] op_sel_hi:[1,0]
  v_pk_mul_f32 v[114:115], v[114:115], v[22:23] op_sel_hi:[1,0]
  v_pk_mul_f32 v[116:117], v[116:117], v[22:23] op_sel_hi:[1,0]
  v_pk_mul_f32 v[118:119], v[118:119], v[22:23] op_sel_hi:[1,0]
  v_cvt_pk_bf16_f32 v112, v112, v113
  v_cvt_pk_bf16_f32 v113, v114, v115
  v_cvt_pk_bf16_f32 v114, v116, v117
  v_cvt_pk_bf16_f32 v115, v118, v119
  ds_write_b128 v15, v[112:115] offset:0
  v_mfma_f32_16x16x32_bf16 v[60:63], a[164:167], a[116:119], v[60:63]
  v_exp_f32 v30, v92
  v_mfma_f32_16x16x32_bf16 v[60:63], a[168:171], a[120:123], v[60:63]
  v_pk_mul_f32 v[120:121], v[120:121], v[22:23] op_sel_hi:[1,0]
  v_pk_mul_f32 v[122:123], v[122:123], v[22:23] op_sel_hi:[1,0]
  v_pk_mul_f32 v[124:125], v[124:125], v[22:23] op_sel_hi:[1,0]
  v_pk_mul_f32 v[126:127], v[126:127], v[22:23] op_sel_hi:[1,0]
  v_cvt_pk_bf16_f32 v120, v120, v121
  v_mfma_f32_16x16x32_bf16 v[60:63], a[172:175], a[124:127], v[60:63]
  v_cvt_pk_bf16_f32 v121, v122, v123
  v_cvt_pk_bf16_f32 v122, v124, v125
  v_cvt_pk_bf16_f32 v123, v126, v127
  v_mfma_f32_16x16x32_bf16 v[64:67], a[176:179], a[112:115], 0
  ds_write_b128 v15, v[120:123] offset:64
  ds_read_b128 a[0:3], v16 offset:0
  v_mfma_f32_16x16x32_bf16 v[64:67], a[180:183], a[116:119], v[64:67]
  ds_read_b128 a[4:7], v16 offset:1088
  ds_read_b128 a[8:11], v16 offset:2176
  ds_read_b128 a[12:15], v16 offset:3264
  v_mfma_f32_16x16x32_bf16 v[64:67], a[184:187], a[120:123], v[64:67]
  v_fma_f32 v92, v60, s30, v26
  v_exp_f32 v31, v93
  v_mfma_f32_16x16x32_bf16 v[64:67], a[188:191], a[124:127], v[64:67]
  v_cvt_pk_bf16_f32 v83, v30, v31
  v_fma_f32 v93, v61, s30, v26
  v_mfma_f32_16x16x32_bf16 v[36:39], a[240:243], v[76:79], v[36:39]
  v_exp_f32 v28, v92
  v_mfma_f32_16x16x32_bf16 v[128:131], a[194:197], v[76:79], v[128:131]
  v_fma_f32 v92, v62, s30, v26
  v_exp_f32 v29, v93
  v_mfma_f32_16x16x32_bf16 v[132:135], a[200:203], v[76:79], v[132:135]
  v_fma_f32 v93, v63, s30, v26
  v_cvt_pk_bf16_f32 v84, v28, v29
  v_mfma_f32_16x16x32_bf16 v[136:139], a[206:209], v[76:79], v[136:139]
  v_rcp_f32 v22, v36
  v_cmp_nge_f32 vcc, s32, v36
  s_nop 0
  s_or_b64 s[42:43], s[42:43], vcc
  v_mfma_f32_16x16x32_bf16 v[140:143], a[212:215], v[76:79], v[140:143]
  v_exp_f32 v30, v92
  v_mfma_f32_16x16x32_bf16 v[144:147], a[218:221], v[76:79], v[144:147]
  v_pk_mul_f32 v[128:129], v[128:129], v[22:23] op_sel_hi:[1,0]
  v_pk_mul_f32 v[130:131], v[130:131], v[22:23] op_sel_hi:[1,0]
  v_pk_mul_f32 v[132:133], v[132:133], v[22:23] op_sel_hi:[1,0]
  v_pk_mul_f32 v[134:135], v[134:135], v[22:23] op_sel_hi:[1,0]
  v_cvt_pk_bf16_f32 v128, v128, v129
  v_cvt_pk_bf16_f32 v129, v130, v131
  v_cvt_pk_bf16_f32 v130, v132, v133
  v_cvt_pk_bf16_f32 v131, v134, v135
  ds_write_b128 v14, v[128:131] offset:0
  v_mfma_f32_16x16x32_bf16 v[148:151], a[224:227], v[76:79], v[148:151]
  v_fma_f32 v92, v64, s30, v26
  v_exp_f32 v31, v93
  v_mfma_f32_16x16x32_bf16 v[152:155], a[230:233], v[76:79], v[152:155]
  v_pk_mul_f32 v[136:137], v[136:137], v[22:23] op_sel_hi:[1,0]
  v_pk_mul_f32 v[138:139], v[138:139], v[22:23] op_sel_hi:[1,0]
  v_pk_mul_f32 v[140:141], v[140:141], v[22:23] op_sel_hi:[1,0]
  v_pk_mul_f32 v[142:143], v[142:143], v[22:23] op_sel_hi:[1,0]
  v_cvt_pk_bf16_f32 v136, v136, v137
  v_cvt_pk_bf16_f32 v137, v138, v139
  v_cvt_pk_bf16_f32 v138, v140, v141
  v_cvt_pk_bf16_f32 v139, v142, v143
  ds_write_b128 v14, v[136:139] offset:64
  s_add_u32 s35, s28, 18874368
  s_waitcnt lgkmcnt(2)
  buffer_store_dwordx4 a[0:3], v17, s[20:23], s35 offen offset:0 nt
  buffer_store_dwordx4 a[4:7], v17, s[20:23], s35 offen offset:1024 nt
  v_mfma_f32_16x16x32_bf16 v[156:159], a[236:239], v[76:79], v[156:159]
  buffer_store_dwordx4 a[8:11], v17, s[20:23], s35 offen offset:2048 nt
  buffer_store_dwordx4 a[12:15], v17, s[20:23], s35 offen offset:3072 nt
  v_mfma_f32_16x16x32_bf16 v[40:43], a[240:243], v[80:83], v[40:43]
  v_fma_f32 v93, v65, s30, v26
  v_cvt_pk_bf16_f32 v85, v30, v31
  v_mfma_f32_16x16x32_bf16 v[160:163], a[194:197], v[80:83], v[160:163]
  v_pk_mul_f32 v[144:145], v[144:145], v[22:23] op_sel_hi:[1,0]
  v_pk_mul_f32 v[146:147], v[146:147], v[22:23] op_sel_hi:[1,0]
  v_pk_mul_f32 v[148:149], v[148:149], v[22:23] op_sel_hi:[1,0]
  v_pk_mul_f32 v[150:151], v[150:151], v[22:23] op_sel_hi:[1,0]
  v_cvt_pk_bf16_f32 v144, v144, v145
  v_mfma_f32_16x16x32_bf16 v[164:167], a[200:203], v[80:83], v[164:167]
  v_cvt_pk_bf16_f32 v145, v146, v147
  v_exp_f32 v28, v92
  v_cvt_pk_bf16_f32 v146, v148, v149
  v_fma_f32 v92, v66, s30, v26
  v_cvt_pk_bf16_f32 v147, v150, v151
  v_mfma_f32_16x16x32_bf16 v[168:171], a[206:209], v[80:83], v[168:171]
  ds_write_b128 v15, v[144:147] offset:0
  v_exp_f32 v29, v93
  v_fma_f32 v93, v67, s30, v26
  v_mfma_f32_16x16x32_bf16 v[172:175], a[212:215], v[80:83], v[172:175]
  v_cvt_pk_bf16_f32 v86, v28, v29
  v_pk_mul_f32 v[152:153], v[152:153], v[22:23] op_sel_hi:[1,0]
  v_pk_mul_f32 v[154:155], v[154:155], v[22:23] op_sel_hi:[1,0]
  v_pk_mul_f32 v[156:157], v[156:157], v[22:23] op_sel_hi:[1,0]
  v_pk_mul_f32 v[158:159], v[158:159], v[22:23] op_sel_hi:[1,0]
  v_mfma_f32_16x16x32_bf16 v[176:179], a[218:221], v[80:83], v[176:179]
  v_exp_f32 v30, v92
  v_cvt_pk_bf16_f32 v152, v152, v153
  v_cvt_pk_bf16_f32 v153, v154, v155
  v_exp_f32 v31, v93
  v_mfma_f32_16x16x32_bf16 v[180:183], a[224:227], v[80:83], v[180:183]
  v_cvt_pk_bf16_f32 v154, v156, v157
  v_cvt_pk_bf16_f32 v155, v158, v159
  v_cvt_pk_bf16_f32 v87, v30, v31
  ds_write_b128 v15, v[152:155] offset:64
  v_mfma_f32_16x16x32_bf16 v[184:187], a[230:233], v[80:83], v[184:187]
  ds_read_b128 a[16:19], v16 offset:0
  ds_read_b128 a[20:23], v16 offset:1088
  v_mfma_f32_16x16x32_bf16 v[188:191], a[236:239], v[80:83], v[188:191]
  ds_read_b128 a[24:27], v16 offset:2176
  ds_read_b128 a[28:31], v16 offset:3264
  v_mfma_f32_16x16x32_bf16 v[44:47], a[240:243], v[84:87], v[44:47]
  s_add_u32 s35, s28, 18878464
  s_waitcnt lgkmcnt(3)
  buffer_store_dwordx4 a[16:19], v17, s[20:23], s35 offen offset:0 nt
  v_mfma_f32_16x16x32_bf16 v[192:195], a[194:197], v[84:87], v[192:195]
  s_waitcnt lgkmcnt(2)
  buffer_store_dwordx4 a[20:23], v17, s[20:23], s35 offen offset:1024 nt
  s_waitcnt lgkmcnt(1)
  buffer_store_dwordx4 a[24:27], v17, s[20:23], s35 offen offset:2048 nt
  v_mfma_f32_16x16x32_bf16 v[196:199], a[200:203], v[84:87], v[196:199]
  s_waitcnt lgkmcnt(0)
  buffer_store_dwordx4 a[28:31], v17, s[20:23], s35 offen offset:3072 nt
  v_cmp_nge_f32 vcc, s32, v19
  s_nop 0
  s_or_b64 s[42:43], s[42:43], vcc
  v_mfma_f32_16x16x32_bf16 v[200:203], a[206:209], v[84:87], v[200:203]
  v_min_f32 v0, v18, v20
  v_sub_f32 v18, v0, v18
  v_mfma_f32_16x16x32_bf16 v[204:207], a[212:215], v[84:87], v[204:207]
  v_sub_f32 v20, v0, v20
  v_exp_f32 v18, v18
  v_mfma_f32_16x16x32_bf16 v[208:211], a[218:221], v[84:87], v[208:211]
  v_exp_f32 v20, v20
  v_mfma_f32_16x16x32_bf16 v[212:215], a[224:227], v[84:87], v[212:215]
  v_lshrrev_b32 v0, 7, v17
  v_mul_f32 v19, v18, v19
  v_mfma_f32_16x16x32_bf16 v[216:219], a[230:233], v[84:87], v[216:219]
  v_fmac_f32 v19, v20, v21
  v_rcp_f32 v22, v19
  v_mfma_f32_16x16x32_bf16 v[220:223], a[236:239], v[84:87], v[220:223]
  v_and_b32 v1, 0x70, v17
  v_mul_f32 v18, v18, v22
  v_mul_f32 v20, v20, v22
  v_pk_mul_f32 v[224:225], v[224:225], v[18:19] op_sel_hi:[1,0]
  v_pk_mul_f32 v[226:227], v[226:227], v[18:19] op_sel_hi:[1,0]
  v_pk_mul_f32 v[228:229], v[228:229], v[18:19] op_sel_hi:[1,0]
  v_pk_mul_f32 v[230:231], v[230:231], v[18:19] op_sel_hi:[1,0]
  v_pk_fma_f32 v[224:225], v[240:241], v[20:21], v[224:225] op_sel_hi:[1,0,1]
  v_pk_fma_f32 v[226:227], v[242:243], v[20:21], v[226:227] op_sel_hi:[1,0,1]
  v_pk_fma_f32 v[228:229], v[244:245], v[20:21], v[228:229] op_sel_hi:[1,0,1]
  v_pk_fma_f32 v[230:231], v[246:247], v[20:21], v[230:231] op_sel_hi:[1,0,1]
  v_cvt_pk_bf16_f32 v224, v224, v225
  v_cvt_pk_bf16_f32 v225, v226, v227
  v_cvt_pk_bf16_f32 v226, v228, v229
  v_cvt_pk_bf16_f32 v227, v230, v231
  ds_write_b128 v14, v[224:227] offset:0
  v_pk_mul_f32 v[232:233], v[232:233], v[18:19] op_sel_hi:[1,0]
  v_pk_mul_f32 v[234:235], v[234:235], v[18:19] op_sel_hi:[1,0]
  v_pk_mul_f32 v[236:237], v[236:237], v[18:19] op_sel_hi:[1,0]
  v_pk_mul_f32 v[238:239], v[238:239], v[18:19] op_sel_hi:[1,0]
  v_pk_fma_f32 v[232:233], v[248:249], v[20:21], v[232:233] op_sel_hi:[1,0,1]
  v_pk_fma_f32 v[234:235], v[250:251], v[20:21], v[234:235] op_sel_hi:[1,0,1]
  v_pk_fma_f32 v[236:237], v[252:253], v[20:21], v[236:237] op_sel_hi:[1,0,1]
  v_pk_fma_f32 v[238:239], v[254:255], v[20:21], v[238:239] op_sel_hi:[1,0,1]
  v_cvt_pk_bf16_f32 v232, v232, v233
  v_cvt_pk_bf16_f32 v233, v234, v235
  v_cvt_pk_bf16_f32 v234, v236, v237
  v_cvt_pk_bf16_f32 v235, v238, v239
  ds_write_b128 v14, v[232:235] offset:64
  s_lshl_b32 s36, s39, 7
  v_add_u32 v1, s36, v1
  v_mul_u32_u24 v18, 0x110, v0
  v_add3_u32 v18, v18, v1, s26
  ds_read_b128 a[128:131], v18 offset:0
  ds_read_b128 a[132:135], v18 offset:2176
  v_lshl_add_u32 v13, v0, 8, v1
  v_rcp_f32 v22, v40
  v_cmp_nge_f32 vcc, s32, v40
  s_nop 0
  s_or_b64 s[42:43], s[42:43], vcc
  v_pk_mul_f32 v[160:161], v[160:161], v[22:23] op_sel_hi:[1,0]
  v_pk_mul_f32 v[162:163], v[162:163], v[22:23] op_sel_hi:[1,0]
  v_pk_mul_f32 v[164:165], v[164:165], v[22:23] op_sel_hi:[1,0]
  v_pk_mul_f32 v[166:167], v[166:167], v[22:23] op_sel_hi:[1,0]
  v_cvt_pk_bf16_f32 v160, v160, v161
  v_cvt_pk_bf16_f32 v161, v162, v163
  v_cvt_pk_bf16_f32 v162, v164, v165
  v_cvt_pk_bf16_f32 v163, v166, v167
  ds_write_b128 v14, v[160:163] offset:0
  v_pk_mul_f32 v[168:169], v[168:169], v[22:23] op_sel_hi:[1,0]
  v_pk_mul_f32 v[170:171], v[170:171], v[22:23] op_sel_hi:[1,0]
  v_pk_mul_f32 v[172:173], v[172:173], v[22:23] op_sel_hi:[1,0]
  v_pk_mul_f32 v[174:175], v[174:175], v[22:23] op_sel_hi:[1,0]
  v_cvt_pk_bf16_f32 v168, v168, v169
  v_cvt_pk_bf16_f32 v169, v170, v171
  v_cvt_pk_bf16_f32 v170, v172, v173
  v_cvt_pk_bf16_f32 v171, v174, v175
  ds_write_b128 v14, v[168:171] offset:64
  s_add_u32 s35, s29, 18874368
  s_waitcnt lgkmcnt(3)
  buffer_store_dwordx4 a[128:131], v13, s[20:23], s35 offen offset:0 nt
  s_waitcnt lgkmcnt(2)
  buffer_store_dwordx4 a[132:135], v13, s[20:23], s35 offen offset:2048 nt
  v_pk_mul_f32 v[176:177], v[176:177], v[22:23] op_sel_hi:[1,0]
  v_pk_mul_f32 v[178:179], v[178:179], v[22:23] op_sel_hi:[1,0]
  v_pk_mul_f32 v[180:181], v[180:181], v[22:23] op_sel_hi:[1,0]
  v_pk_mul_f32 v[182:183], v[182:183], v[22:23] op_sel_hi:[1,0]
  v_cvt_pk_bf16_f32 v176, v176, v177
  v_cvt_pk_bf16_f32 v177, v178, v179
  v_cvt_pk_bf16_f32 v178, v180, v181
  v_cvt_pk_bf16_f32 v179, v182, v183
  ds_write_b128 v15, v[176:179] offset:0
  v_pk_mul_f32 v[184:185], v[184:185], v[22:23] op_sel_hi:[1,0]
  v_pk_mul_f32 v[186:187], v[186:187], v[22:23] op_sel_hi:[1,0]
  v_pk_mul_f32 v[188:189], v[188:189], v[22:23] op_sel_hi:[1,0]
  v_pk_mul_f32 v[190:191], v[190:191], v[22:23] op_sel_hi:[1,0]
  v_cvt_pk_bf16_f32 v184, v184, v185
  v_cvt_pk_bf16_f32 v185, v186, v187
  v_cvt_pk_bf16_f32 v186, v188, v189
  v_cvt_pk_bf16_f32 v187, v190, v191
  ds_write_b128 v15, v[184:187] offset:64
  ds_read_b128 a[32:35], v16 offset:0
  ds_read_b128 a[36:39], v16 offset:1088
  ds_read_b128 a[40:43], v16 offset:2176
  ds_read_b128 a[44:47], v16 offset:3264
  v_rcp_f32 v22, v44
  v_cmp_nge_f32 vcc, s32, v44
  s_nop 0
  s_or_b64 s[42:43], s[42:43], vcc
  v_pk_mul_f32 v[192:193], v[192:193], v[22:23] op_sel_hi:[1,0]
  v_pk_mul_f32 v[194:195], v[194:195], v[22:23] op_sel_hi:[1,0]
  v_pk_mul_f32 v[196:197], v[196:197], v[22:23] op_sel_hi:[1,0]
  v_pk_mul_f32 v[198:199], v[198:199], v[22:23] op_sel_hi:[1,0]
  v_cvt_pk_bf16_f32 v192, v192, v193
  v_cvt_pk_bf16_f32 v193, v194, v195
  v_cvt_pk_bf16_f32 v194, v196, v197
  v_cvt_pk_bf16_f32 v195, v198, v199
  ds_write_b128 v14, v[192:195] offset:0
  v_pk_mul_f32 v[200:201], v[200:201], v[22:23] op_sel_hi:[1,0]
  v_pk_mul_f32 v[202:203], v[202:203], v[22:23] op_sel_hi:[1,0]
  v_pk_mul_f32 v[204:205], v[204:205], v[22:23] op_sel_hi:[1,0]
  v_pk_mul_f32 v[206:207], v[206:207], v[22:23] op_sel_hi:[1,0]
  v_cvt_pk_bf16_f32 v200, v200, v201
  v_cvt_pk_bf16_f32 v201, v202, v203
  v_cvt_pk_bf16_f32 v202, v204, v205
  v_cvt_pk_bf16_f32 v203, v206, v207
  ds_write_b128 v14, v[200:203] offset:64
  s_add_u32 s35, s28, 18882560
  s_waitcnt lgkmcnt(5)
  buffer_store_dwordx4 a[32:35], v17, s[20:23], s35 offen offset:0 nt
  s_waitcnt lgkmcnt(4)
  buffer_store_dwordx4 a[36:39], v17, s[20:23], s35 offen offset:1024 nt
  s_waitcnt lgkmcnt(3)
  buffer_store_dwordx4 a[40:43], v17, s[20:23], s35 offen offset:2048 nt
  s_waitcnt lgkmcnt(2)
  buffer_store_dwordx4 a[44:47], v17, s[20:23], s35 offen offset:3072 nt
  v_pk_mul_f32 v[208:209], v[208:209], v[22:23] op_sel_hi:[1,0]
  v_pk_mul_f32 v[210:211], v[210:211], v[22:23] op_sel_hi:[1,0]
  v_pk_mul_f32 v[212:213], v[212:213], v[22:23] op_sel_hi:[1,0]
  v_pk_mul_f32 v[214:215], v[214:215], v[22:23] op_sel_hi:[1,0]
  v_cvt_pk_bf16_f32 v208, v208, v209
  v_cvt_pk_bf16_f32 v209, v210, v211
  v_cvt_pk_bf16_f32 v210, v212, v213
  v_cvt_pk_bf16_f32 v211, v214, v215
  ds_write_b128 v15, v[208:211] offset:0
  v_pk_mul_f32 v[216:217], v[216:217], v[22:23] op_sel_hi:[1,0]
  v_pk_mul_f32 v[218:219], v[218:219], v[22:23] op_sel_hi:[1,0]
  v_pk_mul_f32 v[220:221], v[220:221], v[22:23] op_sel_hi:[1,0]
  v_pk_mul_f32 v[222:223], v[222:223], v[22:23] op_sel_hi:[1,0]
  v_cvt_pk_bf16_f32 v216, v216, v217
  v_cvt_pk_bf16_f32 v217, v218, v219
  v_cvt_pk_bf16_f32 v218, v220, v221
  v_cvt_pk_bf16_f32 v219, v222, v223
  ds_write_b128 v15, v[216:219] offset:64
  ds_read_b128 a[48:51], v16 offset:0
  ds_read_b128 a[52:55], v16 offset:1088
  ds_read_b128 a[56:59], v16 offset:2176
  ds_read_b128 a[60:63], v16 offset:3264
  s_add_u32 s35, s28, 18886656
  s_waitcnt lgkmcnt(3)
  buffer_store_dwordx4 a[48:51], v17, s[20:23], s35 offen offset:0 nt
  s_waitcnt lgkmcnt(2)
  buffer_store_dwordx4 a[52:55], v17, s[20:23], s35 offen offset:1024 nt
  s_waitcnt lgkmcnt(1)
  buffer_store_dwordx4 a[56:59], v17, s[20:23], s35 offen offset:2048 nt
  s_waitcnt lgkmcnt(0)
  buffer_store_dwordx4 a[60:63], v17, s[20:23], s35 offen offset:3072 nt
  s_cmp_lg_u32 s38, 0
  s_cbranch_scc1 L_fin
  s_cmp_lg_u64 s[42:43], 0
  s_cselect_b32 s36, 1, 0
  v_mov_b32 v35, 160640
  v_mov_b32 v34, s36
  ds_or_b32 v35, v34
  s_waitcnt lgkmcnt(0)
  s_barrier
  ds_read_b32 v34, v35
  s_waitcnt lgkmcnt(0)
  v_readfirstlane_b32 s36, v34
  s_nop 0
  s_cmp_lg_u32 s36, 0
  s_cbranch_scc1 L_slow
L_fin:
  s_waitcnt vmcnt(0)
L_end:
  s_endpgm
L_slow:
  s_waitcnt vmcnt(0)
  s_add_u32 s36, s28, 0
  buffer_load_dwordx4 v[96:99], v12, s[8:11], s36 offen offset:0
  buffer_load_dwordx4 v[100:103], v12, s[8:11], s36 offen offset:64
  buffer_load_dwordx4 v[104:107], v12, s[8:11], s36 offen offset:128
  buffer_load_dwordx4 v[108:111], v12, s[8:11], s36 offen offset:192
  v_mov_b32 v23, 0xff800000
  s_add_u32 s36, s28, 4096
  buffer_load_dwordx4 v[112:115], v12, s[8:11], s36 offen offset:0
  buffer_load_dwordx4 v[116:119], v12, s[8:11], s36 offen offset:64
  buffer_load_dwordx4 v[120:123], v12, s[8:11], s36 offen offset:128
  buffer_load_dwordx4 v[124:127], v12, s[8:11], s36 offen offset:192
  v_mov_b32 v24, 0xff800000
  s_add_u32 s36, s28, 8192
  buffer_load_dwordx4 v[128:131], v12, s[8:11], s36 offen offset:0
  buffer_load_dwordx4 v[132:135], v12, s[8:11], s36 offen offset:64
  buffer_load_dwordx4 v[136:139], v12, s[8:11], s36 offen offset:128
  buffer_load_dwordx4 v[140:143], v12, s[8:11], s36 offen offset:192
  v_mov_b32 v25, 0xff800000
  s_add_u32 s36, s28, 12288
  buffer_load_dwordx4 v[144:147], v12, s[8:11], s36 offen offset:0
  buffer_load_dwordx4 v[148:151], v12, s[8:11], s36 offen offset:64
  buffer_load_dwordx4 v[152:155], v12, s[8:11], s36 offen offset:128
  buffer_load_dwordx4 v[156:159], v12, s[8:11], s36 offen offset:192
  v_mov_b32 v26, 0xff800000
  s_add_u32 s36, s29, 0
  buffer_load_dwordx4 v[160:163], v12, s[8:11], s36 offen offset:0
  buffer_load_dwordx4 v[164:167], v12, s[8:11], s36 offen offset:64
  buffer_load_dwordx4 v[168:171], v12, s[8:11], s36 offen offset:128
  buffer_load_dwordx4 v[172:175], v12, s[8:11], s36 offen offset:192
  v_mov_b32 v27, 0xff800000
  s_and_b32 s33, s27, 0xfffe0000
  s_add_u32 s33, s33, 0
  s_mov_b32 s37, 0
L_sl0:
  buffer_load_dwordx4 v[192:195], v12, s[12:15], s33 offen offset:0
  buffer_load_dwordx4 v[196:199], v12, s[12:15], s33 offen offset:64
  buffer_load_dwordx4 v[200:203], v12, s[12:15], s33 offen offset:128
  buffer_load_dwordx4 v[204:207], v12, s[12:15], s33 offen offset:192
  s_waitcnt vmcnt(0)
  v_mfma_f32_16x16x32_bf16 v[52:55], v[192:195], v[96:99], 0
  v_mfma_f32_16x16x32_bf16 v[52:55], v[196:199], v[100:103], v[52:55]
  v_mfma_f32_16x16x32_bf16 v[52:55], v[200:203], v[104:107], v[52:55]
  v_mfma_f32_16x16x32_bf16 v[52:55], v[204:207], v[108:111], v[52:55]
  v_mfma_f32_16x16x32_bf16 v[56:59], v[192:195], v[112:115], 0
  v_mfma_f32_16x16x32_bf16 v[56:59], v[196:199], v[116:119], v[56:59]
  v_mfma_f32_16x16x32_bf16 v[56:59], v[200:203], v[120:123], v[56:59]
  v_mfma_f32_16x16x32_bf16 v[56:59], v[204:207], v[124:127], v[56:59]
  v_mfma_f32_16x16x32_bf16 v[60:63], v[192:195], v[128:131], 0
  v_mfma_f32_16x16x32_bf16 v[60:63], v[196:199], v[132:135], v[60:63]
  v_mfma_f32_16x16x32_bf16 v[60:63], v[200:203], v[136:139], v[60:63]
  v_mfma_f32_16x16x32_bf16 v[60:63], v[204:207], v[140:143], v[60:63]
  v_mfma_f32_16x16x32_bf16 v[64:67], v[192:195], v[144:147], 0
  v_mfma_f32_16x16x32_bf16 v[64:67], v[196:199], v[148:151], v[64:67]
  v_mfma_f32_16x16x32_bf16 v[64:67], v[200:203], v[152:155], v[64:67]
  v_mfma_f32_16x16x32_bf16 v[64:67], v[204:207], v[156:159], v[64:67]
  v_mfma_f32_16x16x32_bf16 v[68:71], v[192:195], v[160:163], 0
  v_mfma_f32_16x16x32_bf16 v[68:71], v[196:199], v[164:167], v[68:71]
  v_mfma_f32_16x16x32_bf16 v[68:71], v[200:203], v[168:171], v[68:71]
  v_mfma_f32_16x16x32_bf16 v[68:71], v[204:207], v[172:175], v[68:71]
  v_max3_f32 v23, v23, v52, v53
  v_max3_f32 v23, v23, v54, v55
  v_max3_f32 v24, v24, v56, v57
  v_max3_f32 v24, v24, v58, v59
  v_max3_f32 v25, v25, v60, v61
  v_max3_f32 v25, v25, v62, v63
  v_max3_f32 v26, v26, v64, v65
  v_max3_f32 v26, v26, v66, v67
  v_max3_f32 v27, v27, v68, v69
  v_max3_f32 v27, v27, v70, v71
  s_add_u32 s33, s33, 4096
  s_add_u32 s37, s37, 1
  s_cmp_lt_u32 s37, 32
  s_cbranch_scc1 L_sl0
  v_mov_b32 v94, v23
  s_nop 1
  v_permlane32_swap_b32 v23, v94
  v_max_f32 v23, v23, v94
  v_mov_b32 v94, v23
  s_nop 1
  v_permlane16_swap_b32 v23, v94
  v_max_f32 v23, v23, v94
  v_mul_f32 v23, s31, v23
  v_accvgpr_write_b32 a244, v23
  v_mov_b32 v94, v24
  s_nop 1
  v_permlane32_swap_b32 v24, v94
  v_max_f32 v24, v24, v94
  v_mov_b32 v94, v24
  s_nop 1
  v_permlane16_swap_b32 v24, v94
  v_max_f32 v24, v24, v94
  v_mul_f32 v24, s31, v24
  v_accvgpr_write_b32 a245, v24
  v_mov_b32 v94, v25
  s_nop 1
  v_permlane32_swap_b32 v25, v94
  v_max_f32 v25, v25, v94
  v_mov_b32 v94, v25
  s_nop 1
  v_permlane16_swap_b32 v25, v94
  v_max_f32 v25, v25, v94
  v_mul_f32 v25, s31, v25
  v_accvgpr_write_b32 a246, v25
  v_mov_b32 v94, v26
  s_nop 1
  v_permlane32_swap_b32 v26, v94
  v_max_f32 v26, v26, v94
  v_mov_b32 v94, v26
  s_nop 1
  v_permlane16_swap_b32 v26, v94
  v_max_f32 v26, v26, v94
  v_mul_f32 v26, s31, v26
  v_accvgpr_write_b32 a247, v26
  v_mov_b32 v94, v27
  s_nop 1
  v_permlane32_swap_b32 v27, v94
  v_max_f32 v27, v27, v94
  v_mov_b32 v94, v27
  s_nop 1
  v_permlane16_swap_b32 v27, v94
  v_max_f32 v27, v27, v94
  v_mul_f32 v27, s31, v27
  v_accvgpr_write_b32 a248, v27
  s_add_u32 s36, s28, 18874368
  buffer_load_dwordx4 v[96:99], v12, s[8:11], s36 offen offset:0
  buffer_load_dwordx4 v[100:103], v12, s[8:11], s36 offen offset:64
  buffer_load_dwordx4 v[104:107], v12, s[8:11], s36 offen offset:128
  buffer_load_dwordx4 v[108:111], v12, s[8:11], s36 offen offset:192
  v_mov_b32 v23, 0xff800000
  s_add_u32 s36, s28, 18878464
  buffer_load_dwordx4 v[112:115], v12, s[8:11], s36 offen offset:0
  buffer_load_dwordx4 v[116:119], v12, s[8:11], s36 offen offset:64
  buffer_load_dwordx4 v[120:123], v12, s[8:11], s36 offen offset:128
  buffer_load_dwordx4 v[124:127], v12, s[8:11], s36 offen offset:192
  v_mov_b32 v24, 0xff800000
  s_add_u32 s36, s28, 18882560
  buffer_load_dwordx4 v[128:131], v12, s[8:11], s36 offen offset:0
  buffer_load_dwordx4 v[132:135], v12, s[8:11], s36 offen offset:64
  buffer_load_dwordx4 v[136:139], v12, s[8:11], s36 offen offset:128
  buffer_load_dwordx4 v[140:143], v12, s[8:11], s36 offen offset:192
  v_mov_b32 v25, 0xff800000
  s_add_u32 s36, s28, 18886656
  buffer_load_dwordx4 v[144:147], v12, s[8:11], s36 offen offset:0
  buffer_load_dwordx4 v[148:151], v12, s[8:11], s36 offen offset:64
  buffer_load_dwordx4 v[152:155], v12, s[8:11], s36 offen offset:128
  buffer_load_dwordx4 v[156:159], v12, s[8:11], s36 offen offset:192
  v_mov_b32 v26, 0xff800000
  s_add_u32 s36, s29, 18874368
  buffer_load_dwordx4 v[160:163], v12, s[8:11], s36 offen offset:0
  buffer_load_dwordx4 v[164:167], v12, s[8:11], s36 offen offset:64
  buffer_load_dwordx4 v[168:171], v12, s[8:11], s36 offen offset:128
  buffer_load_dwordx4 v[172:175], v12, s[8:11], s36 offen offset:192
  v_mov_b32 v27, 0xff800000
  s_and_b32 s33, s27, 0xfffe0000
  s_add_u32 s33, s33, 33554432
  s_mov_b32 s37, 0
L_sl1:
  buffer_load_dwordx4 v[192:195], v12, s[12:15], s33 offen offset:0
  buffer_load_dwordx4 v[196:199], v12, s[12:15], s33 offen offset:64
  buffer_load_dwordx4 v[200:203], v12, s[12:15], s33 offen offset:128
  buffer_load_dwordx4 v[204:207], v12, s[12:15], s33 offen offset:192
  s_waitcnt vmcnt(0)
  v_mfma_f32_16x16x32_bf16 v[52:55], v[192:195], v[96:99], 0
  v_mfma_f32_16x16x32_bf16 v[52:55], v[196:199], v[100:103], v[52:55]
  v_mfma_f32_16x16x32_bf16 v[52:55], v[200:203], v[104:107], v[52:55]
  v_mfma_f32_16x16x32_bf16 v[52:55], v[204:207], v[108:111], v[52:55]
  v_mfma_f32_16x16x32_bf16 v[56:59], v[192:195], v[112:115], 0
  v_mfma_f32_16x16x32_bf16 v[56:59], v[196:199], v[116:119], v[56:59]
  v_mfma_f32_16x16x32_bf16 v[56:59], v[200:203], v[120:123], v[56:59]
  v_mfma_f32_16x16x32_bf16 v[56:59], v[204:207], v[124:127], v[56:59]
  v_mfma_f32_16x16x32_bf16 v[60:63], v[192:195], v[128:131], 0
  v_mfma_f32_16x16x32_bf16 v[60:63], v[196:199], v[132:135], v[60:63]
  v_mfma_f32_16x16x32_bf16 v[60:63], v[200:203], v[136:139], v[60:63]
  v_mfma_f32_16x16x32_bf16 v[60:63], v[204:207], v[140:143], v[60:63]
  v_mfma_f32_16x16x32_bf16 v[64:67], v[192:195], v[144:147], 0
  v_mfma_f32_16x16x32_bf16 v[64:67], v[196:199], v[148:151], v[64:67]
  v_mfma_f32_16x16x32_bf16 v[64:67], v[200:203], v[152:155], v[64:67]
  v_mfma_f32_16x16x32_bf16 v[64:67], v[204:207], v[156:159], v[64:67]
  v_mfma_f32_16x16x32_bf16 v[68:71], v[192:195], v[160:163], 0
  v_mfma_f32_16x16x32_bf16 v[68:71], v[196:199], v[164:167], v[68:71]
  v_mfma_f32_16x16x32_bf16 v[68:71], v[200:203], v[168:171], v[68:71]
  v_mfma_f32_16x16x32_bf16 v[68:71], v[204:207], v[172:175], v[68:71]
  v_max3_f32 v23, v23, v52, v53
  v_max3_f32 v23, v23, v54, v55
  v_max3_f32 v24, v24, v56, v57
  v_max3_f32 v24, v24, v58, v59
  v_max3_f32 v25, v25, v60, v61
  v_max3_f32 v25, v25, v62, v63
  v_max3_f32 v26, v26, v64, v65
  v_max3_f32 v26, v26, v66, v67
  v_max3_f32 v27, v27, v68, v69
  v_max3_f32 v27, v27, v70, v71
  s_add_u32 s33, s33, 4096
  s_add_u32 s37, s37, 1
  s_cmp_lt_u32 s37, 32
  s_cbranch_scc1 L_sl1
  v_mov_b32 v94, v23
  s_nop 1
  v_permlane32_swap_b32 v23, v94
  v_max_f32 v23, v23, v94
  v_mov_b32 v94, v23
  s_nop 1
  v_permlane16_swap_b32 v23, v94
  v_max_f32 v23, v23, v94
  v_mul_f32 v23, s31, v23
  v_accvgpr_write_b32 a249, v23
  v_mov_b32 v94, v24
  s_nop 1
  v_permlane32_swap_b32 v24, v94
  v_max_f32 v24, v24, v94
  v_mov_b32 v94, v24
  s_nop 1
  v_permlane16_swap_b32 v24, v94
  v_max_f32 v24, v24, v94
  v_mul_f32 v24, s31, v24
  v_accvgpr_write_b32 a250, v24
  v_mov_b32 v94, v25
  s_nop 1
  v_permlane32_swap_b32 v25, v94
  v_max_f32 v25, v25, v94
  v_mov_b32 v94, v25
  s_nop 1
  v_permlane16_swap_b32 v25, v94
  v_max_f32 v25, v25, v94
  v_mul_f32 v25, s31, v25
  v_accvgpr_write_b32 a251, v25
  v_mov_b32 v94, v26
  s_nop 1
  v_permlane32_swap_b32 v26, v94
  v_max_f32 v26, v26, v94
  v_mov_b32 v94, v26
  s_nop 1
  v_permlane16_swap_b32 v26, v94
  v_max_f32 v26, v26, v94
  v_mul_f32 v26, s31, v26
  v_accvgpr_write_b32 a252, v26
  v_mov_b32 v94, v27
  s_nop 1
  v_permlane32_swap_b32 v27, v94
  v_max_f32 v27, v27, v94
  v_mov_b32 v94, v27
  s_nop 1
  v_permlane16_swap_b32 v27, v94
  v_max_f32 v27, v27, v94
  v_mul_f32 v27, s31, v27
  v_accvgpr_write_b32 a253, v27
  s_mov_b32 s38, 1
  s_barrier
  s_branch L_start
.section .rodata,"a"
.p2align 6
.amdhsa_kernel standalone__mha_softmax__near_ridge_kernel
  .amdhsa_next_free_vgpr 512
  .amdhsa_next_free_sgpr 102
  .amdhsa_accum_offset 256
  .amdhsa_group_segment_fixed_size 0
  .amdhsa_kernarg_size 48
  .amdhsa_user_sgpr_count 2
  .amdhsa_user_sgpr_kernarg_segment_ptr 1
  .amdhsa_system_sgpr_workgroup_id_x 1
.end_amdhsa_kernel
```
